```python
import torch

def _softmax(x, axis=-1):
    return torch.softmax(x, dim=axis)
def _gelu(x):
    return torch.nn.functional.gelu(x, approximate="tanh")
def _silu(x):
    return torch.nn.functional.silu(x)
def _sigmoid(x):
    return torch.sigmoid(x)
def _layernorm(x, axis=-1, eps=1e-5):
    m = x.mean(dim=axis, keepdim=True)
    v = x.var(dim=axis, keepdim=True, unbiased=False)
    return (x - m) / torch.sqrt(v + eps)
def _scatter_add(tgt, idx, src, axis=0):
    return tgt.clone().index_add_(axis, idx, src)
def _segment_sum(src, seg, n):
    out = torch.zeros((n,) + src.shape[1:], dtype=src.dtype)
    return out.index_add_(0, seg, src)
def _pad(x, pw):
    flat = tuple(v for pair in reversed(pw) for v in pair)
    return torch.nn.functional.pad(x, flat)

kernel_name = 'interleave_layers__sliding_block__glu_gated_bilinear__prompt'

def setup_inputs():

    _w = (lambda a: (lambda t: t.to(torch.bfloat16) if t.is_floating_point() else t)(torch.as_tensor(a)))
    def _A_setup():
        B, S, D = 1, 2048, 512
        return {
            "x": _w((lambda *s: torch.randn(*s, dtype=torch.bfloat16) * 0.05)(B, S, D)),
            "wqkv": _w((lambda *s: torch.randn(*s, dtype=torch.bfloat16) * 0.05)(D, 3 * D)),
            "wo": _w((lambda *s: torch.randn(*s, dtype=torch.bfloat16) * 0.05)(D, D)),
        }
    _A_in = _A_setup()

    def _B_setup():
        B, S, D, F = 1, 2048, 512, 1792
        return {
            "x": _w((lambda *s: torch.randn(*s, dtype=torch.bfloat16) * 0.05)(B, S, D)),
            "w_gate": _w((lambda *s: torch.randn(*s, dtype=torch.bfloat16) * 0.8)(D, F) * (D ** -0.5)),
            "w_up": _w((lambda *s: torch.randn(*s, dtype=torch.bfloat16) * 0.8)(D, F) * (D ** -0.5)),
            "w_down": _w((lambda *s: torch.randn(*s, dtype=torch.bfloat16) * 0.8)(F, D) * (F ** -0.5)),
        }
    _B_in = _B_setup()

    return {
        "A_x": _A_in["x"],
        "A_wqkv": _A_in["wqkv"],
        "A_wo": _A_in["wo"],
        "B_x": _B_in["x"],
        "B_w_gate": _B_in["w_gate"],
        "B_w_up": _B_in["w_up"],
        "B_w_down": _B_in["w_down"],
    }

def reference(A_x, A_wqkv, A_wo, B_x, B_w_gate, B_w_up, B_w_down):
    def _A_ref(x, wqkv, wo):
        B, S, D = x.shape
        H = 32; Dh = D // H; W = 256
        qkv = (lambda x, *d: x.permute(*d))((x @ wqkv).reshape(B, S, 3, H, Dh), 2, 0, 3, 1, 4)
        q, k, v = qkv[0], qkv[1], qkv[2]
        scores = torch.einsum("bhqd,bhkd->bhqk", q, k) * (Dh ** -0.5)
        idx = torch.arange(S)
        mask = (idx[:, None] - idx[None, :] >= 0) & (idx[:, None] - idx[None, :] < W)
        scores = torch.where(mask[None, None], scores, -1e9)
        p = _softmax(scores, axis=-1)
        o = torch.einsum("bhqk,bhkd->bhqd", p, v)
        return (lambda x, *d: x.permute(*d))(o, 0, 2, 1, 3).reshape(B, S, D) @ wo

    def _B_ref(x, w_gate, w_up, w_down):
        g = torch.einsum("bsd,df->bsf", x, w_gate)
        u = torch.einsum("bsd,df->bsf", x, w_up)
        h = g * u
        return torch.einsum("bsf,fd->bsd", h, w_down)

    x = A_x
    x = x + _A_ref(_layernorm(x, axis=-1), A_wqkv, A_wo)
    x = x + _B_ref(_layernorm(x, axis=-1), B_w_gate, B_w_up, B_w_down)
    x = x + _A_ref(_layernorm(x, axis=-1), A_wqkv, A_wo)
    x = x + _B_ref(_layernorm(x, axis=-1), B_w_gate, B_w_up, B_w_down)
    return x
```

```asm
; @launch grid=(256,1,1) block=(256,1,1) lds=163840
.amdgcn_target "amdgcn-amd-amdhsa--gfx950"
.text
.globl interleave_layers__sliding_block__glu_gated_bilinear__prompt_kernel
.p2align 8
.type interleave_layers__sliding_block__glu_gated_bilinear__prompt_kernel,@function
interleave_layers__sliding_block__glu_gated_bilinear__prompt_kernel:
	s_cmp_ge_u32 s2, 256
	s_cbranch_scc1 L_exit
	s_load_dwordx2 s[4:5], s[0:1], 0
	s_load_dwordx2 s[6:7], s[0:1], 8
	s_load_dwordx2 s[8:9], s[0:1], 16
	s_load_dwordx2 s[10:11], s[0:1], 32
	s_load_dwordx2 s[12:13], s[0:1], 40
	s_load_dwordx2 s[14:15], s[0:1], 48
	s_load_dwordx2 s[16:17], s[0:1], 56
	s_load_dwordx2 s[18:19], s[0:1], 64
	s_load_dwordx2 s[20:21], s[0:1], 72
	v_lshrrev_b32 v20, 6, v0
	v_and_b32 v0, 63, v0
	v_readfirstlane_b32 s24, v20
	v_lshlrev_b32 v1, 2, v0
	v_lshlrev_b32 v2, 4, v0
	v_add_u32 v3, 4096, v2
	v_add_u32 v4, 8192, v2
	v_add_u32 v5, 12288, v2
	v_add_u32 v6, 16384, v2
	v_add_u32 v7, 20480, v2
	v_add_u32 v8, 24576, v2
	v_add_u32 v9, 28672, v2
	v_add_u32 v18, 57344, v2
	v_add_u32 v19, 114688, v2
	s_and_b32 s40, s2, 7
	s_lshr_b32 s41, s2, 3
	s_and_b32 s23, s41, 15
	s_lshr_b32 s41, s41, 4
	s_lshl_b32 s40, s40, 1
	s_add_u32 s22, s40, s41
	s_lshl_b32 s48, s22, 4
	s_add_u32 s48, s48, s23
	s_lshl_b32 s27, s22, 2
	s_add_u32 s27, s27, s24
	s_and_b32 s40, s23, 1
	s_lshl_b32 s40, s40, 1
	s_and_b32 s41, s24, 1
	s_add_u32 s40, s40, s41
	s_lshl_b32 s28, s22, 2
	s_add_u32 s28, s28, s40
	s_lshr_b32 s40, s23, 1
	s_lshl_b32 s40, s40, 1
	s_lshr_b32 s41, s24, 1
	s_add_u32 s29, s40, s41
	s_mov_b32 s26, 400000
	s_getreg_b32 s50, hwreg(HW_REG_XCC_ID, 0, 4)
	s_waitcnt lgkmcnt(0)
	s_and_b32 s70, s28, 3
	v_mov_b32 v20, 0
	global_load_dword v250, v20, s[20:21] sc1
	v_and_b32 v22, 31, v0
	v_lshrrev_b32 v23, 5, v0
	v_lshlrev_b32 v24, 10, v22
	v_lshl_add_u32 v24, v23, 4, v24
	s_lshl_b32 s46, s27, 15
	s_lshl_b32 s47, s23, 6
	s_add_u32 s46, s46, s47
	s_add_u32 s30, s4, s46
	s_addc_u32 s31, s5, 0
	global_load_dwordx4 v[32:35], v24, s[30:31]
	global_load_dwordx4 v[36:39], v24, s[30:31] offset:32
	s_and_b32 s80, s48, 63
	s_lshr_b32 s81, s48, 6
	s_mov_b32 s82, 1024
	s_mov_b32 s92, 1024
	s_mov_b32 s93, 0
	s_mov_b32 s94, 0
	s_mov_b32 s95, 1
	s_add_u32 s96, s8, 0
	s_addc_u32 s97, s9, 0
	s_add_u32 s88, s20, 2621440
	s_addc_u32 s89, s21, 0
	s_add_u32 s90, s20, 720896
	s_addc_u32 s91, s21, 0
	s_cmp_ge_u32 s80, 58
	s_cbranch_scc1 L_jgo_3
	s_mov_b32 s95, 0
	s_lshl_b32 s40, s81, 2
	s_add_u32 s40, s40, s24
	s_cmp_lt_u32 s80, 12
	s_cbranch_scc1 L_jq_4
	s_cmp_lt_u32 s80, 40
	s_cbranch_scc1 L_jg_1
	s_cmp_lt_u32 s80, 44
	s_cbranch_scc1 L_jo_2
	s_sub_u32 s41, s80, 44
	s_lshl_b32 s46, s41, 17
	s_lshl_b32 s47, s81, 8
	s_add_u32 s46, s46, s47
	s_add_u32 s96, s14, s46
	s_addc_u32 s97, s15, 0
	s_mul_i32 s46, s40, 114688
	s_lshl_b32 s47, s41, 13
	s_add_u32 s46, s46, s47
	s_add_u32 s46, s46, 6815744
	s_add_u32 s88, s20, s46
	s_addc_u32 s89, s21, 0
	s_branch L_jgo_3
L_jo_2:
	s_sub_u32 s41, s80, 40
	s_lshl_b32 s46, s41, 17
	s_lshl_b32 s47, s81, 8
	s_add_u32 s46, s46, s47
	s_add_u32 s96, s8, s46
	s_addc_u32 s97, s9, 0
	s_lshl_b32 s46, s40, 15
	s_lshl_b32 s47, s41, 13
	s_add_u32 s46, s46, s47
	s_add_u32 s46, s46, 2621440
	s_add_u32 s88, s20, s46
	s_addc_u32 s89, s21, 0
	s_branch L_jgo_3
L_jq_4:
	s_mov_b32 s82, 3072
	s_mov_b32 s92, 3072
	s_mov_b32 s94, 1
	s_lshr_b32 s41, s80, 2
	s_and_b32 s42, s80, 3
	s_mul_i32 s46, s42, 393216
	s_lshl_b32 s47, s41, 10
	s_add_u32 s46, s46, s47
	s_lshl_b32 s47, s81, 8
	s_add_u32 s46, s46, s47
	s_add_u32 s96, s6, s46
	s_addc_u32 s97, s7, 0
	s_add_u32 s43, s41, 2
	s_cmp_ge_u32 s43, 3
	s_cselect_b32 s44, 3, 0
	s_sub_u32 s43, s43, s44
	s_mul_i32 s46, s40, 98304
	s_mul_i32 s47, s42, 24576
	s_add_u32 s46, s46, s47
	s_lshl_b32 s47, s43, 10
	s_add_u32 s46, s46, s47
	s_add_u32 s46, s46, 1048576
	s_add_u32 s88, s20, s46
	s_addc_u32 s89, s21, 0
	s_lshr_b32 s44, s42, 1
	s_and_b32 s45, s42, 1
	s_mul_i32 s46, s40, 3072
	s_lshl_b32 s47, s43, 10
	s_add_u32 s46, s46, s47
	s_lshl_b32 s47, s42, 8
	s_add_u32 s46, s46, s47
	s_add_u32 s46, s46, 655360
	s_add_u32 s90, s20, s46
	s_addc_u32 s91, s21, 0
	s_branch L_jgo_3
L_jg_1:
	s_mov_b32 s82, 3584
	s_mov_b32 s92, 7168
	s_mov_b32 s93, 1
	s_mov_b32 s94, 1
	s_sub_u32 s41, s80, 12
	s_and_b32 s42, s41, 3
	s_lshr_b32 s41, s41, 2
	s_mul_i32 s43, s81, 7
	s_add_u32 s41, s41, s43
	s_cmp_ge_u32 s24, 2
	s_cbranch_scc1 L_jup_5
	s_mul_i32 s46, s42, 458752
	s_lshl_b32 s47, s41, 7
	s_add_u32 s46, s46, s47
	s_add_u32 s96, s10, s46
	s_addc_u32 s97, s11, 0
	s_branch L_jupd_6
L_jup_5:
	s_mul_i32 s46, s42, 458752
	s_lshl_b32 s47, s41, 7
	s_add_u32 s46, s46, s47
	s_add_u32 s96, s12, s46
	s_addc_u32 s97, s13, 0
L_jupd_6:
	s_lshl_b32 s43, s41, 2
	s_add_u32 s43, s43, s24
	s_mul_i32 s44, s43, 9363
	s_lshr_b32 s44, s44, 16
	s_mul_i32 s45, s44, 7
	s_sub_u32 s45, s43, s45
	s_mul_i32 s46, s44, 229376
	s_mul_i32 s47, s42, 57344
	s_add_u32 s46, s46, s47
	s_lshl_b32 s47, s45, 10
	s_add_u32 s46, s46, s47
	s_add_u32 s46, s46, 3145728
	s_add_u32 s88, s20, s46
	s_addc_u32 s89, s21, 0
	s_lshr_b32 s44, s42, 1
	s_and_b32 s45, s42, 1
	s_lshl_b32 s46, s43, 10
	s_lshl_b32 s47, s42, 8
	s_add_u32 s46, s46, s47
	s_add_u32 s46, s46, 720896
	s_add_u32 s90, s20, s46
	s_addc_u32 s91, s21, 0
L_jgo_3:
	v_and_b32 v50, 15, v0
	v_lshrrev_b32 v50, 2, v50
	v_and_b32 v51, 3, v0
	v_lshlrev_b32 v51, 3, v51
	v_bfe_u32 v52, v0, 4, 1
	v_lshl_add_u32 v53, v23, 2, v50
	s_cmp_eq_u32 s93, 0
	s_cbranch_scc1 L_tyA_7
	s_and_b32 s40, s24, 1
	s_lshl_b32 s40, s40, 6
	s_lshr_b32 s41, s24, 1
	s_lshl_b32 s41, s41, 1
	v_lshrrev_b32 v25, 3, v0
	v_add_u32 v25, s40, v25
	v_mul_lo_u32 v25, v25, s82
	v_or_b32 v26, s41, v52
	v_lshlrev_b32 v26, 1, v26
	v_and_b32 v27, 7, v0
	v_xor_b32 v27, v27, v26
	v_lshl_add_u32 v40, v27, 4, v25
	s_lshl_b32 s86, s82, 3
	v_lshrrev_b32 v25, 1, v50
	v_lshl_or_b32 v25, v52, 1, v25
	v_xor_b32 v25, s24, v25
	v_lshlrev_b32 v25, 5, v25
	v_lshl_add_u32 v25, v53, 7, v25
	v_lshl_add_u32 v25, v52, 14, v25
	v_add_u32 v25, v25, v51
	v_add_u32 v109, 98304, v25
	s_branch L_tyJ_8
L_tyA_7:
	s_lshl_b32 s40, s24, 5
	v_lshrrev_b32 v26, 4, v0
	v_add_u32 v25, s40, v26
	v_mul_lo_u32 v25, v25, s82
	v_lshlrev_b32 v26, 2, v26
	v_and_b32 v27, 15, v0
	v_xor_b32 v27, v27, v26
	v_lshl_add_u32 v40, v27, 4, v25
	s_lshl_b32 s86, s82, 2
	v_xor_b32 v25, s24, v50
	v_lshlrev_b32 v25, 6, v25
	v_lshl_add_u32 v25, v53, 8, v25
	v_lshl_add_u32 v25, v52, 5, v25
	v_add_u32 v25, v25, v51
	v_add_u32 v109, 98304, v25
L_tyJ_8:
	s_lshl_b32 s87, s24, 13
	v_add_u32 v41, s86, v40
	v_add_u32 v42, s86, v41
	v_add_u32 v43, s86, v42
	v_add_u32 v44, s86, v43
	v_add_u32 v45, s86, v44
	v_add_u32 v46, s86, v45
	v_add_u32 v47, s86, v46
	s_waitcnt vmcnt(2)
	v_readfirstlane_b32 s51, v250
	s_and_b32 s51, s51, -16
	s_add_u32 s51, s51, 16
	s_waitcnt vmcnt(1)
	v_lshlrev_b32 v24, 16, v32
	v_and_b32 v25, 0xffff0000, v32
	v_add_f32 v26, v24, v25
	v_mul_f32 v27, v24, v24
	v_fmac_f32 v27, v25, v25
	v_lshlrev_b32 v24, 16, v33
	v_and_b32 v25, 0xffff0000, v33
	v_add_f32 v26, v26, v24
	v_fmac_f32 v27, v24, v24
	v_add_f32 v26, v26, v25
	v_fmac_f32 v27, v25, v25
	v_lshlrev_b32 v24, 16, v34
	v_and_b32 v25, 0xffff0000, v34
	v_add_f32 v26, v26, v24
	v_fmac_f32 v27, v24, v24
	v_add_f32 v26, v26, v25
	v_fmac_f32 v27, v25, v25
	v_lshlrev_b32 v24, 16, v35
	v_and_b32 v25, 0xffff0000, v35
	v_add_f32 v26, v26, v24
	v_fmac_f32 v27, v24, v24
	v_add_f32 v26, v26, v25
	v_fmac_f32 v27, v25, v25
	s_waitcnt vmcnt(0)
	v_lshlrev_b32 v24, 16, v36
	v_and_b32 v25, 0xffff0000, v36
	v_add_f32 v26, v26, v24
	v_fmac_f32 v27, v24, v24
	v_add_f32 v26, v26, v25
	v_fmac_f32 v27, v25, v25
	v_lshlrev_b32 v24, 16, v37
	v_and_b32 v25, 0xffff0000, v37
	v_add_f32 v26, v26, v24
	v_fmac_f32 v27, v24, v24
	v_add_f32 v26, v26, v25
	v_fmac_f32 v27, v25, v25
	v_lshlrev_b32 v24, 16, v38
	v_and_b32 v25, 0xffff0000, v38
	v_add_f32 v26, v26, v24
	v_fmac_f32 v27, v24, v24
	v_add_f32 v26, v26, v25
	v_fmac_f32 v27, v25, v25
	v_lshlrev_b32 v24, 16, v39
	v_and_b32 v25, 0xffff0000, v39
	v_add_f32 v26, v26, v24
	v_fmac_f32 v27, v24, v24
	v_add_f32 v26, v26, v25
	v_fmac_f32 v27, v25, v25
	s_nop 1
	v_permlane32_swap_b32 v26, v27
	v_permlane32_swap_b32 v32, v34
	v_permlane32_swap_b32 v33, v35
	v_permlane32_swap_b32 v36, v38
	v_permlane32_swap_b32 v37, v39
	v_add_f32 v26, v26, v27
	s_mul_i32 s46, s22, 2359296
	s_lshl_b32 s47, s24, 15
	s_add_u32 s46, s46, s47
	s_lshl_b32 s47, s23, 11
	s_add_u32 s46, s46, s47
	s_add_u32 s46, s46, 9437184
	s_add_u32 s36, s20, s46
	s_addc_u32 s37, s21, 0
	s_mul_i32 s46, s22, 2359296
	s_lshl_b32 s47, s24, 12
	s_add_u32 s46, s46, s47
	s_lshl_b32 s47, s23, 8
	s_add_u32 s46, s46, s47
	s_add_u32 s46, s46, 9961472
	s_add_u32 s38, s20, s46
	s_addc_u32 s39, s21, 0
	global_store_dwordx4 v2, v[32:35], s[36:37] sc1
	global_store_dwordx4 v2, v[36:39], s[36:37] offset:1024 sc1
	global_store_dword v1, v26, s[38:39] sc1
	s_cmp_eq_u32 s95, 1
	s_cbranch_scc1 L_alt_9
	s_add_u32 m0, s87, 98304
	s_nop 0
	global_load_lds_dwordx4 v40, s[96:97]
	s_add_u32 m0, s87, 99328
	s_nop 0
	global_load_lds_dwordx4 v41, s[96:97]
	s_add_u32 m0, s87, 100352
	s_nop 0
	global_load_lds_dwordx4 v42, s[96:97]
	s_add_u32 m0, s87, 101376
	s_nop 0
	global_load_lds_dwordx4 v43, s[96:97]
	s_add_u32 m0, s87, 102400
	s_nop 0
	global_load_lds_dwordx4 v44, s[96:97]
	s_add_u32 m0, s87, 103424
	s_nop 0
	global_load_lds_dwordx4 v45, s[96:97]
	s_add_u32 m0, s87, 104448
	s_nop 0
	global_load_lds_dwordx4 v46, s[96:97]
	s_add_u32 m0, s87, 105472
	s_nop 0
	global_load_lds_dwordx4 v47, s[96:97]
	s_branch L_join_10
L_alt_9:
	global_load_dword v31, v1, s[4:5]
	global_load_dword v31, v1, s[4:5]
	global_load_dword v31, v1, s[4:5]
	global_load_dword v31, v1, s[4:5]
	global_load_dword v31, v1, s[4:5]
	global_load_dword v31, v1, s[4:5]
	global_load_dword v31, v1, s[4:5]
	global_load_dword v31, v1, s[4:5]
L_join_10:
	v_lshrrev_b32 v56, 2, v0
	v_mul_u32_u24 v56, 3072, v56
	v_and_b32 v57, 3, v0
	v_lshl_add_u32 v56, v57, 4, v56
	v_add_u32 v57, 1024, v56
	s_lshl_b32 s46, s23, 6
	s_mul_i32 s47, s24, 393216
	s_add_u32 s46, s46, s47
	s_add_u32 s58, s6, s46
	s_addc_u32 s59, s7, 0
	s_lshl_b32 s67, s24, 13
	s_add_u32 m0, s67, 0
	s_nop 0
	global_load_lds_dwordx4 v57, s[58:59] offset:0
	s_lshl_b32 s46, s22, 8
	s_lshl_b32 s47, s23, 4
	s_add_u32 s46, s46, s47
	s_lshl_b32 s47, s24, 2
	s_add_u32 s46, s46, s47
	s_add_u32 s46, s46, 4096
	s_add_u32 s36, s20, s46
	s_addc_u32 s37, s21, 0
	s_or_b32 s40, s51, s50
	s_waitcnt vmcnt(9)
	v_mov_b32 v28, s40
	v_mov_b32 v29, 0
	s_mov_b64 exec, 1
	global_store_dword v29, v28, s[36:37] sc1
	s_mov_b64 exec, -1
	s_lshl_b32 s46, s22, 8
	s_add_u32 s46, s46, 12288
	s_add_u32 s32, s20, s46
	s_addc_u32 s33, s21, 0
	v_lshrrev_b32 v30, 1, v0
	v_and_b32 v30, 7, v30
	v_lshlrev_b32 v30, 12, v30
	s_waitcnt vmcnt(2)
	v_and_b32 v31, 1, v0
	v_lshl_add_u32 v30, v31, 7, v30
	global_load_dword v31, v30, s[32:33] sc1
	s_add_u32 m0, s67, 31744
	s_nop 0
	global_load_lds_dwordx4 v57, s[58:59] offset:1024
	s_add_u32 m0, s67, 65536
	s_nop 0
	global_load_lds_dwordx4 v56, s[58:59] offset:0
	s_add_u32 s58, s58, 49152
	s_addc_u32 s59, s59, 0
	s_add_u32 m0, s67, 1024
	s_nop 0
	global_load_lds_dwordx4 v57, s[58:59] offset:0
	s_add_u32 m0, s67, 32768
	s_nop 0
	global_load_lds_dwordx4 v57, s[58:59] offset:1024
	s_add_u32 m0, s67, 66560
	s_nop 0
	global_load_lds_dwordx4 v56, s[58:59] offset:0
	s_add_u32 s58, s58, 49152
	s_addc_u32 s59, s59, 0
	s_add_u32 m0, s67, 2048
	s_nop 0
	global_load_lds_dwordx4 v57, s[58:59] offset:0
	s_add_u32 m0, s67, 33792
	s_nop 0
	global_load_lds_dwordx4 v57, s[58:59] offset:1024
	s_add_u32 m0, s67, 67584
	s_nop 0
	global_load_lds_dwordx4 v56, s[58:59] offset:0
	s_add_u32 s58, s58, 49152
	s_addc_u32 s59, s59, 0
	s_add_u32 m0, s67, 3072
	s_nop 0
	global_load_lds_dwordx4 v57, s[58:59] offset:0
	s_add_u32 m0, s67, 34816
	s_nop 0
	global_load_lds_dwordx4 v57, s[58:59] offset:1024
	s_add_u32 m0, s67, 68608
	s_nop 0
	global_load_lds_dwordx4 v56, s[58:59] offset:0
	s_add_u32 s58, s58, 49152
	s_addc_u32 s59, s59, 0
	s_add_u32 m0, s67, 4096
	s_nop 0
	global_load_lds_dwordx4 v57, s[58:59] offset:0
	s_add_u32 m0, s67, 35840
	s_nop 0
	global_load_lds_dwordx4 v57, s[58:59] offset:1024
	s_add_u32 m0, s67, 69632
	s_nop 0
	global_load_lds_dwordx4 v56, s[58:59] offset:0
	s_add_u32 s58, s58, 49152
	s_addc_u32 s59, s59, 0
	s_add_u32 m0, s67, 5120
	s_nop 0
	global_load_lds_dwordx4 v57, s[58:59] offset:0
	s_add_u32 m0, s67, 36864
	s_nop 0
	global_load_lds_dwordx4 v57, s[58:59] offset:1024
	s_add_u32 m0, s67, 70656
	s_nop 0
	global_load_lds_dwordx4 v56, s[58:59] offset:0
	s_add_u32 s58, s58, 49152
	s_addc_u32 s59, s59, 0
	s_add_u32 m0, s67, 6144
	s_nop 0
	global_load_lds_dwordx4 v57, s[58:59] offset:0
	s_add_u32 m0, s67, 37888
	s_nop 0
	global_load_lds_dwordx4 v57, s[58:59] offset:1024
	s_add_u32 m0, s67, 71680
	s_nop 0
	global_load_lds_dwordx4 v56, s[58:59] offset:0
	s_add_u32 s58, s58, 49152
	s_addc_u32 s59, s59, 0
	s_add_u32 m0, s67, 7168
	s_nop 0
	global_load_lds_dwordx4 v57, s[58:59] offset:0
	s_add_u32 m0, s67, 38912
	s_nop 0
	global_load_lds_dwordx4 v57, s[58:59] offset:1024
	s_add_u32 m0, s67, 72704
	s_nop 0
	global_load_lds_dwordx4 v56, s[58:59] offset:0
	s_xor_b32 s40, s29, 0
	s_mul_i32 s46, s40, 114688
	s_mul_i32 s47, s24, 28672
	s_add_u32 s46, s46, s47
	s_add_u32 s46, s46, 6815744
	s_add_u32 s72, s20, s46
	s_addc_u32 s73, s21, 0
	s_lshl_b32 s46, s40, 15
	s_lshl_b32 s47, s24, 13
	s_add_u32 s46, s46, s47
	s_add_u32 s46, s46, 2621440
	s_add_u32 s76, s20, s46
	s_addc_u32 s77, s21, 0
	s_xor_b32 s40, s29, 1
	s_mul_i32 s46, s40, 114688
	s_mul_i32 s47, s24, 28672
	s_add_u32 s46, s46, s47
	s_add_u32 s46, s46, 6815744
	s_add_u32 s74, s20, s46
	s_addc_u32 s75, s21, 0
	s_lshl_b32 s46, s40, 15
	s_lshl_b32 s47, s24, 13
	s_add_u32 s46, s46, s47
	s_add_u32 s46, s46, 2621440
	s_add_u32 s78, s20, s46
	s_addc_u32 s79, s21, 0
	v_and_b32 v20, 31, v0
	v_lshrrev_b32 v21, 5, v0
	v_mov_b32 v105, 0xf149f2ca
	v_lshlrev_b32 v22, 2, v21
	v_sub_u32 v22, v20, v22
	v_bfe_u32 v106, v0, 2, 2
	v_lshl_add_u32 v106, v21, 2, v106
	v_lshlrev_b32 v106, 6, v106
	v_bfe_u32 v107, v0, 4, 1
	v_lshl_add_u32 v106, v107, 5, v106
	v_and_b32 v107, 3, v0
	v_lshl_add_u32 v106, v107, 3, v106
	v_add_u32 v107, 65536, v106
	s_cmp_ge_u32 s22, 1
	s_cselect_b32 s40, 0, 0xf149f2ca
	v_cmp_gt_i32 vcc, 0, v22
	s_nop 1
	v_cndmask_b32 v208, 0, v105, vcc
	v_mov_b32 v224, s40
	v_sub_f32 v240, v105, v208
	v_cmp_gt_i32 vcc, 1, v22
	s_nop 1
	v_cndmask_b32 v209, 0, v105, vcc
	v_mov_b32 v225, s40
	v_sub_f32 v241, v105, v209
	v_cmp_gt_i32 vcc, 2, v22
	s_nop 1
	v_cndmask_b32 v210, 0, v105, vcc
	v_mov_b32 v226, s40
	v_sub_f32 v242, v105, v210
	v_cmp_gt_i32 vcc, 3, v22
	s_nop 1
	v_cndmask_b32 v211, 0, v105, vcc
	v_mov_b32 v227, s40
	v_sub_f32 v243, v105, v211
	v_cmp_gt_i32 vcc, 8, v22
	s_nop 1
	v_cndmask_b32 v212, 0, v105, vcc
	v_mov_b32 v228, s40
	v_sub_f32 v244, v105, v212
	v_cmp_gt_i32 vcc, 9, v22
	s_nop 1
	v_cndmask_b32 v213, 0, v105, vcc
	v_mov_b32 v229, s40
	v_sub_f32 v245, v105, v213
	v_cmp_gt_i32 vcc, 10, v22
	s_nop 1
	v_cndmask_b32 v214, 0, v105, vcc
	v_mov_b32 v230, s40
	v_sub_f32 v246, v105, v214
	v_cmp_gt_i32 vcc, 11, v22
	s_nop 1
	v_cndmask_b32 v215, 0, v105, vcc
	v_mov_b32 v231, s40
	v_sub_f32 v247, v105, v215
	v_cmp_gt_i32 vcc, 16, v22
	s_nop 1
	v_cndmask_b32 v216, 0, v105, vcc
	v_mov_b32 v232, s40
	v_sub_f32 v248, v105, v216
	v_cmp_gt_i32 vcc, 17, v22
	s_nop 1
	v_cndmask_b32 v217, 0, v105, vcc
	v_mov_b32 v233, s40
	v_sub_f32 v249, v105, v217
	v_cmp_gt_i32 vcc, 18, v22
	s_nop 1
	v_cndmask_b32 v218, 0, v105, vcc
	v_mov_b32 v234, s40
	v_sub_f32 v250, v105, v218
	v_cmp_gt_i32 vcc, 19, v22
	s_nop 1
	v_cndmask_b32 v219, 0, v105, vcc
	v_mov_b32 v235, s40
	v_sub_f32 v251, v105, v219
	v_cmp_gt_i32 vcc, 24, v22
	s_nop 1
	v_cndmask_b32 v220, 0, v105, vcc
	v_mov_b32 v236, s40
	v_sub_f32 v252, v105, v220
	v_cmp_gt_i32 vcc, 25, v22
	s_nop 1
	v_cndmask_b32 v221, 0, v105, vcc
	v_mov_b32 v237, s40
	v_sub_f32 v253, v105, v221
	v_cmp_gt_i32 vcc, 26, v22
	s_nop 1
	v_cndmask_b32 v222, 0, v105, vcc
	v_mov_b32 v238, s40
	v_sub_f32 v254, v105, v222
	v_cmp_gt_i32 vcc, 27, v22
	s_nop 1
	v_cndmask_b32 v223, 0, v105, vcc
	v_mov_b32 v239, s40
	v_sub_f32 v255, v105, v223
	s_cmp_ge_u32 s22, 2
	s_cbranch_scc1 L_oldok_11
	v_mov_b32 v240, v105
	v_mov_b32 v241, v105
	v_mov_b32 v242, v105
	v_mov_b32 v243, v105
	v_mov_b32 v244, v105
	v_mov_b32 v245, v105
	v_mov_b32 v246, v105
	v_mov_b32 v247, v105
	v_mov_b32 v248, v105
	v_mov_b32 v249, v105
	v_mov_b32 v250, v105
	v_mov_b32 v251, v105
	v_mov_b32 v252, v105
	v_mov_b32 v253, v105
	v_mov_b32 v254, v105
	v_mov_b32 v255, v105
L_oldok_11:
	v_mov_b32 v24, 0x3f803f80
	v_mov_b32 v25, 0x3f803f80
	v_mov_b32 v26, 0x3f803f80
	v_mov_b32 v27, 0x3f803f80
	v_add_u32 v23, 147456, v2
	ds_write_b128 v23, v[24:27]
	ds_write_b128 v23, v[24:27] offset:1024
	s_and_b32 s63, s24, 1
	s_lshr_b32 s60, s24, 1
	s_sub_u32 s61, 3, s60
	s_lshl_b32 s40, s63, 10
	s_add_u32 s40, s40, 98304
	v_add_u32 v104, s40, v2
	v_and_b32 v30, 15, v20
	v_subrev_u32 v30, 4, v30
	v_cmp_gt_u32 vcc, 8, v30
	v_mov_b32 v28, 64
	s_nop 0
	v_cndmask_b32 v28, 0, v28, vcc
	v_add_u32 v28, 147456, v28
	s_lshl_b32 s40, s63, 8
	s_add_u32 s40, s40, 100352
	v_add_u32 v29, s40, v2
	v_mov_b32 v30, 4096
	v_cmp_gt_u32 vcc, 16, v20
	s_nop 1
	v_cndmask_b32 v174, v28, v29, vcc
	v_cndmask_b32 v175, 0, v30, vcc
	s_mul_i32 s46, s23, 229376
	s_mul_i32 s47, s24, 7168
	s_add_u32 s46, s46, s47
	s_add_u32 s46, s46, 3145728
	s_add_u32 s64, s20, s46
	s_addc_u32 s65, s21, 0
	s_mul_i32 s66, s24, 7168
	s_mul_i32 s46, s22, 2359296
	s_lshl_b32 s47, s24, 15
	s_add_u32 s46, s46, s47
	s_add_u32 s46, s46, 9437184
	s_add_u32 s30, s20, s46
	s_addc_u32 s31, s21, 0
	s_waitcnt vmcnt(0)
	s_barrier
	s_cmp_eq_u32 s93, 0
	s_cbranch_scc1 L_alt_12
	ds_read_b64_tr_b16 v[64:65], v109 offset:0
	ds_read_b64_tr_b16 v[66:67], v109 offset:1024
	ds_read_b64_tr_b16 v[68:69], v109 offset:2048
	ds_read_b64_tr_b16 v[70:71], v109 offset:3072
	ds_read_b64_tr_b16 v[72:73], v109 offset:4096
	ds_read_b64_tr_b16 v[74:75], v109 offset:5120
	ds_read_b64_tr_b16 v[76:77], v109 offset:6144
	ds_read_b64_tr_b16 v[78:79], v109 offset:7168
	ds_read_b64_tr_b16 v[192:193], v109 offset:8192
	ds_read_b64_tr_b16 v[194:195], v109 offset:9216
	ds_read_b64_tr_b16 v[196:197], v109 offset:10240
	ds_read_b64_tr_b16 v[198:199], v109 offset:11264
	ds_read_b64_tr_b16 v[200:201], v109 offset:12288
	ds_read_b64_tr_b16 v[202:203], v109 offset:13312
	ds_read_b64_tr_b16 v[204:205], v109 offset:14336
	ds_read_b64_tr_b16 v[206:207], v109 offset:15360
	s_branch L_join_13
L_alt_12:
	ds_read_b64_tr_b16 v[64:65], v109 offset:0
	ds_read_b64_tr_b16 v[66:67], v109 offset:2048
	ds_read_b64_tr_b16 v[68:69], v109 offset:4096
	ds_read_b64_tr_b16 v[70:71], v109 offset:6144
	ds_read_b64_tr_b16 v[72:73], v109 offset:8192
	ds_read_b64_tr_b16 v[74:75], v109 offset:10240
	ds_read_b64_tr_b16 v[76:77], v109 offset:12288
	ds_read_b64_tr_b16 v[78:79], v109 offset:14336
	ds_read_b64_tr_b16 v[192:193], v109 offset:16384
	ds_read_b64_tr_b16 v[194:195], v109 offset:18432
	ds_read_b64_tr_b16 v[196:197], v109 offset:20480
	ds_read_b64_tr_b16 v[198:199], v109 offset:22528
	ds_read_b64_tr_b16 v[200:201], v109 offset:24576
	ds_read_b64_tr_b16 v[202:203], v109 offset:26624
	ds_read_b64_tr_b16 v[204:205], v109 offset:28672
	ds_read_b64_tr_b16 v[206:207], v109 offset:30720
L_join_13:
	s_lshl_b32 s46, s22, 8
	s_add_u32 s46, s46, 4096
	s_add_u32 s38, s20, s46
	s_addc_u32 s39, s21, 0
	s_mov_b32 s49, 0
	s_nop 1
L_poll_14:
	global_load_dword v28, v1, s[38:39] sc1
	s_waitcnt vmcnt(0)
	v_and_b32 v29, -16, v28
	v_cmp_ne_u32 vcc, s51, v29
	s_nop 4
	s_cbranch_vccz L_pollout_15
	s_add_u32 s49, s49, 1
	s_cmp_ge_u32 s49, s26
	s_cbranch_scc0 L_poll_14
	s_mov_b32 s26, 1
L_pollout_15:
	s_or_b32 s40, s51, s50
	v_cmp_ne_u32 vcc, s40, v28
	s_cmp_eq_u64 vcc, 0
	s_cselect_b32 s25, 1, 0
	s_mul_i32 s46, s22, 2359296
	s_lshl_b32 s47, s24, 12
	s_add_u32 s46, s46, s47
	s_add_u32 s46, s46, 9961472
	s_add_u32 s32, s20, s46
	s_addc_u32 s33, s21, 0
	global_load_dwordx4 a[0:3], v2, s[30:31] offset:0
	global_load_dwordx4 a[4:7], v2, s[30:31] offset:1024
	global_load_dwordx4 a[8:11], v2, s[30:31] offset:2048
	global_load_dwordx4 a[12:15], v2, s[30:31] offset:3072
	global_load_dword v112, v1, s[32:33] offset:0
	global_load_dword v113, v1, s[32:33] offset:256
	global_load_dword v114, v1, s[32:33] offset:512
	global_load_dword v115, v1, s[32:33] offset:768
	s_min_u32 s40, s24, 2
	s_lshl_b32 s41, s40, 15
	v_add_u32 v28, s41, v106
	ds_read_b64_tr_b16 v[80:81], v28 offset:0
	ds_read_b64_tr_b16 v[82:83], v28 offset:512
	ds_read_b64_tr_b16 v[84:85], v28 offset:1024
	ds_read_b64_tr_b16 v[86:87], v28 offset:1536
	ds_read_b64_tr_b16 v[88:89], v28 offset:2048
	ds_read_b64_tr_b16 v[90:91], v28 offset:2560
	ds_read_b64_tr_b16 v[92:93], v28 offset:3072
	ds_read_b64_tr_b16 v[94:95], v28 offset:3584
	ds_read_b64_tr_b16 v[96:97], v28 offset:4096
	ds_read_b64_tr_b16 v[98:99], v28 offset:4608
	s_waitcnt lgkmcnt(8)
	v_mfma_f32_32x32x16_bf16 v[32:47], v[24:27], v[80:83], 0
	global_load_dword v116, v1, s[32:33] offset:1024
	ds_read_b64_tr_b16 v[80:81], v28 offset:5120
	ds_read_b64_tr_b16 v[82:83], v28 offset:5632
	s_waitcnt lgkmcnt(8)
	v_mfma_f32_32x32x16_bf16 v[48:63], v[24:27], v[84:87], 0
	global_load_dword v117, v1, s[32:33] offset:1280
	global_load_dword v118, v1, s[32:33] offset:1536
	ds_read_b64_tr_b16 v[84:85], v28 offset:6144
	ds_read_b64_tr_b16 v[86:87], v28 offset:6656
	s_waitcnt lgkmcnt(8)
	v_mfma_f32_32x32x16_bf16 v[32:47], v[24:27], v[88:91], v[32:47]
	global_load_dword v119, v1, s[32:33] offset:1792
	ds_read_b64_tr_b16 v[88:89], v28 offset:7168
	ds_read_b64_tr_b16 v[90:91], v28 offset:7680
	s_waitcnt lgkmcnt(8)
	v_mfma_f32_32x32x16_bf16 v[48:63], v[24:27], v[92:95], v[48:63]
	global_load_dword v120, v1, s[32:33] offset:2048
	global_load_dword v121, v1, s[32:33] offset:2304
	ds_read_b64_tr_b16 v[92:93], v28 offset:8192
	ds_read_b64_tr_b16 v[94:95], v28 offset:8704
	s_waitcnt lgkmcnt(8)
	v_mfma_f32_32x32x16_bf16 v[32:47], v[24:27], v[96:99], v[32:47]
	global_load_dword v122, v1, s[32:33] offset:2560
	ds_read_b64_tr_b16 v[96:97], v28 offset:9216
	ds_read_b64_tr_b16 v[98:99], v28 offset:9728
	s_waitcnt lgkmcnt(8)
	v_mfma_f32_32x32x16_bf16 v[48:63], v[24:27], v[80:83], v[48:63]
	global_load_dword v123, v1, s[32:33] offset:2816
	global_load_dword v124, v1, s[32:33] offset:3072
	ds_read_b64_tr_b16 v[80:81], v28 offset:10240
	ds_read_b64_tr_b16 v[82:83], v28 offset:10752
	s_waitcnt lgkmcnt(8)
	v_mfma_f32_32x32x16_bf16 v[32:47], v[24:27], v[84:87], v[32:47]
	global_load_dword v125, v1, s[32:33] offset:3328
	ds_read_b64_tr_b16 v[84:85], v28 offset:11264
	ds_read_b64_tr_b16 v[86:87], v28 offset:11776
	s_waitcnt lgkmcnt(8)
	v_mfma_f32_32x32x16_bf16 v[48:63], v[24:27], v[88:91], v[48:63]
	global_load_dword v126, v1, s[32:33] offset:3584
	global_load_dword v127, v1, s[32:33] offset:3840
	ds_read_b64_tr_b16 v[88:89], v28 offset:12288
	ds_read_b64_tr_b16 v[90:91], v28 offset:12800
	s_waitcnt lgkmcnt(8)
	v_mfma_f32_32x32x16_bf16 v[32:47], v[24:27], v[92:95], v[32:47]
	global_load_dwordx4 a[16:19], v3, s[30:31] offset:0
	ds_read_b64_tr_b16 v[92:93], v28 offset:13312
	ds_read_b64_tr_b16 v[94:95], v28 offset:13824
	s_waitcnt lgkmcnt(8)
	v_mfma_f32_32x32x16_bf16 v[48:63], v[24:27], v[96:99], v[48:63]
	global_load_dwordx4 a[20:23], v3, s[30:31] offset:1024
	global_load_dwordx4 a[24:27], v3, s[30:31] offset:2048
	ds_read_b64_tr_b16 v[96:97], v28 offset:14336
	ds_read_b64_tr_b16 v[98:99], v28 offset:14848
	s_waitcnt lgkmcnt(8)
	v_mfma_f32_32x32x16_bf16 v[32:47], v[24:27], v[80:83], v[32:47]
	global_load_dwordx4 a[28:31], v3, s[30:31] offset:3072
	ds_read_b64_tr_b16 v[80:81], v28 offset:15360
	ds_read_b64_tr_b16 v[82:83], v28 offset:15872
	s_waitcnt lgkmcnt(8)
	v_mfma_f32_32x32x16_bf16 v[48:63], v[24:27], v[84:87], v[48:63]
	global_load_dwordx4 a[32:35], v4, s[30:31] offset:0
	global_load_dwordx4 a[36:39], v4, s[30:31] offset:1024
	ds_read_b64_tr_b16 v[84:85], v28 offset:16384
	ds_read_b64_tr_b16 v[86:87], v28 offset:16896
	s_waitcnt lgkmcnt(8)
	v_mfma_f32_32x32x16_bf16 v[32:47], v[24:27], v[88:91], v[32:47]
	global_load_dwordx4 a[40:43], v4, s[30:31] offset:2048
	ds_read_b64_tr_b16 v[88:89], v28 offset:17408
	ds_read_b64_tr_b16 v[90:91], v28 offset:17920
	s_waitcnt lgkmcnt(8)
	v_mfma_f32_32x32x16_bf16 v[48:63], v[24:27], v[92:95], v[48:63]
	global_load_dwordx4 a[44:47], v4, s[30:31] offset:3072
	global_load_dwordx4 a[48:51], v5, s[30:31] offset:0
	ds_read_b64_tr_b16 v[92:93], v28 offset:18432
	ds_read_b64_tr_b16 v[94:95], v28 offset:18944
	s_waitcnt lgkmcnt(8)
	v_mfma_f32_32x32x16_bf16 v[32:47], v[24:27], v[96:99], v[32:47]
	global_load_dwordx4 a[52:55], v5, s[30:31] offset:1024
	ds_read_b64_tr_b16 v[96:97], v28 offset:19456
	ds_read_b64_tr_b16 v[98:99], v28 offset:19968
	s_waitcnt lgkmcnt(8)
	v_mfma_f32_32x32x16_bf16 v[48:63], v[24:27], v[80:83], v[48:63]
	global_load_dwordx4 a[56:59], v5, s[30:31] offset:2048
	global_load_dwordx4 a[60:63], v5, s[30:31] offset:3072
	ds_read_b64_tr_b16 v[80:81], v28 offset:20480
	ds_read_b64_tr_b16 v[82:83], v28 offset:20992
	s_waitcnt lgkmcnt(8)
	v_mfma_f32_32x32x16_bf16 v[32:47], v[24:27], v[84:87], v[32:47]
	global_load_dwordx4 a[64:67], v6, s[30:31] offset:0
	ds_read_b64_tr_b16 v[84:85], v28 offset:21504
	ds_read_b64_tr_b16 v[86:87], v28 offset:22016
	s_waitcnt lgkmcnt(8)
	v_mfma_f32_32x32x16_bf16 v[48:63], v[24:27], v[88:91], v[48:63]
	global_load_dwordx4 a[68:71], v6, s[30:31] offset:1024
	global_load_dwordx4 a[72:75], v6, s[30:31] offset:2048
	ds_read_b64_tr_b16 v[88:89], v28 offset:22528
	ds_read_b64_tr_b16 v[90:91], v28 offset:23040
	s_waitcnt lgkmcnt(8)
	v_mfma_f32_32x32x16_bf16 v[32:47], v[24:27], v[92:95], v[32:47]
	global_load_dwordx4 a[76:79], v6, s[30:31] offset:3072
	ds_read_b64_tr_b16 v[92:93], v28 offset:23552
	ds_read_b64_tr_b16 v[94:95], v28 offset:24064
	s_waitcnt lgkmcnt(8)
	v_mfma_f32_32x32x16_bf16 v[48:63], v[24:27], v[96:99], v[48:63]
	global_load_dwordx4 a[80:83], v7, s[30:31] offset:0
	global_load_dwordx4 a[84:87], v7, s[30:31] offset:1024
	ds_read_b64_tr_b16 v[96:97], v28 offset:24576
	ds_read_b64_tr_b16 v[98:99], v28 offset:25088
	s_waitcnt lgkmcnt(8)
	v_mfma_f32_32x32x16_bf16 v[32:47], v[24:27], v[80:83], v[32:47]
	global_load_dwordx4 a[88:91], v7, s[30:31] offset:2048
	ds_read_b64_tr_b16 v[80:81], v28 offset:25600
	ds_read_b64_tr_b16 v[82:83], v28 offset:26112
	s_waitcnt lgkmcnt(8)
	v_mfma_f32_32x32x16_bf16 v[48:63], v[24:27], v[84:87], v[48:63]
	global_load_dwordx4 a[92:95], v7, s[30:31] offset:3072
	global_load_dwordx4 a[96:99], v8, s[30:31] offset:0
	ds_read_b64_tr_b16 v[84:85], v28 offset:26624
	ds_read_b64_tr_b16 v[86:87], v28 offset:27136
	s_waitcnt lgkmcnt(8)
	v_mfma_f32_32x32x16_bf16 v[32:47], v[24:27], v[88:91], v[32:47]
	global_load_dwordx4 a[100:103], v8, s[30:31] offset:1024
	ds_read_b64_tr_b16 v[88:89], v28 offset:27648
	ds_read_b64_tr_b16 v[90:91], v28 offset:28160
	s_waitcnt lgkmcnt(8)
	v_mfma_f32_32x32x16_bf16 v[48:63], v[24:27], v[92:95], v[48:63]
	global_load_dwordx4 a[104:107], v8, s[30:31] offset:2048
	global_load_dwordx4 a[108:111], v8, s[30:31] offset:3072
	ds_read_b64_tr_b16 v[92:93], v28 offset:28672
	ds_read_b64_tr_b16 v[94:95], v28 offset:29184
	s_waitcnt lgkmcnt(8)
	v_mfma_f32_32x32x16_bf16 v[32:47], v[24:27], v[96:99], v[32:47]
	global_load_dwordx4 a[112:115], v9, s[30:31] offset:0
	ds_read_b64_tr_b16 v[96:97], v28 offset:29696
	ds_read_b64_tr_b16 v[98:99], v28 offset:30208
	s_waitcnt lgkmcnt(8)
	v_mfma_f32_32x32x16_bf16 v[48:63], v[24:27], v[80:83], v[48:63]
	global_load_dwordx4 a[116:119], v9, s[30:31] offset:1024
	global_load_dwordx4 a[120:123], v9, s[30:31] offset:2048
	ds_read_b64_tr_b16 v[80:81], v28 offset:30720
	ds_read_b64_tr_b16 v[82:83], v28 offset:31232
	s_waitcnt lgkmcnt(8)
	v_mfma_f32_32x32x16_bf16 v[32:47], v[24:27], v[84:87], v[32:47]
	global_load_dwordx4 a[124:127], v9, s[30:31] offset:3072
	ds_read_b64_tr_b16 v[84:85], v28 offset:31744
	ds_read_b64_tr_b16 v[86:87], v28 offset:32256
	s_waitcnt lgkmcnt(8)
	v_mfma_f32_32x32x16_bf16 v[48:63], v[24:27], v[88:91], v[48:63]
	s_mul_i32 s46, s22, 2359296
	s_lshl_b32 s47, s70, 15
	s_add_u32 s46, s46, s47
	s_lshl_b32 s47, s29, 11
	s_add_u32 s46, s46, s47
	s_add_u32 s46, s46, 9437184
	s_add_u32 s34, s20, s46
	s_addc_u32 s35, s21, 0
	global_load_dwordx4 v[10:13], v2, s[34:35]
	global_load_dwordx4 v[14:17], v2, s[34:35] offset:1024
	s_waitcnt lgkmcnt(6)
	v_mfma_f32_32x32x16_bf16 v[32:47], v[24:27], v[92:95], v[32:47]
	s_waitcnt lgkmcnt(4)
	v_mfma_f32_32x32x16_bf16 v[48:63], v[24:27], v[96:99], v[48:63]
	s_waitcnt lgkmcnt(2)
	v_mfma_f32_32x32x16_bf16 v[32:47], v[24:27], v[80:83], v[32:47]
	s_waitcnt lgkmcnt(0)
	v_mfma_f32_32x32x16_bf16 v[48:63], v[24:27], v[84:87], v[48:63]
	s_waitcnt lgkmcnt(0)
	s_cmp_eq_u32 s95, 1
	s_cbranch_scc1 L_alt_16
	global_store_dwordx4 v2, v[64:67], s[88:89] sc1
	s_add_u32 s88, s88, s92
	s_addc_u32 s89, s89, 0
	global_store_dwordx4 v2, v[68:71], s[88:89] sc1
	s_add_u32 s88, s88, s92
	s_addc_u32 s89, s89, 0
	global_store_dwordx4 v2, v[72:75], s[88:89] sc1
	s_add_u32 s88, s88, s92
	s_addc_u32 s89, s89, 0
	global_store_dwordx4 v2, v[76:79], s[88:89] sc1
	s_add_u32 s88, s88, s92
	s_addc_u32 s89, s89, 0
	global_store_dwordx4 v2, v[192:195], s[88:89] sc1
	s_add_u32 s88, s88, s92
	s_addc_u32 s89, s89, 0
	global_store_dwordx4 v2, v[196:199], s[88:89] sc1
	s_add_u32 s88, s88, s92
	s_addc_u32 s89, s89, 0
	global_store_dwordx4 v2, v[200:203], s[88:89] sc1
	s_add_u32 s88, s88, s92
	s_addc_u32 s89, s89, 0
	global_store_dwordx4 v2, v[204:207], s[88:89] sc1
	s_branch L_join_17
L_alt_16:
	global_load_dword v31, v1, s[4:5]
	global_load_dword v31, v1, s[4:5]
	global_load_dword v31, v1, s[4:5]
	global_load_dword v31, v1, s[4:5]
	global_load_dword v31, v1, s[4:5]
	global_load_dword v31, v1, s[4:5]
	global_load_dword v31, v1, s[4:5]
	global_load_dword v31, v1, s[4:5]
L_join_17:
	s_xor_b32 s40, s94, 1
	s_nop 1
	s_cmp_lg_u32 s40, 0
	s_cbranch_scc1 L_skip_18
	v_mfma_f32_32x32x16_bf16 v[148:163], v[24:27], v[64:67], 0
	v_mfma_f32_32x32x16_bf16 v[148:163], v[24:27], v[68:71], v[148:163]
	v_mfma_f32_32x32x16_bf16 v[148:163], v[24:27], v[72:75], v[148:163]
	v_mfma_f32_32x32x16_bf16 v[148:163], v[24:27], v[76:79], v[148:163]
	v_mfma_f32_32x32x16_bf16 v[148:163], v[24:27], v[192:195], v[148:163]
	v_mfma_f32_32x32x16_bf16 v[148:163], v[24:27], v[196:199], v[148:163]
	v_mfma_f32_32x32x16_bf16 v[148:163], v[24:27], v[200:203], v[148:163]
	v_mfma_f32_32x32x16_bf16 v[148:163], v[24:27], v[204:207], v[148:163]
	s_nop 11
	v_cvt_pk_bf16_f32 v150, v148, v148
	v_lshlrev_b32 v152, 16, v150
	v_sub_f32 v152, v148, v152
	v_cvt_pk_bf16_f32 v151, v152, v152
	v_and_b32 v153, 31, v0
	v_lshlrev_b32 v153, 3, v153
	v_and_b32 v154, 15, v0
	v_bfe_u32 v155, v0, 4, 1
	v_lshlrev_b32 v154, 4, v154
	v_lshl_add_u32 v154, v155, 3, v154
	s_cmp_eq_u32 s93, 1
	s_cselect_b64 vcc, -1, 0
	v_cndmask_b32 v153, v153, v154, vcc
	s_nop 4
	s_mov_b32 exec_hi, 0
	global_store_dwordx2 v153, v[150:151], s[90:91] sc1
	s_mov_b32 exec_hi, -1
L_skip_18:
	s_min_u32 s40, s24, 2
	v_add_f32 v32, v32, v48
	s_lshl_b32 s41, s40, 10
	s_add_u32 s41, s41, 151552
	v_add_u32 v29, s41, v2
	v_cmp_gt_u32 vcc, 32, v0
	v_cvt_pk_bf16_f32 v80, v32, v32
	v_lshlrev_b32 v81, 16, v80
	v_sub_f32 v81, v32, v81
	v_cvt_pk_bf16_f32 v81, v81, v81
	v_cndmask_b32 v80, 0, v80, vcc
	v_cndmask_b32 v81, 0, v81, vcc
	v_mov_b32 v82, 0
	v_mov_b32 v83, 0
	ds_write_b128 v29, v[80:83]
	s_waitcnt lgkmcnt(0)
	s_barrier
	v_add_u32 v29, 151552, v2
	ds_read_b128 v[176:179], v29 offset:0
	ds_read_b128 v[180:183], v29 offset:1024
	ds_read_b128 v[184:187], v29 offset:2048
	ds_read_b64_tr_b16 v[80:81], v106 offset:0
	ds_read_b64_tr_b16 v[82:83], v106 offset:512
	ds_read_b64_tr_b16 v[84:85], v106 offset:32768
	ds_read_b64_tr_b16 v[86:87], v106 offset:33280
	ds_read_b64_tr_b16 v[88:89], v106 offset:1024
	ds_read_b64_tr_b16 v[90:91], v106 offset:1536
	ds_read_b64_tr_b16 v[92:93], v106 offset:33792
	ds_read_b64_tr_b16 v[94:95], v106 offset:34304
	ds_read_b64_tr_b16 v[96:97], v106 offset:2048
	ds_read_b64_tr_b16 v[98:99], v106 offset:2560
	s_waitcnt vmcnt(57) lgkmcnt(8)
	v_mfma_f32_32x32x16_bf16 v[32:47], v[80:83], a[0:3], 0
	ds_read_b64_tr_b16 v[100:101], v106 offset:34816
	ds_read_b64_tr_b16 v[102:103], v106 offset:35328
	s_waitcnt lgkmcnt(8)
	v_mfma_f32_32x32x16_bf16 v[48:63], a[0:3], v[84:87], 0
	ds_read_b64_tr_b16 v[80:81], v106 offset:3072
	ds_read_b64_tr_b16 v[82:83], v106 offset:3584
	s_waitcnt vmcnt(56) lgkmcnt(8)
	v_mfma_f32_32x32x16_bf16 v[32:47], v[88:91], a[4:7], v[32:47]
	ds_read_b64_tr_b16 v[84:85], v106 offset:35840
	ds_read_b64_tr_b16 v[86:87], v106 offset:36352
	s_waitcnt lgkmcnt(8)
	v_mfma_f32_32x32x16_bf16 v[48:63], a[4:7], v[92:95], v[48:63]
	ds_read_b64_tr_b16 v[88:89], v106 offset:4096
	ds_read_b64_tr_b16 v[90:91], v106 offset:4608
	s_waitcnt vmcnt(55) lgkmcnt(8)
	v_mfma_f32_32x32x16_bf16 v[32:47], v[96:99], a[8:11], v[32:47]
	ds_read_b64_tr_b16 v[92:93], v106 offset:36864
	ds_read_b64_tr_b16 v[94:95], v106 offset:37376
	s_waitcnt lgkmcnt(8)
	v_mfma_f32_32x32x16_bf16 v[48:63], a[8:11], v[100:103], v[48:63]
	ds_read_b64_tr_b16 v[96:97], v106 offset:5120
	ds_read_b64_tr_b16 v[98:99], v106 offset:5632
	s_waitcnt vmcnt(54) lgkmcnt(8)
	v_mfma_f32_32x32x16_bf16 v[32:47], v[80:83], a[12:15], v[32:47]
	ds_read_b64_tr_b16 v[100:101], v106 offset:37888
	ds_read_b64_tr_b16 v[102:103], v106 offset:38400
	s_waitcnt lgkmcnt(8)
	v_mfma_f32_32x32x16_bf16 v[48:63], a[12:15], v[84:87], v[48:63]
	ds_read_b64_tr_b16 v[80:81], v106 offset:6144
	ds_read_b64_tr_b16 v[82:83], v106 offset:6656
	s_waitcnt vmcnt(37) lgkmcnt(8)
	v_mfma_f32_32x32x16_bf16 v[32:47], v[88:91], a[16:19], v[32:47]
	v_pk_add_f32 v[112:113], v[112:113], v[120:121]
	ds_read_b64_tr_b16 v[84:85], v106 offset:38912
	ds_read_b64_tr_b16 v[86:87], v106 offset:39424
	s_waitcnt lgkmcnt(8)
	v_mfma_f32_32x32x16_bf16 v[48:63], a[16:19], v[92:95], v[48:63]
	v_pk_add_f32 v[114:115], v[114:115], v[122:123]
	ds_read_b64_tr_b16 v[88:89], v106 offset:7168
	ds_read_b64_tr_b16 v[90:91], v106 offset:7680
	s_waitcnt vmcnt(36) lgkmcnt(8)
	v_mfma_f32_32x32x16_bf16 v[32:47], v[96:99], a[20:23], v[32:47]
	v_pk_add_f32 v[116:117], v[116:117], v[124:125]
	ds_read_b64_tr_b16 v[92:93], v106 offset:39936
	ds_read_b64_tr_b16 v[94:95], v106 offset:40448
	s_waitcnt lgkmcnt(8)
	v_mfma_f32_32x32x16_bf16 v[48:63], a[20:23], v[100:103], v[48:63]
	v_pk_add_f32 v[118:119], v[118:119], v[126:127]
	ds_read_b64_tr_b16 v[96:97], v106 offset:8192
	ds_read_b64_tr_b16 v[98:99], v106 offset:8704
	s_waitcnt vmcnt(35) lgkmcnt(8)
	v_mfma_f32_32x32x16_bf16 v[32:47], v[80:83], a[24:27], v[32:47]
	v_pk_add_f32 v[112:113], v[112:113], v[116:117]
	ds_read_b64_tr_b16 v[100:101], v106 offset:40960
	ds_read_b64_tr_b16 v[102:103], v106 offset:41472
	s_waitcnt lgkmcnt(8)
	v_mfma_f32_32x32x16_bf16 v[48:63], a[24:27], v[84:87], v[48:63]
	v_pk_add_f32 v[114:115], v[114:115], v[118:119]
	ds_read_b64_tr_b16 v[80:81], v106 offset:9216
	ds_read_b64_tr_b16 v[82:83], v106 offset:9728
	s_waitcnt vmcnt(34) lgkmcnt(8)
	v_mfma_f32_32x32x16_bf16 v[32:47], v[88:91], a[28:31], v[32:47]
	v_pk_add_f32 v[112:113], v[112:113], v[114:115]
	ds_read_b64_tr_b16 v[84:85], v106 offset:41984
	ds_read_b64_tr_b16 v[86:87], v106 offset:42496
	s_waitcnt lgkmcnt(8)
	v_mfma_f32_32x32x16_bf16 v[48:63], a[28:31], v[92:95], v[48:63]
	v_add_f32 v112, v112, v113
	ds_read_b64_tr_b16 v[88:89], v106 offset:10240
	ds_read_b64_tr_b16 v[90:91], v106 offset:10752
	s_waitcnt vmcnt(33) lgkmcnt(8)
	v_mfma_f32_32x32x16_bf16 v[32:47], v[96:99], a[32:35], v[32:47]
	v_mov_b32 v113, v112
	ds_read_b64_tr_b16 v[92:93], v106 offset:43008
	ds_read_b64_tr_b16 v[94:95], v106 offset:43520
	s_waitcnt lgkmcnt(8)
	v_mfma_f32_32x32x16_bf16 v[48:63], a[32:35], v[100:103], v[48:63]
	v_permlane32_swap_b32 v112, v113
	ds_read_b64_tr_b16 v[96:97], v106 offset:11264
	ds_read_b64_tr_b16 v[98:99], v106 offset:11776
	s_waitcnt vmcnt(32) lgkmcnt(8)
	v_mfma_f32_32x32x16_bf16 v[32:47], v[80:83], a[36:39], v[32:47]
	v_mul_f32 v112, 0xbb000000, v112
	ds_read_b64_tr_b16 v[100:101], v106 offset:44032
	ds_read_b64_tr_b16 v[102:103], v106 offset:44544
	s_waitcnt lgkmcnt(8)
	v_mfma_f32_32x32x16_bf16 v[48:63], a[36:39], v[84:87], v[48:63]
	v_mul_f32 v113, 0x3b000000, v113
	ds_read_b64_tr_b16 v[80:81], v106 offset:12288
	ds_read_b64_tr_b16 v[82:83], v106 offset:12800
	s_waitcnt vmcnt(31) lgkmcnt(8)
	v_mfma_f32_32x32x16_bf16 v[32:47], v[88:91], a[40:43], v[32:47]
	v_cvt_pk_bf16_f32 v114, v112, v112
	ds_read_b64_tr_b16 v[84:85], v106 offset:45056
	ds_read_b64_tr_b16 v[86:87], v106 offset:45568
	s_waitcnt lgkmcnt(8)
	v_mfma_f32_32x32x16_bf16 v[48:63], a[40:43], v[92:95], v[48:63]
	v_fma_f32 v113, -v112, v112, v113
	ds_read_b64_tr_b16 v[88:89], v106 offset:13312
	ds_read_b64_tr_b16 v[90:91], v106 offset:13824
	s_waitcnt vmcnt(30) lgkmcnt(8)
	v_mfma_f32_32x32x16_bf16 v[32:47], v[96:99], a[44:47], v[32:47]
	v_lshlrev_b32 v114, 16, v114
	ds_read_b64_tr_b16 v[92:93], v106 offset:46080
	ds_read_b64_tr_b16 v[94:95], v106 offset:46592
	s_waitcnt lgkmcnt(8)
	v_mfma_f32_32x32x16_bf16 v[48:63], a[44:47], v[100:103], v[48:63]
	v_max_f32 v113, 0, v113
	ds_read_b64_tr_b16 v[96:97], v106 offset:14336
	ds_read_b64_tr_b16 v[98:99], v106 offset:14848
	s_waitcnt vmcnt(29) lgkmcnt(8)
	v_mfma_f32_32x32x16_bf16 v[32:47], v[80:83], a[48:51], v[32:47]
	v_sub_f32 v114, v112, v114
	ds_read_b64_tr_b16 v[100:101], v106 offset:47104
	ds_read_b64_tr_b16 v[102:103], v106 offset:47616
	s_waitcnt lgkmcnt(8)
	v_mfma_f32_32x32x16_bf16 v[48:63], a[48:51], v[84:87], v[48:63]
	v_add_f32 v113, 0x3727c5ac, v113
	ds_read_b64_tr_b16 v[80:81], v106 offset:15360
	ds_read_b64_tr_b16 v[82:83], v106 offset:15872
	s_waitcnt vmcnt(28) lgkmcnt(8)
	v_mfma_f32_32x32x16_bf16 v[32:47], v[88:91], a[52:55], v[32:47]
	v_cvt_pk_bf16_f32 v188, v112, v114
	ds_read_b64_tr_b16 v[84:85], v106 offset:48128
	ds_read_b64_tr_b16 v[86:87], v106 offset:48640
	s_waitcnt lgkmcnt(8)
	v_mfma_f32_32x32x16_bf16 v[48:63], a[52:55], v[92:95], v[48:63]
	v_rsq_f32 v128, v113
	ds_read_b64_tr_b16 v[88:89], v106 offset:16384
	ds_read_b64_tr_b16 v[90:91], v106 offset:16896
	s_waitcnt vmcnt(27) lgkmcnt(8)
	v_mfma_f32_32x32x16_bf16 v[32:47], v[96:99], a[56:59], v[32:47]
	v_mov_b32 v189, v188
	ds_read_b64_tr_b16 v[92:93], v106 offset:49152
	ds_read_b64_tr_b16 v[94:95], v106 offset:49664
	s_waitcnt lgkmcnt(8)
	v_mfma_f32_32x32x16_bf16 v[48:63], a[56:59], v[100:103], v[48:63]
	v_mov_b32 v190, v188
	ds_read_b64_tr_b16 v[96:97], v106 offset:17408
	ds_read_b64_tr_b16 v[98:99], v106 offset:17920
	s_waitcnt vmcnt(26) lgkmcnt(8)
	v_mfma_f32_32x32x16_bf16 v[32:47], v[80:83], a[60:63], v[32:47]
	v_mov_b32 v191, v188
	ds_read_b64_tr_b16 v[100:101], v106 offset:50176
	ds_read_b64_tr_b16 v[102:103], v106 offset:50688
	s_waitcnt lgkmcnt(8)
	v_mfma_f32_32x32x16_bf16 v[48:63], a[60:63], v[84:87], v[48:63]
	v_mul_f32 v130, 0x3eb8aa3b, v128
	ds_read_b64_tr_b16 v[80:81], v106 offset:18432
	ds_read_b64_tr_b16 v[82:83], v106 offset:18944
	s_waitcnt vmcnt(25) lgkmcnt(8)
	v_mfma_f32_32x32x16_bf16 v[32:47], v[88:91], a[64:67], v[32:47]
	s_lshl_b32 s40, s24, 8
	s_add_u32 s40, s40, 149504
	ds_read_b64_tr_b16 v[84:85], v106 offset:51200
	ds_read_b64_tr_b16 v[86:87], v106 offset:51712
	s_waitcnt lgkmcnt(8)
	v_mfma_f32_32x32x16_bf16 v[48:63], a[64:67], v[92:95], v[48:63]
	v_add_u32 v23, s40, v1
	ds_read_b64_tr_b16 v[88:89], v106 offset:19456
	ds_read_b64_tr_b16 v[90:91], v106 offset:19968
	s_waitcnt vmcnt(24) lgkmcnt(8)
	v_mfma_f32_32x32x16_bf16 v[32:47], v[96:99], a[68:71], v[32:47]
	v_lshlrev_b32 v28, 4, v21
	ds_read_b64_tr_b16 v[92:93], v106 offset:52224
	ds_read_b64_tr_b16 v[94:95], v106 offset:52736
	s_waitcnt lgkmcnt(8)
	v_mfma_f32_32x32x16_bf16 v[48:63], a[68:71], v[100:103], v[48:63]
	ds_write_b32 v23, v128
	ds_read_b64_tr_b16 v[96:97], v106 offset:20480
	ds_read_b64_tr_b16 v[98:99], v106 offset:20992
	s_waitcnt vmcnt(23) lgkmcnt(9)
	v_mfma_f32_32x32x16_bf16 v[32:47], v[80:83], a[72:75], v[32:47]
	v_add_u32 v28, s40, v28
	ds_read_b64_tr_b16 v[100:101], v106 offset:53248
	ds_read_b64_tr_b16 v[102:103], v106 offset:53760
	s_waitcnt lgkmcnt(9)
	v_mfma_f32_32x32x16_bf16 v[48:63], a[72:75], v[84:87], v[48:63]
	ds_read_b128 v[132:135], v28 offset:0
	ds_read_b64_tr_b16 v[80:81], v106 offset:21504
	ds_read_b64_tr_b16 v[82:83], v106 offset:22016
	s_waitcnt vmcnt(22) lgkmcnt(10)
	v_mfma_f32_32x32x16_bf16 v[32:47], v[88:91], a[76:79], v[32:47]
	ds_read_b128 v[136:139], v28 offset:32
	ds_read_b64_tr_b16 v[84:85], v106 offset:54272
	ds_read_b64_tr_b16 v[86:87], v106 offset:54784
	s_waitcnt lgkmcnt(11)
	v_mfma_f32_32x32x16_bf16 v[48:63], a[76:79], v[92:95], v[48:63]
	ds_read_b128 v[140:143], v28 offset:64
	ds_read_b64_tr_b16 v[88:89], v106 offset:22528
	ds_read_b64_tr_b16 v[90:91], v106 offset:23040
	s_waitcnt vmcnt(21) lgkmcnt(11)
	v_mfma_f32_32x32x16_bf16 v[32:47], v[96:99], a[80:83], v[32:47]
	ds_read_b128 v[144:147], v28 offset:96
	ds_read_b64_tr_b16 v[92:93], v106 offset:55296
	ds_read_b64_tr_b16 v[94:95], v106 offset:55808
	s_waitcnt lgkmcnt(12)
	v_mfma_f32_32x32x16_bf16 v[48:63], a[80:83], v[100:103], v[48:63]
	ds_read_b64_tr_b16 v[96:97], v106 offset:23552
	ds_read_b64_tr_b16 v[98:99], v106 offset:24064
	s_waitcnt vmcnt(20) lgkmcnt(11)
	v_mfma_f32_32x32x16_bf16 v[32:47], v[80:83], a[84:87], v[32:47]
	ds_read_b64_tr_b16 v[100:101], v106 offset:56320
	ds_read_b64_tr_b16 v[102:103], v106 offset:56832
	s_waitcnt lgkmcnt(10)
	v_mfma_f32_32x32x16_bf16 v[48:63], a[84:87], v[84:87], v[48:63]
	ds_read_b64_tr_b16 v[80:81], v106 offset:24576
	ds_read_b64_tr_b16 v[82:83], v106 offset:25088
	s_waitcnt vmcnt(19) lgkmcnt(9)
	v_mfma_f32_32x32x16_bf16 v[32:47], v[88:91], a[88:91], v[32:47]
	ds_read_b64_tr_b16 v[84:85], v106 offset:57344
	ds_read_b64_tr_b16 v[86:87], v106 offset:57856
	s_waitcnt lgkmcnt(8)
	v_mfma_f32_32x32x16_bf16 v[48:63], a[88:91], v[92:95], v[48:63]
	ds_read_b64_tr_b16 v[88:89], v106 offset:25600
	ds_read_b64_tr_b16 v[90:91], v106 offset:26112
	s_waitcnt vmcnt(18) lgkmcnt(8)
	v_mfma_f32_32x32x16_bf16 v[32:47], v[96:99], a[92:95], v[32:47]
	ds_read_b64_tr_b16 v[92:93], v106 offset:58368
	ds_read_b64_tr_b16 v[94:95], v106 offset:58880
	s_waitcnt lgkmcnt(8)
	v_mfma_f32_32x32x16_bf16 v[48:63], a[92:95], v[100:103], v[48:63]
	ds_read_b64_tr_b16 v[96:97], v106 offset:26624
	ds_read_b64_tr_b16 v[98:99], v106 offset:27136
	s_waitcnt vmcnt(17) lgkmcnt(8)
	v_mfma_f32_32x32x16_bf16 v[32:47], v[80:83], a[96:99], v[32:47]
	ds_read_b64_tr_b16 v[100:101], v106 offset:59392
	ds_read_b64_tr_b16 v[102:103], v106 offset:59904
	s_waitcnt lgkmcnt(8)
	v_mfma_f32_32x32x16_bf16 v[48:63], a[96:99], v[84:87], v[48:63]
	ds_read_b64_tr_b16 v[80:81], v106 offset:27648
	ds_read_b64_tr_b16 v[82:83], v106 offset:28160
	s_waitcnt vmcnt(16) lgkmcnt(8)
	v_mfma_f32_32x32x16_bf16 v[32:47], v[88:91], a[100:103], v[32:47]
	ds_read_b64_tr_b16 v[84:85], v106 offset:60416
	ds_read_b64_tr_b16 v[86:87], v106 offset:60928
	s_waitcnt lgkmcnt(8)
	v_mfma_f32_32x32x16_bf16 v[48:63], a[100:103], v[92:95], v[48:63]
	ds_read_b64_tr_b16 v[88:89], v106 offset:28672
	ds_read_b64_tr_b16 v[90:91], v106 offset:29184
	s_waitcnt vmcnt(15) lgkmcnt(8)
	v_mfma_f32_32x32x16_bf16 v[32:47], v[96:99], a[104:107], v[32:47]
	ds_read_b64_tr_b16 v[92:93], v106 offset:61440
	ds_read_b64_tr_b16 v[94:95], v106 offset:61952
	s_waitcnt lgkmcnt(8)
	v_mfma_f32_32x32x16_bf16 v[48:63], a[104:107], v[100:103], v[48:63]
	ds_read_b64_tr_b16 v[96:97], v106 offset:29696
	ds_read_b64_tr_b16 v[98:99], v106 offset:30208
	s_waitcnt vmcnt(14) lgkmcnt(8)
	v_mfma_f32_32x32x16_bf16 v[32:47], v[80:83], a[108:111], v[32:47]
	ds_read_b64_tr_b16 v[100:101], v106 offset:62464
	ds_read_b64_tr_b16 v[102:103], v106 offset:62976
	s_waitcnt lgkmcnt(8)
	v_mfma_f32_32x32x16_bf16 v[48:63], a[108:111], v[84:87], v[48:63]
	ds_read_b64_tr_b16 v[80:81], v106 offset:30720
	ds_read_b64_tr_b16 v[82:83], v106 offset:31232
	s_waitcnt vmcnt(13) lgkmcnt(8)
	v_mfma_f32_32x32x16_bf16 v[32:47], v[88:91], a[112:115], v[32:47]
	ds_read_b64_tr_b16 v[84:85], v106 offset:63488
	ds_read_b64_tr_b16 v[86:87], v106 offset:64000
	s_waitcnt lgkmcnt(8)
	v_mfma_f32_32x32x16_bf16 v[48:63], a[112:115], v[92:95], v[48:63]
	ds_read_b64_tr_b16 v[88:89], v106 offset:31744
	ds_read_b64_tr_b16 v[90:91], v106 offset:32256
	s_waitcnt vmcnt(12) lgkmcnt(8)
	v_mfma_f32_32x32x16_bf16 v[32:47], v[96:99], a[116:119], v[32:47]
	ds_read_b64_tr_b16 v[92:93], v106 offset:64512
	ds_read_b64_tr_b16 v[94:95], v106 offset:65024
	s_waitcnt lgkmcnt(8)
	v_mfma_f32_32x32x16_bf16 v[48:63], a[116:119], v[100:103], v[48:63]
	s_waitcnt vmcnt(11) lgkmcnt(6)
	v_mfma_f32_32x32x16_bf16 v[32:47], v[80:83], a[120:123], v[32:47]
	s_waitcnt lgkmcnt(4)
	v_mfma_f32_32x32x16_bf16 v[48:63], a[120:123], v[84:87], v[48:63]
	s_waitcnt vmcnt(10) lgkmcnt(2)
	v_mfma_f32_32x32x16_bf16 v[32:47], v[88:91], a[124:127], v[32:47]
	s_waitcnt lgkmcnt(0)
	v_mfma_f32_32x32x16_bf16 v[48:63], a[124:127], v[92:95], v[48:63]
	v_mfma_f32_32x32x16_bf16 v[32:47], v[176:179], v[188:191], v[32:47]
	v_mfma_f32_32x32x16_bf16 v[48:63], v[188:191], v[180:183], v[48:63]
	ds_read_b64_tr_b16 v[80:81], v107 offset:0
	ds_read_b64_tr_b16 v[82:83], v107 offset:512
	ds_read_b64_tr_b16 v[84:85], v107 offset:1024
	ds_read_b64_tr_b16 v[86:87], v107 offset:1536
	ds_read_b64_tr_b16 v[88:89], v107 offset:2048
	ds_read_b64_tr_b16 v[90:91], v107 offset:2560
	s_nop 4
	v_pk_mul_f32 v[32:33], v[32:33], v[128:129] op_sel_hi:[1,0]
	v_pk_mul_f32 v[34:35], v[34:35], v[128:129] op_sel_hi:[1,0]
	v_pk_mul_f32 v[36:37], v[36:37], v[128:129] op_sel_hi:[1,0]
	v_pk_mul_f32 v[38:39], v[38:39], v[128:129] op_sel_hi:[1,0]
	v_pk_mul_f32 v[40:41], v[40:41], v[128:129] op_sel_hi:[1,0]
	v_pk_mul_f32 v[42:43], v[42:43], v[128:129] op_sel_hi:[1,0]
	v_pk_mul_f32 v[44:45], v[44:45], v[128:129] op_sel_hi:[1,0]
	v_pk_mul_f32 v[46:47], v[46:47], v[128:129] op_sel_hi:[1,0]
	v_cvt_pk_bf16_f32 v148, v32, v33
	v_cvt_pk_bf16_f32 v149, v34, v35
	v_cvt_pk_bf16_f32 v150, v36, v37
	v_cvt_pk_bf16_f32 v151, v38, v39
	v_cvt_pk_bf16_f32 v152, v40, v41
	v_cvt_pk_bf16_f32 v153, v42, v43
	v_cvt_pk_bf16_f32 v154, v44, v45
	v_cvt_pk_bf16_f32 v155, v46, v47
	s_lshl_b32 s40, s24, 12
	s_add_u32 s40, s40, 131072
	v_add_u32 v23, s40, v2
	s_mul_i32 s46, s22, 2359296
	s_lshl_b32 s47, s24, 16
	s_add_u32 s46, s46, s47
	s_lshl_b32 s47, s23, 12
	s_add_u32 s46, s46, s47
	s_add_u32 s46, s46, 10289152
	s_add_u32 s34, s20, s46
	s_addc_u32 s35, s21, 0
	global_store_dwordx4 v2, v[148:151], s[34:35] offset:0 sc1
	ds_write_b128 v23, v[148:151] offset:0
	global_store_dwordx4 v2, v[152:155], s[34:35] offset:1024 sc1
	ds_write_b128 v23, v[152:155] offset:1024
	v_pk_mul_f32 v[48:49], v[48:49], v[132:133]
	v_pk_mul_f32 v[50:51], v[50:51], v[134:135]
	v_pk_mul_f32 v[52:53], v[52:53], v[136:137]
	v_pk_mul_f32 v[54:55], v[54:55], v[138:139]
	v_pk_mul_f32 v[56:57], v[56:57], v[140:141]
	v_pk_mul_f32 v[58:59], v[58:59], v[142:143]
	v_pk_mul_f32 v[60:61], v[60:61], v[144:145]
	v_pk_mul_f32 v[62:63], v[62:63], v[146:147]
	v_cvt_pk_bf16_f32 v156, v48, v49
	v_cvt_pk_bf16_f32 v157, v50, v51
	v_cvt_pk_bf16_f32 v158, v52, v53
	v_cvt_pk_bf16_f32 v159, v54, v55
	v_cvt_pk_bf16_f32 v160, v56, v57
	v_cvt_pk_bf16_f32 v161, v58, v59
	v_cvt_pk_bf16_f32 v162, v60, v61
	v_cvt_pk_bf16_f32 v163, v62, v63
	global_store_dwordx4 v2, v[156:159], s[34:35] offset:2048 sc1
	ds_write_b128 v23, v[156:159] offset:2048
	global_store_dwordx4 v2, v[160:163], s[34:35] offset:3072 sc1
	ds_write_b128 v23, v[160:163] offset:3072
	s_lshl_b32 s46, s23, 13
	s_lshl_b32 s47, s27, 7
	s_add_u32 s46, s46, s47
	s_add_u32 s46, s46, 50855936
	s_add_u32 s38, s20, s46
	s_addc_u32 s39, s21, 0
	ds_read_b64_tr_b16 v[92:93], v107 offset:3072
	ds_read_b64_tr_b16 v[94:95], v107 offset:3584
	s_waitcnt lgkmcnt(10)
	v_mfma_f32_32x32x16_bf16 v[64:79], v[80:83], a[0:3], 0
	s_lshl_b32 s40, s24, 1
	s_add_u32 s40, s40, 0
	s_lshl_b32 s41, s22, 2
	ds_read_b64_tr_b16 v[80:81], v107 offset:4096
	ds_read_b64_tr_b16 v[82:83], v107 offset:4608
	s_waitcnt lgkmcnt(10)
	v_mfma_f32_32x32x16_bf16 v[64:79], v[84:87], a[4:7], v[64:79]
	s_add_u32 s42, s41, s40
	s_sub_u32 s42, s42, 8
	s_and_b32 s40, s40, 3
	ds_read_b64_tr_b16 v[84:85], v107 offset:5120
	ds_read_b64_tr_b16 v[86:87], v107 offset:5632
	s_waitcnt lgkmcnt(10)
	v_mfma_f32_32x32x16_bf16 v[64:79], v[88:91], a[8:11], v[64:79]
	s_add_u32 s41, s41, s40
	s_cmp_lt_i32 s42, 0
	s_cselect_b32 s44, s41, s42
	ds_read_b64_tr_b16 v[88:89], v107 offset:6144
	ds_read_b64_tr_b16 v[90:91], v107 offset:6656
	s_waitcnt lgkmcnt(6)
	v_mfma_f32_32x32x16_bf16 v[64:79], v[92:95], a[12:15], v[64:79]
	s_lshr_b32 s41, s44, 2
	s_and_b32 s42, s44, 3
	s_mul_i32 s46, s41, 2359296
	ds_read_b64_tr_b16 v[92:93], v107 offset:7168
	ds_read_b64_tr_b16 v[94:95], v107 offset:7680
	s_waitcnt lgkmcnt(6)
	v_mfma_f32_32x32x16_bf16 v[64:79], v[80:83], a[16:19], v[64:79]
	s_lshl_b32 s47, s42, 16
	s_add_u32 s46, s46, s47
	s_lshl_b32 s47, s23, 12
	ds_read_b64_tr_b16 v[80:81], v107 offset:8192
	ds_read_b64_tr_b16 v[82:83], v107 offset:8704
	s_waitcnt lgkmcnt(6)
	v_mfma_f32_32x32x16_bf16 v[64:79], v[84:87], a[20:23], v[64:79]
	s_add_u32 s46, s46, s47
	s_add_u32 s46, s46, 10289152
	s_add_u32 s34, s20, s46
	ds_read_b64_tr_b16 v[84:85], v107 offset:9216
	ds_read_b64_tr_b16 v[86:87], v107 offset:9728
	s_waitcnt lgkmcnt(6)
	v_mfma_f32_32x32x16_bf16 v[64:79], v[88:91], a[24:27], v[64:79]
	s_addc_u32 s35, s21, 0
	s_lshl_b32 s40, s24, 1
	s_add_u32 s40, s40, 1
	ds_read_b64_tr_b16 v[88:89], v107 offset:10240
	ds_read_b64_tr_b16 v[90:91], v107 offset:10752
	s_waitcnt lgkmcnt(6)
	v_mfma_f32_32x32x16_bf16 v[64:79], v[92:95], a[28:31], v[64:79]
	s_lshl_b32 s41, s22, 2
	s_add_u32 s42, s41, s40
	s_sub_u32 s42, s42, 8
	ds_read_b64_tr_b16 v[92:93], v107 offset:11264
	ds_read_b64_tr_b16 v[94:95], v107 offset:11776
	s_waitcnt lgkmcnt(6)
	v_mfma_f32_32x32x16_bf16 v[64:79], v[80:83], a[32:35], v[64:79]
	s_and_b32 s40, s40, 3
	s_add_u32 s41, s41, s40
	s_cmp_lt_i32 s42, 0
	ds_read_b64_tr_b16 v[80:81], v107 offset:12288
	ds_read_b64_tr_b16 v[82:83], v107 offset:12800
	s_waitcnt lgkmcnt(6)
	v_mfma_f32_32x32x16_bf16 v[64:79], v[84:87], a[36:39], v[64:79]
	s_cselect_b32 s45, s41, s42
	s_lshr_b32 s41, s45, 2
	s_and_b32 s42, s45, 3
	ds_read_b64_tr_b16 v[84:85], v107 offset:13312
	ds_read_b64_tr_b16 v[86:87], v107 offset:13824
	s_waitcnt lgkmcnt(6)
	v_mfma_f32_32x32x16_bf16 v[64:79], v[88:91], a[40:43], v[64:79]
	s_mul_i32 s46, s41, 2359296
	s_lshl_b32 s47, s42, 16
	s_add_u32 s46, s46, s47
	ds_read_b64_tr_b16 v[88:89], v107 offset:14336
	ds_read_b64_tr_b16 v[90:91], v107 offset:14848
	s_waitcnt lgkmcnt(6)
	v_mfma_f32_32x32x16_bf16 v[64:79], v[92:95], a[44:47], v[64:79]
	s_lshl_b32 s47, s23, 12
	s_add_u32 s46, s46, s47
	s_add_u32 s46, s46, 10289152
	ds_read_b64_tr_b16 v[92:93], v107 offset:15360
	ds_read_b64_tr_b16 v[94:95], v107 offset:15872
	s_waitcnt lgkmcnt(6)
	v_mfma_f32_32x32x16_bf16 v[64:79], v[80:83], a[48:51], v[64:79]
	s_add_u32 s36, s20, s46
	s_addc_u32 s37, s21, 0
	s_lshl_b32 s40, s45, 7
	ds_read_b64_tr_b16 v[80:81], v107 offset:16384
	ds_read_b64_tr_b16 v[82:83], v107 offset:16896
	s_waitcnt lgkmcnt(6)
	v_mfma_f32_32x32x16_bf16 v[64:79], v[84:87], a[52:55], v[64:79]
	s_lshl_b32 s41, s44, 7
	v_mov_b32 v22, s40
	v_mov_b32 v23, s41
	ds_read_b64_tr_b16 v[84:85], v107 offset:17408
	ds_read_b64_tr_b16 v[86:87], v107 offset:17920
	s_waitcnt lgkmcnt(6)
	v_mfma_f32_32x32x16_bf16 v[64:79], v[88:91], a[56:59], v[64:79]
	v_cmp_eq_u32 vcc, 0, v0
	s_nop 1
	v_cndmask_b32 v23, v22, v23, vcc
	s_cmp_ge_u32 s22, 2
	ds_read_b64_tr_b16 v[88:89], v107 offset:18432
	ds_read_b64_tr_b16 v[90:91], v107 offset:18944
	s_waitcnt lgkmcnt(6)
	v_mfma_f32_32x32x16_bf16 v[64:79], v[92:95], a[60:63], v[64:79]
	s_cselect_b32 s40, 0, 0xf149f2ca
	v_mov_b32 v112, s40
	v_mov_b32 v113, s40
	ds_read_b64_tr_b16 v[92:93], v107 offset:19456
	ds_read_b64_tr_b16 v[94:95], v107 offset:19968
	s_waitcnt lgkmcnt(6)
	v_mfma_f32_32x32x16_bf16 v[64:79], v[80:83], a[64:67], v[64:79]
	v_mov_b32 v114, s40
	v_mov_b32 v115, s40
	v_mov_b32 v116, s40
	ds_read_b64_tr_b16 v[80:81], v107 offset:20480
	ds_read_b64_tr_b16 v[82:83], v107 offset:20992
	s_waitcnt lgkmcnt(6)
	v_mfma_f32_32x32x16_bf16 v[64:79], v[84:87], a[68:71], v[64:79]
	v_mov_b32 v117, s40
	v_mov_b32 v118, s40
	v_mov_b32 v119, s40
	ds_read_b64_tr_b16 v[84:85], v107 offset:21504
	ds_read_b64_tr_b16 v[86:87], v107 offset:22016
	s_waitcnt lgkmcnt(6)
	v_mfma_f32_32x32x16_bf16 v[64:79], v[88:91], a[72:75], v[64:79]
	v_mov_b32 v120, s40
	v_mov_b32 v121, s40
	v_mov_b32 v122, s40
	ds_read_b64_tr_b16 v[88:89], v107 offset:22528
	ds_read_b64_tr_b16 v[90:91], v107 offset:23040
	s_waitcnt lgkmcnt(6)
	v_mfma_f32_32x32x16_bf16 v[64:79], v[92:95], a[76:79], v[64:79]
	v_mov_b32 v123, s40
	v_mov_b32 v124, s40
	v_mov_b32 v125, s40
	ds_read_b64_tr_b16 v[92:93], v107 offset:23552
	ds_read_b64_tr_b16 v[94:95], v107 offset:24064
	s_waitcnt lgkmcnt(6)
	v_mfma_f32_32x32x16_bf16 v[64:79], v[80:83], a[80:83], v[64:79]
	s_waitcnt vmcnt(0)
	v_mov_b32 v28, s51
	s_mov_b32 exec_hi, 0
	global_store_dword v1, v28, s[38:39] sc1
	s_mov_b32 exec_hi, -1
	ds_read_b64_tr_b16 v[80:81], v107 offset:24576
	ds_read_b64_tr_b16 v[82:83], v107 offset:25088
	s_waitcnt lgkmcnt(6)
	v_mfma_f32_32x32x16_bf16 v[64:79], v[84:87], a[84:87], v[64:79]
	v_mov_b32 v126, s40
	v_mov_b32 v127, s40
	ds_read_b64_tr_b16 v[84:85], v107 offset:25600
	ds_read_b64_tr_b16 v[86:87], v107 offset:26112
	s_waitcnt lgkmcnt(6)
	v_mfma_f32_32x32x16_bf16 v[64:79], v[88:91], a[88:91], v[64:79]
	ds_read_b64_tr_b16 v[88:89], v107 offset:26624
	ds_read_b64_tr_b16 v[90:91], v107 offset:27136
	s_waitcnt lgkmcnt(6)
	v_mfma_f32_32x32x16_bf16 v[64:79], v[92:95], a[92:95], v[64:79]
	ds_read_b64_tr_b16 v[92:93], v107 offset:27648
	ds_read_b64_tr_b16 v[94:95], v107 offset:28160
	s_waitcnt lgkmcnt(6)
	v_mfma_f32_32x32x16_bf16 v[64:79], v[80:83], a[96:99], v[64:79]
	ds_read_b64_tr_b16 v[80:81], v107 offset:28672
	ds_read_b64_tr_b16 v[82:83], v107 offset:29184
	s_waitcnt lgkmcnt(6)
	v_mfma_f32_32x32x16_bf16 v[64:79], v[84:87], a[100:103], v[64:79]
	ds_read_b64_tr_b16 v[84:85], v107 offset:29696
	ds_read_b64_tr_b16 v[86:87], v107 offset:30208
	s_waitcnt lgkmcnt(6)
	v_mfma_f32_32x32x16_bf16 v[64:79], v[88:91], a[104:107], v[64:79]
	ds_read_b64_tr_b16 v[88:89], v107 offset:30720
	ds_read_b64_tr_b16 v[90:91], v107 offset:31232
	s_waitcnt lgkmcnt(6)
	v_mfma_f32_32x32x16_bf16 v[64:79], v[92:95], a[108:111], v[64:79]
	ds_read_b64_tr_b16 v[92:93], v107 offset:31744
	ds_read_b64_tr_b16 v[94:95], v107 offset:32256
	s_waitcnt lgkmcnt(6)
	v_mfma_f32_32x32x16_bf16 v[64:79], v[80:83], a[112:115], v[64:79]
	s_waitcnt lgkmcnt(4)
	v_mfma_f32_32x32x16_bf16 v[64:79], v[84:87], a[116:119], v[64:79]
	s_waitcnt lgkmcnt(2)
	v_mfma_f32_32x32x16_bf16 v[64:79], v[88:91], a[120:123], v[64:79]
	s_waitcnt lgkmcnt(0)
	v_mfma_f32_32x32x16_bf16 v[64:79], v[92:95], a[124:127], v[64:79]
	v_mfma_f32_32x32x16_bf16 v[64:79], v[184:187], v[188:191], v[64:79]
	s_lshl_b32 s46, s23, 13
	s_add_u32 s46, s46, 50855936
	s_add_u32 s38, s20, s46
	s_addc_u32 s39, s21, 0
	global_load_dword v108, v23, s[38:39] sc1
	s_nop 6
	v_pk_mul_f32 v[64:65], v[64:65], v[130:131] op_sel_hi:[1,0]
	v_pk_mul_f32 v[66:67], v[66:67], v[130:131] op_sel_hi:[1,0]
	v_pk_mul_f32 v[68:69], v[68:69], v[130:131] op_sel_hi:[1,0]
	v_pk_mul_f32 v[70:71], v[70:71], v[130:131] op_sel_hi:[1,0]
	v_pk_mul_f32 v[72:73], v[72:73], v[130:131] op_sel_hi:[1,0]
	v_pk_mul_f32 v[74:75], v[74:75], v[130:131] op_sel_hi:[1,0]
	v_pk_mul_f32 v[76:77], v[76:77], v[130:131] op_sel_hi:[1,0]
	v_pk_mul_f32 v[78:79], v[78:79], v[130:131] op_sel_hi:[1,0]
	v_cvt_pk_bf16_f32 v164, v64, v65
	v_cvt_pk_bf16_f32 v165, v66, v67
	v_cvt_pk_bf16_f32 v166, v68, v69
	v_cvt_pk_bf16_f32 v167, v70, v71
	v_cvt_pk_bf16_f32 v168, v72, v73
	v_cvt_pk_bf16_f32 v169, v74, v75
	v_cvt_pk_bf16_f32 v170, v76, v77
	v_cvt_pk_bf16_f32 v171, v78, v79
	s_lshl_b32 s40, s24, 11
	s_add_u32 s40, s40, 155648
	v_add_u32 v22, s40, v2
	ds_write_b128 v22, v[164:167] offset:0
	ds_write_b128 v22, v[168:171] offset:1024
	s_lshl_b32 s40, s60, 11
	s_lshl_b32 s41, s63, 10
	s_add_u32 s41, s41, 155648
	s_add_u32 s40, s40, s41
	v_add_u32 v22, s40, v2
	s_lshl_b32 s40, s61, 11
	s_add_u32 s40, s40, s41
	v_add_u32 v28, s40, v2
	s_mov_b32 s62, 0
	s_waitcnt lgkmcnt(0)
	s_barrier
	ds_read_b128 v[164:167], v22
	ds_read_b128 v[168:171], v28
	s_waitcnt lgkmcnt(0)
	s_cmp_lg_u32 s24, 0
	s_cbranch_scc1 L_skip_19
	s_lshl_b32 s46, s48, 7
	s_add_u32 s46, s46, 51380224
	s_add_u32 s32, s20, s46
	s_addc_u32 s33, s21, 0
	v_lshrrev_b32 v28, 3, v0
	v_and_b32 v29, 7, v0
	v_lshlrev_b32 v28, 15, v28
	v_lshl_add_u32 v28, v29, 4, v28
	v_add_u32 v29, 262144, v28
	v_mov_b32 v24, s51
	v_mov_b32 v25, s51
	v_mov_b32 v26, s51
	v_mov_b32 v27, s51
	s_nop 4
	global_store_dwordx4 v28, v[24:27], s[32:33] sc1
	global_store_dwordx4 v29, v[24:27], s[32:33] sc1
	s_nop 4
L_skip_19:
	global_load_dword v109, v23, s[38:39] sc1
	s_cmp_eq_u32 s60, 0
	s_cbranch_scc0 L_alt_20
	ds_read_b128 v[80:83], v104 offset:45056
	ds_read_b128 v[84:87], v104 offset:32768
	s_waitcnt lgkmcnt(1)
	v_mfma_f32_32x32x16_bf16 v[32:47], v[80:83], v[168:171], v[208:223]
	s_waitcnt lgkmcnt(0)
	v_mfma_f32_32x32x16_bf16 v[48:63], v[84:87], v[164:167], v[208:223]
	v_mad_u32_u24 v172, v175, 11, v174
	s_nop 8
	v_exp_f32 v32, v32
	v_exp_f32 v33, v33
	v_exp_f32 v34, v34
	v_exp_f32 v35, v35
	ds_read_b128 v[80:83], v104 offset:40960
	v_exp_f32 v36, v36
	v_exp_f32 v37, v37
	v_exp_f32 v38, v38
	v_exp_f32 v39, v39
	v_exp_f32 v40, v40
	v_exp_f32 v41, v41
	ds_read_b128 v[88:91], v172 offset:0
	ds_read_b128 v[92:95], v172 offset:1024
	v_exp_f32 v42, v42
	v_exp_f32 v43, v43
	v_exp_f32 v44, v44
	v_exp_f32 v45, v45
	v_exp_f32 v46, v46
	v_exp_f32 v47, v47
	v_cvt_pk_bf16_f32 v64, v32, v33
	v_cvt_pk_bf16_f32 v65, v34, v35
	v_cvt_pk_bf16_f32 v66, v36, v37
	v_cvt_pk_bf16_f32 v67, v38, v39
	v_cvt_pk_bf16_f32 v68, v40, v41
	v_cvt_pk_bf16_f32 v69, v42, v43
	v_cvt_pk_bf16_f32 v70, v44, v45
	v_cvt_pk_bf16_f32 v71, v46, v47
	global_load_dword v110, v23, s[38:39] sc1
	s_nop 3
	s_cmp_eq_u32 s62, 1
	s_cbranch_scc1 L_hchk_22
	s_waitcnt vmcnt(2)
	v_cmp_ne_u32 vcc, s51, v108
	s_nop 4
	s_cbranch_vccnz L_hchk_22
	s_lshl_b32 s40, s24, 13
	s_add_u32 m0, s40, 98304
	s_nop 0
	global_load_lds_dwordx4 v2, s[34:35] offset:0
	global_load_lds_dwordx4 v2, s[34:35] offset:1024
	global_load_lds_dwordx4 v2, s[34:35] offset:2048
	global_load_lds_dwordx4 v2, s[34:35] offset:3072
	s_lshl_b32 s40, s24, 13
	s_add_u32 m0, s40, 102400
	s_nop 0
	global_load_lds_dwordx4 v2, s[36:37] offset:0
	global_load_lds_dwordx4 v2, s[36:37] offset:1024
	global_load_lds_dwordx4 v2, s[36:37] offset:2048
	global_load_lds_dwordx4 v2, s[36:37] offset:3072
	s_mov_b32 s62, 1
L_hchk_22:
	s_waitcnt lgkmcnt(2)
	v_mfma_f32_32x32x16_bf16 v[32:47], v[80:83], v[168:171], 0
	v_mad_u32_u24 v173, v175, 8, v174
	v_exp_f32 v48, v48
	v_exp_f32 v49, v49
	v_exp_f32 v50, v50
	v_exp_f32 v51, v51
	s_waitcnt lgkmcnt(1)
	v_mfma_f32_32x32x16_bf16 v[192:207], v[88:91], v[64:67], 0
	ds_read_b128 v[84:87], v104 offset:36864
	v_exp_f32 v52, v52
	v_exp_f32 v53, v53
	v_exp_f32 v54, v54
	v_exp_f32 v55, v55
	v_exp_f32 v56, v56
	v_exp_f32 v57, v57
	ds_read_b128 v[96:99], v173 offset:0
	ds_read_b128 v[100:103], v173 offset:1024
	s_waitcnt lgkmcnt(3)
	v_mfma_f32_32x32x16_bf16 v[192:207], v[92:95], v[68:71], v[192:207]
	v_exp_f32 v58, v58
	v_exp_f32 v59, v59
	v_exp_f32 v60, v60
	v_exp_f32 v61, v61
	v_exp_f32 v62, v62
	v_exp_f32 v63, v63
	v_cvt_pk_bf16_f32 v72, v48, v49
	v_cvt_pk_bf16_f32 v73, v50, v51
	v_cvt_pk_bf16_f32 v74, v52, v53
	v_cvt_pk_bf16_f32 v75, v54, v55
	v_cvt_pk_bf16_f32 v76, v56, v57
	v_cvt_pk_bf16_f32 v77, v58, v59
	v_cvt_pk_bf16_f32 v78, v60, v61
	v_cvt_pk_bf16_f32 v79, v62, v63
	global_load_dword v111, v23, s[38:39] sc1
	s_nop 3
	s_cmp_eq_u32 s62, 1
	s_cbranch_scc1 L_hchk_23
	s_waitcnt vmcnt(2)
	v_cmp_ne_u32 vcc, s51, v109
	s_nop 4
	s_cbranch_vccnz L_hchk_23
	s_lshl_b32 s40, s24, 13
	s_add_u32 m0, s40, 98304
	s_nop 0
	global_load_lds_dwordx4 v2, s[34:35] offset:0
	global_load_lds_dwordx4 v2, s[34:35] offset:1024
	global_load_lds_dwordx4 v2, s[34:35] offset:2048
	global_load_lds_dwordx4 v2, s[34:35] offset:3072
	s_lshl_b32 s40, s24, 13
	s_add_u32 m0, s40, 102400
	s_nop 0
	global_load_lds_dwordx4 v2, s[36:37] offset:0
	global_load_lds_dwordx4 v2, s[36:37] offset:1024
	global_load_lds_dwordx4 v2, s[36:37] offset:2048
	global_load_lds_dwordx4 v2, s[36:37] offset:3072
	s_mov_b32 s62, 1
L_hchk_23:
	s_waitcnt lgkmcnt(2)
	v_mfma_f32_32x32x16_bf16 v[48:63], v[84:87], v[168:171], 0
	v_mad_u32_u24 v172, v175, 10, v174
	v_exp_f32 v32, v32
	v_exp_f32 v33, v33
	v_exp_f32 v34, v34
	v_exp_f32 v35, v35
	s_waitcnt lgkmcnt(1)
	v_mfma_f32_32x32x16_bf16 v[176:191], v[96:99], v[72:75], 0
	ds_read_b128 v[80:83], v104 offset:32768
	v_exp_f32 v36, v36
	v_exp_f32 v37, v37
	v_exp_f32 v38, v38
	v_exp_f32 v39, v39
	v_exp_f32 v40, v40
	v_exp_f32 v41, v41
	ds_read_b128 v[88:91], v172 offset:0
	ds_read_b128 v[92:95], v172 offset:1024
	s_waitcnt lgkmcnt(3)
	v_mfma_f32_32x32x16_bf16 v[176:191], v[100:103], v[76:79], v[176:191]
	v_exp_f32 v42, v42
	v_exp_f32 v43, v43
	v_exp_f32 v44, v44
	v_exp_f32 v45, v45
	v_exp_f32 v46, v46
	v_exp_f32 v47, v47
	v_cvt_pk_bf16_f32 v64, v32, v33
	v_cvt_pk_bf16_f32 v65, v34, v35
	v_cvt_pk_bf16_f32 v66, v36, v37
	v_cvt_pk_bf16_f32 v67, v38, v39
	v_cvt_pk_bf16_f32 v68, v40, v41
	v_cvt_pk_bf16_f32 v69, v42, v43
	v_cvt_pk_bf16_f32 v70, v44, v45
	v_cvt_pk_bf16_f32 v71, v46, v47
	s_nop 4
	s_cmp_eq_u32 s62, 1
	s_cbranch_scc1 L_hchk_24
	s_waitcnt vmcnt(1)
	v_cmp_ne_u32 vcc, s51, v110
	s_nop 4
	s_cbranch_vccnz L_hchk_24
	s_lshl_b32 s40, s24, 13
	s_add_u32 m0, s40, 98304
	s_nop 0
	global_load_lds_dwordx4 v2, s[34:35] offset:0
	global_load_lds_dwordx4 v2, s[34:35] offset:1024
	global_load_lds_dwordx4 v2, s[34:35] offset:2048
	global_load_lds_dwordx4 v2, s[34:35] offset:3072
	s_lshl_b32 s40, s24, 13
	s_add_u32 m0, s40, 102400
	s_nop 0
	global_load_lds_dwordx4 v2, s[36:37] offset:0
	global_load_lds_dwordx4 v2, s[36:37] offset:1024
	global_load_lds_dwordx4 v2, s[36:37] offset:2048
	global_load_lds_dwordx4 v2, s[36:37] offset:3072
	s_mov_b32 s62, 1
L_hchk_24:
	s_waitcnt lgkmcnt(2)
	v_mfma_f32_32x32x16_bf16 v[32:47], v[80:83], v[168:171], 0
	v_mad_u32_u24 v173, v175, 9, v174
	v_exp_f32 v48, v48
	v_exp_f32 v49, v49
	v_exp_f32 v50, v50
	v_exp_f32 v51, v51
	s_waitcnt lgkmcnt(1)
	v_mfma_f32_32x32x16_bf16 v[192:207], v[88:91], v[64:67], v[192:207]
	v_exp_f32 v52, v52
	v_exp_f32 v53, v53
	v_exp_f32 v54, v54
	v_exp_f32 v55, v55
	v_exp_f32 v56, v56
	v_exp_f32 v57, v57
	ds_read_b128 v[96:99], v173 offset:0
	ds_read_b128 v[100:103], v173 offset:1024
	s_waitcnt lgkmcnt(2)
	v_mfma_f32_32x32x16_bf16 v[192:207], v[92:95], v[68:71], v[192:207]
	v_exp_f32 v58, v58
	v_exp_f32 v59, v59
	v_exp_f32 v60, v60
	v_exp_f32 v61, v61
	v_exp_f32 v62, v62
	v_exp_f32 v63, v63
	v_cvt_pk_bf16_f32 v72, v48, v49
	v_cvt_pk_bf16_f32 v73, v50, v51
	v_cvt_pk_bf16_f32 v74, v52, v53
	v_cvt_pk_bf16_f32 v75, v54, v55
	v_cvt_pk_bf16_f32 v76, v56, v57
	v_cvt_pk_bf16_f32 v77, v58, v59
	v_cvt_pk_bf16_f32 v78, v60, v61
	v_cvt_pk_bf16_f32 v79, v62, v63
	s_nop 4
	s_cmp_eq_u32 s62, 1
	s_cbranch_scc1 L_hchk_25
	s_waitcnt vmcnt(0)
	v_cmp_ne_u32 vcc, s51, v111
	s_nop 4
	s_cbranch_vccnz L_hchk_25
	s_lshl_b32 s40, s24, 13
	s_add_u32 m0, s40, 98304
	s_nop 0
	global_load_lds_dwordx4 v2, s[34:35] offset:0
	global_load_lds_dwordx4 v2, s[34:35] offset:1024
	global_load_lds_dwordx4 v2, s[34:35] offset:2048
	global_load_lds_dwordx4 v2, s[34:35] offset:3072
	s_lshl_b32 s40, s24, 13
	s_add_u32 m0, s40, 102400
	s_nop 0
	global_load_lds_dwordx4 v2, s[36:37] offset:0
	global_load_lds_dwordx4 v2, s[36:37] offset:1024
	global_load_lds_dwordx4 v2, s[36:37] offset:2048
	global_load_lds_dwordx4 v2, s[36:37] offset:3072
	s_mov_b32 s62, 1
L_hchk_25:
	v_mad_u32_u24 v172, v175, 8, v174
	v_exp_f32 v32, v32
	v_exp_f32 v33, v33
	v_exp_f32 v34, v34
	v_exp_f32 v35, v35
	s_waitcnt lgkmcnt(1)
	v_mfma_f32_32x32x16_bf16 v[192:207], v[96:99], v[72:75], v[192:207]
	v_exp_f32 v36, v36
	v_exp_f32 v37, v37
	v_exp_f32 v38, v38
	v_exp_f32 v39, v39
	v_exp_f32 v40, v40
	v_exp_f32 v41, v41
	ds_read_b128 v[88:91], v172 offset:0
	ds_read_b128 v[92:95], v172 offset:1024
	s_waitcnt lgkmcnt(2)
	v_mfma_f32_32x32x16_bf16 v[192:207], v[100:103], v[76:79], v[192:207]
	v_exp_f32 v42, v42
	v_exp_f32 v43, v43
	v_exp_f32 v44, v44
	v_exp_f32 v45, v45
	v_exp_f32 v46, v46
	v_exp_f32 v47, v47
	v_cvt_pk_bf16_f32 v64, v32, v33
	v_cvt_pk_bf16_f32 v65, v34, v35
	v_cvt_pk_bf16_f32 v66, v36, v37
	v_cvt_pk_bf16_f32 v67, v38, v39
	v_cvt_pk_bf16_f32 v68, v40, v41
	v_cvt_pk_bf16_f32 v69, v42, v43
	v_cvt_pk_bf16_f32 v70, v44, v45
	v_cvt_pk_bf16_f32 v71, v46, v47
	s_nop 4
	s_cmp_eq_u32 s62, 1
	s_cbranch_scc1 L_hfin_26
	s_mov_b32 s49, 0
	s_nop 1
L_poll_27:
	global_load_dword v28, v23, s[38:39] sc1
	s_waitcnt vmcnt(0)
	v_cmp_ne_u32 vcc, s51, v28
	s_nop 4
	s_cbranch_vccz L_pollout_28
	s_add_u32 s49, s49, 1
	s_cmp_ge_u32 s49, s26
	s_cbranch_scc0 L_poll_27
	s_mov_b32 s26, 1
L_pollout_28:
	s_lshl_b32 s40, s24, 13
	s_add_u32 m0, s40, 98304
	s_nop 0
	global_load_lds_dwordx4 v2, s[34:35] offset:0
	global_load_lds_dwordx4 v2, s[34:35] offset:1024
	global_load_lds_dwordx4 v2, s[34:35] offset:2048
	global_load_lds_dwordx4 v2, s[34:35] offset:3072
	s_lshl_b32 s40, s24, 13
	s_add_u32 m0, s40, 102400
	s_nop 0
	global_load_lds_dwordx4 v2, s[36:37] offset:0
	global_load_lds_dwordx4 v2, s[36:37] offset:1024
	global_load_lds_dwordx4 v2, s[36:37] offset:2048
	global_load_lds_dwordx4 v2, s[36:37] offset:3072
	s_mov_b32 s62, 1
L_hfin_26:
	s_lshr_b32 s40, s23, 2
	s_lshl_b32 s46, s22, 15
	s_lshl_b32 s47, s40, 13
	s_add_u32 s46, s46, s47
	s_add_u32 s46, s46, 51380224
	s_add_u32 s38, s20, s46
	s_addc_u32 s39, s21, 0
	v_lshlrev_b32 v27, 7, v0
	global_load_dword v108, v27, s[38:39] sc1
	s_waitcnt vmcnt(0)
	s_barrier
	ds_read_b128 v[84:87], v104 offset:28672
	ds_read_b128 v[80:83], v104 offset:28672
	s_waitcnt lgkmcnt(1)
	v_mfma_f32_32x32x16_bf16 v[48:63], v[84:87], v[164:167], v[224:239]
	v_mfma_f32_32x32x16_bf16 v[192:207], v[88:91], v[64:67], v[192:207]
	v_mfma_f32_32x32x16_bf16 v[192:207], v[92:95], v[68:71], v[192:207]
	s_waitcnt vmcnt(0)
	v_cmp_ne_u32 vcc, s51, v108
	s_nop 9
	s_cbranch_vccz L_pfok_29
	s_mov_b32 s49, 0
	s_nop 1
L_poll_30:
	global_load_dword v28, v27, s[38:39] sc1
	s_waitcnt vmcnt(0)
	v_cmp_ne_u32 vcc, s51, v28
	s_nop 4
	s_cbranch_vccz L_pollout_31
	s_add_u32 s49, s49, 1
	s_cmp_ge_u32 s49, s26
	s_cbranch_scc0 L_poll_30
	s_mov_b32 s26, 1
L_pollout_31:
L_pfok_29:
	s_waitcnt lgkmcnt(0)
	v_mfma_f32_32x32x16_bf16 v[32:47], v[80:83], v[168:171], v[224:239]
	v_mad_u32_u24 v173, v175, 7, v174
	v_exp_f32 v48, v48
	v_exp_f32 v49, v49
	global_load_dwordx4 a[128:131], v2, s[76:77] offset:0
	v_exp_f32 v50, v50
	v_exp_f32 v51, v51
	ds_read_b128 v[84:87], v104 offset:24576
	v_exp_f32 v52, v52
	v_exp_f32 v53, v53
	global_load_dwordx4 a[160:163], v2, s[78:79] offset:0
	v_exp_f32 v54, v54
	v_exp_f32 v55, v55
	v_exp_f32 v56, v56
	v_exp_f32 v57, v57
	ds_read_b128 v[96:99], v173 offset:0
	ds_read_b128 v[100:103], v173 offset:1024
	v_exp_f32 v58, v58
	v_exp_f32 v59, v59
	global_load_dwordx4 a[132:135], v2, s[76:77] offset:1024
	v_exp_f32 v60, v60
	v_exp_f32 v61, v61
	v_exp_f32 v62, v62
	global_load_dwordx4 a[164:167], v2, s[78:79] offset:1024
	v_exp_f32 v63, v63
	v_cvt_pk_bf16_f32 v72, v48, v49
	v_cvt_pk_bf16_f32 v73, v50, v51
	v_cvt_pk_bf16_f32 v74, v52, v53
	v_cvt_pk_bf16_f32 v75, v54, v55
	v_cvt_pk_bf16_f32 v76, v56, v57
	v_cvt_pk_bf16_f32 v77, v58, v59
	v_cvt_pk_bf16_f32 v78, v60, v61
	v_cvt_pk_bf16_f32 v79, v62, v63
	s_waitcnt lgkmcnt(2)
	v_mfma_f32_32x32x16_bf16 v[48:63], v[84:87], v[164:167], v[224:239]
	v_mad_u32_u24 v172, v175, 7, v174
	v_exp_f32 v32, v32
	v_exp_f32 v33, v33
	global_load_dwordx4 a[136:139], v2, s[76:77] offset:2048
	v_exp_f32 v34, v34
	v_exp_f32 v35, v35
	s_waitcnt lgkmcnt(1)
	v_mfma_f32_32x32x16_bf16 v[176:191], v[96:99], v[72:75], v[176:191]
	ds_read_b128 v[80:83], v104 offset:24576
	v_exp_f32 v36, v36
	v_exp_f32 v37, v37
	global_load_dwordx4 a[168:171], v2, s[78:79] offset:2048
	v_exp_f32 v38, v38
	v_exp_f32 v39, v39
	v_exp_f32 v40, v40
	v_exp_f32 v41, v41
	ds_read_b128 v[88:91], v172 offset:0
	ds_read_b128 v[92:95], v172 offset:1024
	s_waitcnt lgkmcnt(3)
	v_mfma_f32_32x32x16_bf16 v[176:191], v[100:103], v[76:79], v[176:191]
	v_exp_f32 v42, v42
	v_exp_f32 v43, v43
	global_load_dwordx4 a[140:143], v2, s[76:77] offset:3072
	v_exp_f32 v44, v44
	v_exp_f32 v45, v45
	v_exp_f32 v46, v46
	global_load_dwordx4 a[172:175], v2, s[78:79] offset:3072
	v_exp_f32 v47, v47
	v_cvt_pk_bf16_f32 v64, v32, v33
	v_cvt_pk_bf16_f32 v65, v34, v35
	v_cvt_pk_bf16_f32 v66, v36, v37
	v_cvt_pk_bf16_f32 v67, v38, v39
	v_cvt_pk_bf16_f32 v68, v40, v41
	v_cvt_pk_bf16_f32 v69, v42, v43
	v_cvt_pk_bf16_f32 v70, v44, v45
	v_cvt_pk_bf16_f32 v71, v46, v47
	s_waitcnt lgkmcnt(2)
	v_mfma_f32_32x32x16_bf16 v[32:47], v[80:83], v[168:171], v[224:239]
	v_mad_u32_u24 v173, v175, 6, v174
	v_exp_f32 v48, v48
	v_exp_f32 v49, v49
	global_load_dwordx4 a[144:147], v3, s[76:77] offset:0
	v_exp_f32 v50, v50
	v_exp_f32 v51, v51
	s_waitcnt lgkmcnt(1)
	v_mfma_f32_32x32x16_bf16 v[192:207], v[88:91], v[64:67], v[192:207]
	ds_read_b128 v[84:87], v104 offset:20480
	v_exp_f32 v52, v52
	v_exp_f32 v53, v53
	global_load_dwordx4 a[176:179], v3, s[78:79] offset:0
	v_exp_f32 v54, v54
	v_exp_f32 v55, v55
	v_exp_f32 v56, v56
	v_exp_f32 v57, v57
	ds_read_b128 v[96:99], v173 offset:0
	ds_read_b128 v[100:103], v173 offset:1024
	s_waitcnt lgkmcnt(3)
	v_mfma_f32_32x32x16_bf16 v[192:207], v[92:95], v[68:71], v[192:207]
	v_exp_f32 v58, v58
	v_exp_f32 v59, v59
	global_load_dwordx4 a[148:151], v3, s[76:77] offset:1024
	v_exp_f32 v60, v60
	v_exp_f32 v61, v61
	v_exp_f32 v62, v62
	global_load_dwordx4 a[180:183], v3, s[78:79] offset:1024
	v_exp_f32 v63, v63
	v_cvt_pk_bf16_f32 v72, v48, v49
	v_cvt_pk_bf16_f32 v73, v50, v51
	v_cvt_pk_bf16_f32 v74, v52, v53
	v_cvt_pk_bf16_f32 v75, v54, v55
	v_cvt_pk_bf16_f32 v76, v56, v57
	v_cvt_pk_bf16_f32 v77, v58, v59
	v_cvt_pk_bf16_f32 v78, v60, v61
	v_cvt_pk_bf16_f32 v79, v62, v63
	s_waitcnt lgkmcnt(2)
	v_mfma_f32_32x32x16_bf16 v[48:63], v[84:87], v[164:167], v[224:239]
	v_mad_u32_u24 v172, v175, 6, v174
	v_exp_f32 v32, v32
	v_exp_f32 v33, v33
	global_load_dwordx4 a[152:155], v3, s[76:77] offset:2048
	v_exp_f32 v34, v34
	v_exp_f32 v35, v35
	s_waitcnt lgkmcnt(1)
	v_mfma_f32_32x32x16_bf16 v[176:191], v[96:99], v[72:75], v[176:191]
	ds_read_b128 v[80:83], v104 offset:20480
	v_exp_f32 v36, v36
	v_exp_f32 v37, v37
	global_load_dwordx4 a[184:187], v3, s[78:79] offset:2048
	v_exp_f32 v38, v38
	v_exp_f32 v39, v39
	v_exp_f32 v40, v40
	v_exp_f32 v41, v41
	ds_read_b128 v[88:91], v172 offset:0
	ds_read_b128 v[92:95], v172 offset:1024
	s_waitcnt lgkmcnt(3)
	v_mfma_f32_32x32x16_bf16 v[176:191], v[100:103], v[76:79], v[176:191]
	v_exp_f32 v42, v42
	v_exp_f32 v43, v43
	global_load_dwordx4 a[156:159], v3, s[76:77] offset:3072
	v_exp_f32 v44, v44
	v_exp_f32 v45, v45
	v_exp_f32 v46, v46
	global_load_dwordx4 a[188:191], v3, s[78:79] offset:3072
	v_exp_f32 v47, v47
	v_cvt_pk_bf16_f32 v64, v32, v33
	v_cvt_pk_bf16_f32 v65, v34, v35
	v_cvt_pk_bf16_f32 v66, v36, v37
	v_cvt_pk_bf16_f32 v67, v38, v39
	v_cvt_pk_bf16_f32 v68, v40, v41
	v_cvt_pk_bf16_f32 v69, v42, v43
	v_cvt_pk_bf16_f32 v70, v44, v45
	v_cvt_pk_bf16_f32 v71, v46, v47
	s_waitcnt lgkmcnt(2)
	v_mfma_f32_32x32x16_bf16 v[32:47], v[80:83], v[168:171], v[224:239]
	v_mad_u32_u24 v173, v175, 5, v174
	v_exp_f32 v48, v48
	v_exp_f32 v49, v49
	s_add_u32 m0, s66, 0
	s_nop 0
	global_load_lds_dwordx4 v2, s[64:65] offset:0
	v_exp_f32 v50, v50
	v_exp_f32 v51, v51
	s_waitcnt lgkmcnt(1)
	v_mfma_f32_32x32x16_bf16 v[192:207], v[88:91], v[64:67], v[192:207]
	ds_read_b128 v[84:87], v104 offset:16384
	v_exp_f32 v52, v52
	v_exp_f32 v53, v53
	global_load_lds_dwordx4 v2, s[64:65] offset:1024
	v_exp_f32 v54, v54
	v_exp_f32 v55, v55
	v_exp_f32 v56, v56
	v_exp_f32 v57, v57
	ds_read_b128 v[96:99], v173 offset:0
	ds_read_b128 v[100:103], v173 offset:1024
	s_waitcnt lgkmcnt(3)
	v_mfma_f32_32x32x16_bf16 v[192:207], v[92:95], v[68:71], v[192:207]
	v_exp_f32 v58, v58
	v_exp_f32 v59, v59
	global_load_lds_dwordx4 v2, s[64:65] offset:2048
	v_exp_f32 v60, v60
	v_exp_f32 v61, v61
	v_exp_f32 v62, v62
	global_load_lds_dwordx4 v2, s[64:65] offset:3072
	v_exp_f32 v63, v63
	v_cvt_pk_bf16_f32 v72, v48, v49
	v_cvt_pk_bf16_f32 v73, v50, v51
	v_cvt_pk_bf16_f32 v74, v52, v53
	v_cvt_pk_bf16_f32 v75, v54, v55
	v_cvt_pk_bf16_f32 v76, v56, v57
	v_cvt_pk_bf16_f32 v77, v58, v59
	v_cvt_pk_bf16_f32 v78, v60, v61
	v_cvt_pk_bf16_f32 v79, v62, v63
	s_waitcnt lgkmcnt(2)
	v_mfma_f32_32x32x16_bf16 v[48:63], v[84:87], v[164:167], v[224:239]
	v_mad_u32_u24 v172, v175, 5, v174
	v_exp_f32 v32, v32
	v_exp_f32 v33, v33
	s_add_u32 m0, s66, 4096
	s_nop 0
	global_load_lds_dwordx4 v3, s[64:65] offset:0
	v_exp_f32 v34, v34
	v_exp_f32 v35, v35
	s_waitcnt lgkmcnt(1)
	v_mfma_f32_32x32x16_bf16 v[176:191], v[96:99], v[72:75], v[176:191]
	ds_read_b128 v[80:83], v104 offset:16384
	v_exp_f32 v36, v36
	v_exp_f32 v37, v37
	global_load_lds_dwordx4 v3, s[64:65] offset:1024
	v_exp_f32 v38, v38
	v_exp_f32 v39, v39
	v_exp_f32 v40, v40
	v_exp_f32 v41, v41
	ds_read_b128 v[88:91], v172 offset:0
	ds_read_b128 v[92:95], v172 offset:1024
	s_waitcnt lgkmcnt(3)
	v_mfma_f32_32x32x16_bf16 v[176:191], v[100:103], v[76:79], v[176:191]
	v_exp_f32 v42, v42
	v_exp_f32 v43, v43
	global_load_lds_dwordx4 v3, s[64:65] offset:2048
	s_add_u32 s64, s64, 28672
	s_addc_u32 s65, s65, 0
	v_exp_f32 v44, v44
	v_exp_f32 v45, v45
	v_exp_f32 v46, v46
	s_add_u32 m0, s66, 28672
	s_nop 0
	global_load_lds_dwordx4 v2, s[64:65] offset:0
	v_exp_f32 v47, v47
	v_cvt_pk_bf16_f32 v64, v32, v33
	v_cvt_pk_bf16_f32 v65, v34, v35
	v_cvt_pk_bf16_f32 v66, v36, v37
	v_cvt_pk_bf16_f32 v67, v38, v39
	v_cvt_pk_bf16_f32 v68, v40, v41
	v_cvt_pk_bf16_f32 v69, v42, v43
	v_cvt_pk_bf16_f32 v70, v44, v45
	v_cvt_pk_bf16_f32 v71, v46, v47
	s_waitcnt lgkmcnt(2)
	v_mfma_f32_32x32x16_bf16 v[32:47], v[80:83], v[168:171], v[224:239]
	v_mad_u32_u24 v173, v175, 4, v174
	v_exp_f32 v48, v48
	v_exp_f32 v49, v49
	global_load_lds_dwordx4 v2, s[64:65] offset:1024
	v_exp_f32 v50, v50
	v_exp_f32 v51, v51
	s_waitcnt lgkmcnt(1)
	v_mfma_f32_32x32x16_bf16 v[192:207], v[88:91], v[64:67], v[192:207]
	ds_read_b128 v[84:87], v104 offset:12288
	v_exp_f32 v52, v52
	v_exp_f32 v53, v53
	global_load_lds_dwordx4 v2, s[64:65] offset:2048
	v_exp_f32 v54, v54
	v_exp_f32 v55, v55
	v_exp_f32 v56, v56
	v_exp_f32 v57, v57
	ds_read_b128 v[96:99], v173 offset:0
	ds_read_b128 v[100:103], v173 offset:1024
	s_waitcnt lgkmcnt(3)
	v_mfma_f32_32x32x16_bf16 v[192:207], v[92:95], v[68:71], v[192:207]
	v_exp_f32 v58, v58
	v_exp_f32 v59, v59
	global_load_lds_dwordx4 v2, s[64:65] offset:3072
	v_exp_f32 v60, v60
	v_exp_f32 v61, v61
	v_exp_f32 v62, v62
	s_add_u32 m0, s66, 32768
	s_nop 0
	global_load_lds_dwordx4 v3, s[64:65] offset:0
	v_exp_f32 v63, v63
	v_cvt_pk_bf16_f32 v72, v48, v49
	v_cvt_pk_bf16_f32 v73, v50, v51
	v_cvt_pk_bf16_f32 v74, v52, v53
	v_cvt_pk_bf16_f32 v75, v54, v55
	v_cvt_pk_bf16_f32 v76, v56, v57
	v_cvt_pk_bf16_f32 v77, v58, v59
	v_cvt_pk_bf16_f32 v78, v60, v61
	v_cvt_pk_bf16_f32 v79, v62, v63
	s_waitcnt lgkmcnt(2)
	v_mfma_f32_32x32x16_bf16 v[48:63], v[84:87], v[164:167], v[112:127]
	v_mad_u32_u24 v172, v175, 4, v174
	v_exp_f32 v32, v32
	v_exp_f32 v33, v33
	global_load_lds_dwordx4 v3, s[64:65] offset:1024
	v_exp_f32 v34, v34
	v_exp_f32 v35, v35
	s_waitcnt lgkmcnt(1)
	v_mfma_f32_32x32x16_bf16 v[176:191], v[96:99], v[72:75], v[176:191]
	ds_read_b128 v[80:83], v104 offset:12288
	v_exp_f32 v36, v36
	v_exp_f32 v37, v37
	global_load_lds_dwordx4 v3, s[64:65] offset:2048
	s_add_u32 s64, s64, 28672
	s_addc_u32 s65, s65, 0
	v_exp_f32 v38, v38
	v_exp_f32 v39, v39
	v_exp_f32 v40, v40
	v_exp_f32 v41, v41
	ds_read_b128 v[88:91], v172 offset:0
	ds_read_b128 v[92:95], v172 offset:1024
	s_waitcnt lgkmcnt(3)
	v_mfma_f32_32x32x16_bf16 v[176:191], v[100:103], v[76:79], v[176:191]
	v_exp_f32 v42, v42
	v_exp_f32 v43, v43
	s_add_u32 m0, s66, 57344
	s_nop 0
	global_load_lds_dwordx4 v2, s[64:65] offset:0
	v_exp_f32 v44, v44
	v_exp_f32 v45, v45
	v_exp_f32 v46, v46
	global_load_lds_dwordx4 v2, s[64:65] offset:1024
	v_exp_f32 v47, v47
	v_cvt_pk_bf16_f32 v64, v32, v33
	v_cvt_pk_bf16_f32 v65, v34, v35
	v_cvt_pk_bf16_f32 v66, v36, v37
	v_cvt_pk_bf16_f32 v67, v38, v39
	v_cvt_pk_bf16_f32 v68, v40, v41
	v_cvt_pk_bf16_f32 v69, v42, v43
	v_cvt_pk_bf16_f32 v70, v44, v45
	v_cvt_pk_bf16_f32 v71, v46, v47
	s_waitcnt lgkmcnt(2)
	v_mfma_f32_32x32x16_bf16 v[32:47], v[80:83], v[168:171], v[240:255]
	v_mad_u32_u24 v173, v175, 3, v174
	v_exp_f32 v48, v48
	v_exp_f32 v49, v49
	global_load_lds_dwordx4 v2, s[64:65] offset:2048
	v_exp_f32 v50, v50
	v_exp_f32 v51, v51
	s_waitcnt lgkmcnt(1)
	v_mfma_f32_32x32x16_bf16 v[192:207], v[88:91], v[64:67], v[192:207]
	ds_read_b128 v[84:87], v104 offset:8192
	v_exp_f32 v52, v52
	v_exp_f32 v53, v53
	global_load_lds_dwordx4 v2, s[64:65] offset:3072
	v_exp_f32 v54, v54
	v_exp_f32 v55, v55
	v_exp_f32 v56, v56
	v_exp_f32 v57, v57
	ds_read_b128 v[96:99], v173 offset:0
	ds_read_b128 v[100:103], v173 offset:1024
	s_waitcnt lgkmcnt(3)
	v_mfma_f32_32x32x16_bf16 v[192:207], v[92:95], v[68:71], v[192:207]
	v_exp_f32 v58, v58
	v_exp_f32 v59, v59
	s_add_u32 m0, s66, 61440
	s_nop 0
	global_load_lds_dwordx4 v3, s[64:65] offset:0
	v_exp_f32 v60, v60
	v_exp_f32 v61, v61
	v_exp_f32 v62, v62
	global_load_lds_dwordx4 v3, s[64:65] offset:1024
	v_exp_f32 v63, v63
	v_cvt_pk_bf16_f32 v72, v48, v49
	v_cvt_pk_bf16_f32 v73, v50, v51
	v_cvt_pk_bf16_f32 v74, v52, v53
	v_cvt_pk_bf16_f32 v75, v54, v55
	v_cvt_pk_bf16_f32 v76, v56, v57
	v_cvt_pk_bf16_f32 v77, v58, v59
	v_cvt_pk_bf16_f32 v78, v60, v61
	v_cvt_pk_bf16_f32 v79, v62, v63
	s_waitcnt lgkmcnt(2)
	v_mfma_f32_32x32x16_bf16 v[48:63], v[84:87], v[164:167], v[112:127]
	v_mad_u32_u24 v172, v175, 3, v174
	v_exp_f32 v32, v32
	v_exp_f32 v33, v33
	global_load_lds_dwordx4 v3, s[64:65] offset:2048
	s_add_u32 s64, s64, 28672
	s_addc_u32 s65, s65, 0
	v_exp_f32 v34, v34
	v_exp_f32 v35, v35
	s_waitcnt lgkmcnt(1)
	v_mfma_f32_32x32x16_bf16 v[176:191], v[96:99], v[72:75], v[176:191]
	ds_read_b128 v[80:83], v104 offset:4096
	v_exp_f32 v36, v36
	v_exp_f32 v37, v37
	global_load_dwordx4 a[0:3], v2, s[72:73] offset:0
	v_exp_f32 v38, v38
	v_exp_f32 v39, v39
	v_exp_f32 v40, v40
	v_exp_f32 v41, v41
	ds_read_b128 v[88:91], v172 offset:0
	ds_read_b128 v[92:95], v172 offset:1024
	s_waitcnt lgkmcnt(3)
	v_mfma_f32_32x32x16_bf16 v[176:191], v[100:103], v[76:79], v[176:191]
	v_exp_f32 v42, v42
	v_exp_f32 v43, v43
	global_load_dwordx4 a[4:7], v2, s[74:75] offset:0
	v_exp_f32 v44, v44
	v_exp_f32 v45, v45
	v_exp_f32 v46, v46
	global_load_dwordx4 a[8:11], v2, s[72:73] offset:1024
	v_exp_f32 v47, v47
	v_cvt_pk_bf16_f32 v64, v32, v33
	v_cvt_pk_bf16_f32 v65, v34, v35
	v_cvt_pk_bf16_f32 v66, v36, v37
	v_cvt_pk_bf16_f32 v67, v38, v39
	v_cvt_pk_bf16_f32 v68, v40, v41
	v_cvt_pk_bf16_f32 v69, v42, v43
	v_cvt_pk_bf16_f32 v70, v44, v45
	v_cvt_pk_bf16_f32 v71, v46, v47
	s_waitcnt lgkmcnt(2)
	v_mfma_f32_32x32x16_bf16 v[32:47], v[80:83], v[164:167], v[112:127]
	v_mad_u32_u24 v173, v175, 2, v174
	v_exp_f32 v48, v48
	v_exp_f32 v49, v49
	global_load_dwordx4 a[12:15], v2, s[74:75] offset:1024
	v_exp_f32 v50, v50
	v_exp_f32 v51, v51
	s_waitcnt lgkmcnt(1)
	v_mfma_f32_32x32x16_bf16 v[192:207], v[88:91], v[64:67], v[192:207]
	ds_read_b128 v[84:87], v104 offset:0
	v_exp_f32 v52, v52
	v_exp_f32 v53, v53
	global_load_dwordx4 a[16:19], v2, s[72:73] offset:2048
	v_exp_f32 v54, v54
	v_exp_f32 v55, v55
	v_exp_f32 v56, v56
	v_exp_f32 v57, v57
	ds_read_b128 v[96:99], v173 offset:0
	ds_read_b128 v[100:103], v173 offset:1024
	s_waitcnt lgkmcnt(3)
	v_mfma_f32_32x32x16_bf16 v[192:207], v[92:95], v[68:71], v[192:207]
	v_exp_f32 v58, v58
	v_exp_f32 v59, v59
	global_load_dwordx4 a[20:23], v2, s[74:75] offset:2048
	v_exp_f32 v60, v60
	v_exp_f32 v61, v61
	v_exp_f32 v62, v62
	global_load_dwordx4 a[24:27], v2, s[72:73] offset:3072
	v_exp_f32 v63, v63
	v_cvt_pk_bf16_f32 v72, v48, v49
	v_cvt_pk_bf16_f32 v73, v50, v51
	v_cvt_pk_bf16_f32 v74, v52, v53
	v_cvt_pk_bf16_f32 v75, v54, v55
	v_cvt_pk_bf16_f32 v76, v56, v57
	v_cvt_pk_bf16_f32 v77, v58, v59
	v_cvt_pk_bf16_f32 v78, v60, v61
	v_cvt_pk_bf16_f32 v79, v62, v63
	s_waitcnt lgkmcnt(2)
	v_mfma_f32_32x32x16_bf16 v[48:63], v[84:87], v[164:167], v[240:255]
	v_mad_u32_u24 v172, v175, 1, v174
	v_exp_f32 v32, v32
	v_exp_f32 v33, v33
	global_load_dwordx4 a[28:31], v2, s[74:75] offset:3072
	v_exp_f32 v34, v34
	v_exp_f32 v35, v35
	s_waitcnt lgkmcnt(1)
	v_mfma_f32_32x32x16_bf16 v[176:191], v[96:99], v[72:75], v[176:191]
	v_exp_f32 v36, v36
	v_exp_f32 v37, v37
	global_load_dwordx4 a[32:35], v3, s[72:73] offset:0
	v_exp_f32 v38, v38
	v_exp_f32 v39, v39
	v_exp_f32 v40, v40
	v_exp_f32 v41, v41
	ds_read_b128 v[88:91], v172 offset:0
	ds_read_b128 v[92:95], v172 offset:1024
	s_waitcnt lgkmcnt(2)
	v_mfma_f32_32x32x16_bf16 v[176:191], v[100:103], v[76:79], v[176:191]
	v_exp_f32 v42, v42
	v_exp_f32 v43, v43
	global_load_dwordx4 a[36:39], v3, s[74:75] offset:0
	v_exp_f32 v44, v44
	v_exp_f32 v45, v45
	v_exp_f32 v46, v46
	global_load_dwordx4 a[40:43], v3, s[72:73] offset:1024
	v_exp_f32 v47, v47
	v_cvt_pk_bf16_f32 v64, v32, v33
	v_cvt_pk_bf16_f32 v65, v34, v35
	v_cvt_pk_bf16_f32 v66, v36, v37
	v_cvt_pk_bf16_f32 v67, v38, v39
	v_cvt_pk_bf16_f32 v68, v40, v41
	v_cvt_pk_bf16_f32 v69, v42, v43
	v_cvt_pk_bf16_f32 v70, v44, v45
	v_cvt_pk_bf16_f32 v71, v46, v47
	v_mad_u32_u24 v173, v175, 0, v174
	v_exp_f32 v48, v48
	v_exp_f32 v49, v49
	global_load_dwordx4 a[44:47], v3, s[74:75] offset:1024
	v_exp_f32 v50, v50
	v_exp_f32 v51, v51
	s_waitcnt lgkmcnt(1)
	v_mfma_f32_32x32x16_bf16 v[176:191], v[88:91], v[64:67], v[176:191]
	v_exp_f32 v52, v52
	v_exp_f32 v53, v53
	global_load_dwordx4 a[48:51], v3, s[72:73] offset:2048
	v_exp_f32 v54, v54
	v_exp_f32 v55, v55
	v_exp_f32 v56, v56
	v_exp_f32 v57, v57
	ds_read_b128 v[96:99], v173 offset:0
	ds_read_b128 v[100:103], v173 offset:1024
	s_waitcnt lgkmcnt(2)
	v_mfma_f32_32x32x16_bf16 v[176:191], v[92:95], v[68:71], v[176:191]
	v_exp_f32 v58, v58
	v_exp_f32 v59, v59
	global_load_dwordx4 a[52:55], v3, s[74:75] offset:2048
	v_exp_f32 v60, v60
	v_exp_f32 v61, v61
	v_exp_f32 v62, v62
	global_load_dwordx4 a[56:59], v3, s[72:73] offset:3072
	v_exp_f32 v63, v63
	v_cvt_pk_bf16_f32 v72, v48, v49
	v_cvt_pk_bf16_f32 v73, v50, v51
	v_cvt_pk_bf16_f32 v74, v52, v53
	v_cvt_pk_bf16_f32 v75, v54, v55
	v_cvt_pk_bf16_f32 v76, v56, v57
	v_cvt_pk_bf16_f32 v77, v58, v59
	v_cvt_pk_bf16_f32 v78, v60, v61
	v_cvt_pk_bf16_f32 v79, v62, v63
	s_waitcnt lgkmcnt(1)
	v_mfma_f32_32x32x16_bf16 v[176:191], v[96:99], v[72:75], v[176:191]
	s_waitcnt lgkmcnt(0)
	v_mfma_f32_32x32x16_bf16 v[176:191], v[100:103], v[76:79], v[176:191]
	s_branch L_join_21
L_alt_20:
	ds_read_b128 v[80:83], v104 offset:40960
	ds_read_b128 v[84:87], v104 offset:36864
	s_waitcnt lgkmcnt(1)
	v_mfma_f32_32x32x16_bf16 v[32:47], v[80:83], v[168:171], v[208:223]
	s_waitcnt lgkmcnt(0)
	v_mfma_f32_32x32x16_bf16 v[48:63], v[84:87], v[164:167], v[208:223]
	v_mad_u32_u24 v172, v175, 10, v174
	s_nop 8
	v_exp_f32 v32, v32
	v_exp_f32 v33, v33
	v_exp_f32 v34, v34
	v_exp_f32 v35, v35
	ds_read_b128 v[80:83], v104 offset:36864
	v_exp_f32 v36, v36
	v_exp_f32 v37, v37
	v_exp_f32 v38, v38
	v_exp_f32 v39, v39
	v_exp_f32 v40, v40
	v_exp_f32 v41, v41
	ds_read_b128 v[88:91], v172 offset:0
	ds_read_b128 v[92:95], v172 offset:1024
	v_exp_f32 v42, v42
	v_exp_f32 v43, v43
	v_exp_f32 v44, v44
	v_exp_f32 v45, v45
	v_exp_f32 v46, v46
	v_exp_f32 v47, v47
	v_cvt_pk_bf16_f32 v64, v32, v33
	v_cvt_pk_bf16_f32 v65, v34, v35
	v_cvt_pk_bf16_f32 v66, v36, v37
	v_cvt_pk_bf16_f32 v67, v38, v39
	v_cvt_pk_bf16_f32 v68, v40, v41
	v_cvt_pk_bf16_f32 v69, v42, v43
	v_cvt_pk_bf16_f32 v70, v44, v45
	v_cvt_pk_bf16_f32 v71, v46, v47
	global_load_dword v110, v23, s[38:39] sc1
	s_nop 3
	s_cmp_eq_u32 s62, 1
	s_cbranch_scc1 L_hchk_32
	s_waitcnt vmcnt(2)
	v_cmp_ne_u32 vcc, s51, v108
	s_nop 4
	s_cbranch_vccnz L_hchk_32
	s_lshl_b32 s40, s24, 13
	s_add_u32 m0, s40, 98304
	s_nop 0
	global_load_lds_dwordx4 v2, s[34:35] offset:0
	global_load_lds_dwordx4 v2, s[34:35] offset:1024
	global_load_lds_dwordx4 v2, s[34:35] offset:2048
	global_load_lds_dwordx4 v2, s[34:35] offset:3072
	s_lshl_b32 s40, s24, 13
	s_add_u32 m0, s40, 102400
	s_nop 0
	global_load_lds_dwordx4 v2, s[36:37] offset:0
	global_load_lds_dwordx4 v2, s[36:37] offset:1024
	global_load_lds_dwordx4 v2, s[36:37] offset:2048
	global_load_lds_dwordx4 v2, s[36:37] offset:3072
	s_mov_b32 s62, 1
L_hchk_32:
	s_waitcnt lgkmcnt(2)
	v_mfma_f32_32x32x16_bf16 v[32:47], v[80:83], v[168:171], 0
	v_mad_u32_u24 v173, v175, 9, v174
	v_exp_f32 v48, v48
	v_exp_f32 v49, v49
	v_exp_f32 v50, v50
	v_exp_f32 v51, v51
	s_waitcnt lgkmcnt(1)
	v_mfma_f32_32x32x16_bf16 v[192:207], v[88:91], v[64:67], 0
	ds_read_b128 v[84:87], v104 offset:32768
	v_exp_f32 v52, v52
	v_exp_f32 v53, v53
	v_exp_f32 v54, v54
	v_exp_f32 v55, v55
	v_exp_f32 v56, v56
	v_exp_f32 v57, v57
	ds_read_b128 v[96:99], v173 offset:0
	ds_read_b128 v[100:103], v173 offset:1024
	s_waitcnt lgkmcnt(3)
	v_mfma_f32_32x32x16_bf16 v[192:207], v[92:95], v[68:71], v[192:207]
	v_exp_f32 v58, v58
	v_exp_f32 v59, v59
	v_exp_f32 v60, v60
	v_exp_f32 v61, v61
	v_exp_f32 v62, v62
	v_exp_f32 v63, v63
	v_cvt_pk_bf16_f32 v72, v48, v49
	v_cvt_pk_bf16_f32 v73, v50, v51
	v_cvt_pk_bf16_f32 v74, v52, v53
	v_cvt_pk_bf16_f32 v75, v54, v55
	v_cvt_pk_bf16_f32 v76, v56, v57
	v_cvt_pk_bf16_f32 v77, v58, v59
	v_cvt_pk_bf16_f32 v78, v60, v61
	v_cvt_pk_bf16_f32 v79, v62, v63
	global_load_dword v111, v23, s[38:39] sc1
	s_nop 3
	s_cmp_eq_u32 s62, 1
	s_cbranch_scc1 L_hchk_33
	s_waitcnt vmcnt(2)
	v_cmp_ne_u32 vcc, s51, v109
	s_nop 4
	s_cbranch_vccnz L_hchk_33
	s_lshl_b32 s40, s24, 13
	s_add_u32 m0, s40, 98304
	s_nop 0
	global_load_lds_dwordx4 v2, s[34:35] offset:0
	global_load_lds_dwordx4 v2, s[34:35] offset:1024
	global_load_lds_dwordx4 v2, s[34:35] offset:2048
	global_load_lds_dwordx4 v2, s[34:35] offset:3072
	s_lshl_b32 s40, s24, 13
	s_add_u32 m0, s40, 102400
	s_nop 0
	global_load_lds_dwordx4 v2, s[36:37] offset:0
	global_load_lds_dwordx4 v2, s[36:37] offset:1024
	global_load_lds_dwordx4 v2, s[36:37] offset:2048
	global_load_lds_dwordx4 v2, s[36:37] offset:3072
	s_mov_b32 s62, 1
L_hchk_33:
	s_waitcnt lgkmcnt(2)
	v_mfma_f32_32x32x16_bf16 v[48:63], v[84:87], v[164:167], 0
	v_mad_u32_u24 v172, v175, 9, v174
	v_exp_f32 v32, v32
	v_exp_f32 v33, v33
	v_exp_f32 v34, v34
	v_exp_f32 v35, v35
	s_waitcnt lgkmcnt(1)
	v_mfma_f32_32x32x16_bf16 v[176:191], v[96:99], v[72:75], 0
	ds_read_b128 v[80:83], v104 offset:32768
	v_exp_f32 v36, v36
	v_exp_f32 v37, v37
	v_exp_f32 v38, v38
	v_exp_f32 v39, v39
	v_exp_f32 v40, v40
	v_exp_f32 v41, v41
	ds_read_b128 v[88:91], v172 offset:0
	ds_read_b128 v[92:95], v172 offset:1024
	s_waitcnt lgkmcnt(3)
	v_mfma_f32_32x32x16_bf16 v[176:191], v[100:103], v[76:79], v[176:191]
	v_exp_f32 v42, v42
	v_exp_f32 v43, v43
	v_exp_f32 v44, v44
	v_exp_f32 v45, v45
	v_exp_f32 v46, v46
	v_exp_f32 v47, v47
	v_cvt_pk_bf16_f32 v64, v32, v33
	v_cvt_pk_bf16_f32 v65, v34, v35
	v_cvt_pk_bf16_f32 v66, v36, v37
	v_cvt_pk_bf16_f32 v67, v38, v39
	v_cvt_pk_bf16_f32 v68, v40, v41
	v_cvt_pk_bf16_f32 v69, v42, v43
	v_cvt_pk_bf16_f32 v70, v44, v45
	v_cvt_pk_bf16_f32 v71, v46, v47
	s_nop 4
	s_cmp_eq_u32 s62, 1
	s_cbranch_scc1 L_hchk_34
	s_waitcnt vmcnt(1)
	v_cmp_ne_u32 vcc, s51, v110
	s_nop 4
	s_cbranch_vccnz L_hchk_34
	s_lshl_b32 s40, s24, 13
	s_add_u32 m0, s40, 98304
	s_nop 0
	global_load_lds_dwordx4 v2, s[34:35] offset:0
	global_load_lds_dwordx4 v2, s[34:35] offset:1024
	global_load_lds_dwordx4 v2, s[34:35] offset:2048
	global_load_lds_dwordx4 v2, s[34:35] offset:3072
	s_lshl_b32 s40, s24, 13
	s_add_u32 m0, s40, 102400
	s_nop 0
	global_load_lds_dwordx4 v2, s[36:37] offset:0
	global_load_lds_dwordx4 v2, s[36:37] offset:1024
	global_load_lds_dwordx4 v2, s[36:37] offset:2048
	global_load_lds_dwordx4 v2, s[36:37] offset:3072
	s_mov_b32 s62, 1
L_hchk_34:
	s_waitcnt lgkmcnt(2)
	v_mfma_f32_32x32x16_bf16 v[32:47], v[80:83], v[168:171], 0
	v_mad_u32_u24 v173, v175, 8, v174
	v_exp_f32 v48, v48
	v_exp_f32 v49, v49
	v_exp_f32 v50, v50
	v_exp_f32 v51, v51
	s_waitcnt lgkmcnt(1)
	v_mfma_f32_32x32x16_bf16 v[192:207], v[88:91], v[64:67], v[192:207]
	v_exp_f32 v52, v52
	v_exp_f32 v53, v53
	v_exp_f32 v54, v54
	v_exp_f32 v55, v55
	v_exp_f32 v56, v56
	v_exp_f32 v57, v57
	ds_read_b128 v[96:99], v173 offset:0
	ds_read_b128 v[100:103], v173 offset:1024
	s_waitcnt lgkmcnt(2)
	v_mfma_f32_32x32x16_bf16 v[192:207], v[92:95], v[68:71], v[192:207]
	v_exp_f32 v58, v58
	v_exp_f32 v59, v59
	v_exp_f32 v60, v60
	v_exp_f32 v61, v61
	v_exp_f32 v62, v62
	v_exp_f32 v63, v63
	v_cvt_pk_bf16_f32 v72, v48, v49
	v_cvt_pk_bf16_f32 v73, v50, v51
	v_cvt_pk_bf16_f32 v74, v52, v53
	v_cvt_pk_bf16_f32 v75, v54, v55
	v_cvt_pk_bf16_f32 v76, v56, v57
	v_cvt_pk_bf16_f32 v77, v58, v59
	v_cvt_pk_bf16_f32 v78, v60, v61
	v_cvt_pk_bf16_f32 v79, v62, v63
	s_nop 4
	s_cmp_eq_u32 s62, 1
	s_cbranch_scc1 L_hchk_35
	s_waitcnt vmcnt(0)
	v_cmp_ne_u32 vcc, s51, v111
	s_nop 4
	s_cbranch_vccnz L_hchk_35
	s_lshl_b32 s40, s24, 13
	s_add_u32 m0, s40, 98304
	s_nop 0
	global_load_lds_dwordx4 v2, s[34:35] offset:0
	global_load_lds_dwordx4 v2, s[34:35] offset:1024
	global_load_lds_dwordx4 v2, s[34:35] offset:2048
	global_load_lds_dwordx4 v2, s[34:35] offset:3072
	s_lshl_b32 s40, s24, 13
	s_add_u32 m0, s40, 102400
	s_nop 0
	global_load_lds_dwordx4 v2, s[36:37] offset:0
	global_load_lds_dwordx4 v2, s[36:37] offset:1024
	global_load_lds_dwordx4 v2, s[36:37] offset:2048
	global_load_lds_dwordx4 v2, s[36:37] offset:3072
	s_mov_b32 s62, 1
L_hchk_35:
	v_mad_u32_u24 v172, v175, 8, v174
	v_exp_f32 v32, v32
	v_exp_f32 v33, v33
	v_exp_f32 v34, v34
	v_exp_f32 v35, v35
	s_waitcnt lgkmcnt(1)
	v_mfma_f32_32x32x16_bf16 v[176:191], v[96:99], v[72:75], v[176:191]
	v_exp_f32 v36, v36
	v_exp_f32 v37, v37
	v_exp_f32 v38, v38
	v_exp_f32 v39, v39
	v_exp_f32 v40, v40
	v_exp_f32 v41, v41
	ds_read_b128 v[88:91], v172 offset:0
	ds_read_b128 v[92:95], v172 offset:1024
	s_waitcnt lgkmcnt(2)
	v_mfma_f32_32x32x16_bf16 v[176:191], v[100:103], v[76:79], v[176:191]
	v_exp_f32 v42, v42
	v_exp_f32 v43, v43
	v_exp_f32 v44, v44
	v_exp_f32 v45, v45
	v_exp_f32 v46, v46
	v_exp_f32 v47, v47
	v_cvt_pk_bf16_f32 v64, v32, v33
	v_cvt_pk_bf16_f32 v65, v34, v35
	v_cvt_pk_bf16_f32 v66, v36, v37
	v_cvt_pk_bf16_f32 v67, v38, v39
	v_cvt_pk_bf16_f32 v68, v40, v41
	v_cvt_pk_bf16_f32 v69, v42, v43
	v_cvt_pk_bf16_f32 v70, v44, v45
	v_cvt_pk_bf16_f32 v71, v46, v47
	s_nop 4
	s_cmp_eq_u32 s62, 1
	s_cbranch_scc1 L_hfin_36
	s_mov_b32 s49, 0
	s_nop 1
L_poll_37:
	global_load_dword v28, v23, s[38:39] sc1
	s_waitcnt vmcnt(0)
	v_cmp_ne_u32 vcc, s51, v28
	s_nop 4
	s_cbranch_vccz L_pollout_38
	s_add_u32 s49, s49, 1
	s_cmp_ge_u32 s49, s26
	s_cbranch_scc0 L_poll_37
	s_mov_b32 s26, 1
L_pollout_38:
	s_lshl_b32 s40, s24, 13
	s_add_u32 m0, s40, 98304
	s_nop 0
	global_load_lds_dwordx4 v2, s[34:35] offset:0
	global_load_lds_dwordx4 v2, s[34:35] offset:1024
	global_load_lds_dwordx4 v2, s[34:35] offset:2048
	global_load_lds_dwordx4 v2, s[34:35] offset:3072
	s_lshl_b32 s40, s24, 13
	s_add_u32 m0, s40, 102400
	s_nop 0
	global_load_lds_dwordx4 v2, s[36:37] offset:0
	global_load_lds_dwordx4 v2, s[36:37] offset:1024
	global_load_lds_dwordx4 v2, s[36:37] offset:2048
	global_load_lds_dwordx4 v2, s[36:37] offset:3072
	s_mov_b32 s62, 1
L_hfin_36:
	s_lshr_b32 s40, s23, 2
	s_lshl_b32 s46, s22, 15
	s_lshl_b32 s47, s40, 13
	s_add_u32 s46, s46, s47
	s_add_u32 s46, s46, 51380224
	s_add_u32 s38, s20, s46
	s_addc_u32 s39, s21, 0
	v_lshlrev_b32 v27, 7, v0
	global_load_dword v108, v27, s[38:39] sc1
	s_waitcnt vmcnt(0)
	s_barrier
	ds_read_b128 v[84:87], v104 offset:28672
	ds_read_b128 v[80:83], v104 offset:28672
	s_waitcnt lgkmcnt(1)
	v_mfma_f32_32x32x16_bf16 v[48:63], v[84:87], v[164:167], v[224:239]
	v_mfma_f32_32x32x16_bf16 v[192:207], v[88:91], v[64:67], v[192:207]
	v_mfma_f32_32x32x16_bf16 v[192:207], v[92:95], v[68:71], v[192:207]
	s_waitcnt vmcnt(0)
	v_cmp_ne_u32 vcc, s51, v108
	s_nop 9
	s_cbranch_vccz L_pfok_39
	s_mov_b32 s49, 0
	s_nop 1
L_poll_40:
	global_load_dword v28, v27, s[38:39] sc1
	s_waitcnt vmcnt(0)
	v_cmp_ne_u32 vcc, s51, v28
	s_nop 4
	s_cbranch_vccz L_pollout_41
	s_add_u32 s49, s49, 1
	s_cmp_ge_u32 s49, s26
	s_cbranch_scc0 L_poll_40
	s_mov_b32 s26, 1
L_pollout_41:
L_pfok_39:
	s_waitcnt lgkmcnt(0)
	v_mfma_f32_32x32x16_bf16 v[32:47], v[80:83], v[168:171], v[224:239]
	v_mad_u32_u24 v173, v175, 7, v174
	v_exp_f32 v48, v48
	v_exp_f32 v49, v49
	global_load_dwordx4 a[128:131], v2, s[76:77] offset:0
	v_exp_f32 v50, v50
	v_exp_f32 v51, v51
	ds_read_b128 v[84:87], v104 offset:24576
	v_exp_f32 v52, v52
	v_exp_f32 v53, v53
	global_load_dwordx4 a[160:163], v2, s[78:79] offset:0
	v_exp_f32 v54, v54
	v_exp_f32 v55, v55
	v_exp_f32 v56, v56
	v_exp_f32 v57, v57
	ds_read_b128 v[96:99], v173 offset:0
	ds_read_b128 v[100:103], v173 offset:1024
	v_exp_f32 v58, v58
	v_exp_f32 v59, v59
	global_load_dwordx4 a[132:135], v2, s[76:77] offset:1024
	v_exp_f32 v60, v60
	v_exp_f32 v61, v61
	v_exp_f32 v62, v62
	global_load_dwordx4 a[164:167], v2, s[78:79] offset:1024
	v_exp_f32 v63, v63
	v_cvt_pk_bf16_f32 v72, v48, v49
	v_cvt_pk_bf16_f32 v73, v50, v51
	v_cvt_pk_bf16_f32 v74, v52, v53
	v_cvt_pk_bf16_f32 v75, v54, v55
	v_cvt_pk_bf16_f32 v76, v56, v57
	v_cvt_pk_bf16_f32 v77, v58, v59
	v_cvt_pk_bf16_f32 v78, v60, v61
	v_cvt_pk_bf16_f32 v79, v62, v63
	s_waitcnt lgkmcnt(2)
	v_mfma_f32_32x32x16_bf16 v[48:63], v[84:87], v[164:167], v[224:239]
	v_mad_u32_u24 v172, v175, 7, v174
	v_exp_f32 v32, v32
	v_exp_f32 v33, v33
	global_load_dwordx4 a[136:139], v2, s[76:77] offset:2048
	v_exp_f32 v34, v34
	v_exp_f32 v35, v35
	s_waitcnt lgkmcnt(1)
	v_mfma_f32_32x32x16_bf16 v[176:191], v[96:99], v[72:75], v[176:191]
	ds_read_b128 v[80:83], v104 offset:24576
	v_exp_f32 v36, v36
	v_exp_f32 v37, v37
	global_load_dwordx4 a[168:171], v2, s[78:79] offset:2048
	v_exp_f32 v38, v38
	v_exp_f32 v39, v39
	v_exp_f32 v40, v40
	v_exp_f32 v41, v41
	ds_read_b128 v[88:91], v172 offset:0
	ds_read_b128 v[92:95], v172 offset:1024
	s_waitcnt lgkmcnt(3)
	v_mfma_f32_32x32x16_bf16 v[176:191], v[100:103], v[76:79], v[176:191]
	v_exp_f32 v42, v42
	v_exp_f32 v43, v43
	global_load_dwordx4 a[140:143], v2, s[76:77] offset:3072
	v_exp_f32 v44, v44
	v_exp_f32 v45, v45
	v_exp_f32 v46, v46
	global_load_dwordx4 a[172:175], v2, s[78:79] offset:3072
	v_exp_f32 v47, v47
	v_cvt_pk_bf16_f32 v64, v32, v33
	v_cvt_pk_bf16_f32 v65, v34, v35
	v_cvt_pk_bf16_f32 v66, v36, v37
	v_cvt_pk_bf16_f32 v67, v38, v39
	v_cvt_pk_bf16_f32 v68, v40, v41
	v_cvt_pk_bf16_f32 v69, v42, v43
	v_cvt_pk_bf16_f32 v70, v44, v45
	v_cvt_pk_bf16_f32 v71, v46, v47
	s_waitcnt lgkmcnt(2)
	v_mfma_f32_32x32x16_bf16 v[32:47], v[80:83], v[168:171], v[224:239]
	v_mad_u32_u24 v173, v175, 6, v174
	v_exp_f32 v48, v48
	v_exp_f32 v49, v49
	global_load_dwordx4 a[144:147], v3, s[76:77] offset:0
	v_exp_f32 v50, v50
	v_exp_f32 v51, v51
	s_waitcnt lgkmcnt(1)
	v_mfma_f32_32x32x16_bf16 v[192:207], v[88:91], v[64:67], v[192:207]
	ds_read_b128 v[84:87], v104 offset:20480
	v_exp_f32 v52, v52
	v_exp_f32 v53, v53
	global_load_dwordx4 a[176:179], v3, s[78:79] offset:0
	v_exp_f32 v54, v54
	v_exp_f32 v55, v55
	v_exp_f32 v56, v56
	v_exp_f32 v57, v57
	ds_read_b128 v[96:99], v173 offset:0
	ds_read_b128 v[100:103], v173 offset:1024
	s_waitcnt lgkmcnt(3)
	v_mfma_f32_32x32x16_bf16 v[192:207], v[92:95], v[68:71], v[192:207]
	v_exp_f32 v58, v58
	v_exp_f32 v59, v59
	global_load_dwordx4 a[148:151], v3, s[76:77] offset:1024
	v_exp_f32 v60, v60
	v_exp_f32 v61, v61
	v_exp_f32 v62, v62
	global_load_dwordx4 a[180:183], v3, s[78:79] offset:1024
	v_exp_f32 v63, v63
	v_cvt_pk_bf16_f32 v72, v48, v49
	v_cvt_pk_bf16_f32 v73, v50, v51
	v_cvt_pk_bf16_f32 v74, v52, v53
	v_cvt_pk_bf16_f32 v75, v54, v55
	v_cvt_pk_bf16_f32 v76, v56, v57
	v_cvt_pk_bf16_f32 v77, v58, v59
	v_cvt_pk_bf16_f32 v78, v60, v61
	v_cvt_pk_bf16_f32 v79, v62, v63
	s_waitcnt lgkmcnt(2)
	v_mfma_f32_32x32x16_bf16 v[48:63], v[84:87], v[164:167], v[224:239]
	v_mad_u32_u24 v172, v175, 6, v174
	v_exp_f32 v32, v32
	v_exp_f32 v33, v33
	global_load_dwordx4 a[152:155], v3, s[76:77] offset:2048
	v_exp_f32 v34, v34
	v_exp_f32 v35, v35
	s_waitcnt lgkmcnt(1)
	v_mfma_f32_32x32x16_bf16 v[176:191], v[96:99], v[72:75], v[176:191]
	ds_read_b128 v[80:83], v104 offset:20480
	v_exp_f32 v36, v36
	v_exp_f32 v37, v37
	global_load_dwordx4 a[184:187], v3, s[78:79] offset:2048
	v_exp_f32 v38, v38
	v_exp_f32 v39, v39
	v_exp_f32 v40, v40
	v_exp_f32 v41, v41
	ds_read_b128 v[88:91], v172 offset:0
	ds_read_b128 v[92:95], v172 offset:1024
	s_waitcnt lgkmcnt(3)
	v_mfma_f32_32x32x16_bf16 v[176:191], v[100:103], v[76:79], v[176:191]
	v_exp_f32 v42, v42
	v_exp_f32 v43, v43
	global_load_dwordx4 a[156:159], v3, s[76:77] offset:3072
	v_exp_f32 v44, v44
	v_exp_f32 v45, v45
	v_exp_f32 v46, v46
	global_load_dwordx4 a[188:191], v3, s[78:79] offset:3072
	v_exp_f32 v47, v47
	v_cvt_pk_bf16_f32 v64, v32, v33
	v_cvt_pk_bf16_f32 v65, v34, v35
	v_cvt_pk_bf16_f32 v66, v36, v37
	v_cvt_pk_bf16_f32 v67, v38, v39
	v_cvt_pk_bf16_f32 v68, v40, v41
	v_cvt_pk_bf16_f32 v69, v42, v43
	v_cvt_pk_bf16_f32 v70, v44, v45
	v_cvt_pk_bf16_f32 v71, v46, v47
	s_waitcnt lgkmcnt(2)
	v_mfma_f32_32x32x16_bf16 v[32:47], v[80:83], v[168:171], v[224:239]
	v_mad_u32_u24 v173, v175, 5, v174
	v_exp_f32 v48, v48
	v_exp_f32 v49, v49
	s_add_u32 m0, s66, 0
	s_nop 0
	global_load_lds_dwordx4 v2, s[64:65] offset:0
	v_exp_f32 v50, v50
	v_exp_f32 v51, v51
	s_waitcnt lgkmcnt(1)
	v_mfma_f32_32x32x16_bf16 v[192:207], v[88:91], v[64:67], v[192:207]
	ds_read_b128 v[84:87], v104 offset:16384
	v_exp_f32 v52, v52
	v_exp_f32 v53, v53
	global_load_lds_dwordx4 v2, s[64:65] offset:1024
	v_exp_f32 v54, v54
	v_exp_f32 v55, v55
	v_exp_f32 v56, v56
	v_exp_f32 v57, v57
	ds_read_b128 v[96:99], v173 offset:0
	ds_read_b128 v[100:103], v173 offset:1024
	s_waitcnt lgkmcnt(3)
	v_mfma_f32_32x32x16_bf16 v[192:207], v[92:95], v[68:71], v[192:207]
	v_exp_f32 v58, v58
	v_exp_f32 v59, v59
	global_load_lds_dwordx4 v2, s[64:65] offset:2048
	v_exp_f32 v60, v60
	v_exp_f32 v61, v61
	v_exp_f32 v62, v62
	global_load_lds_dwordx4 v2, s[64:65] offset:3072
	v_exp_f32 v63, v63
	v_cvt_pk_bf16_f32 v72, v48, v49
	v_cvt_pk_bf16_f32 v73, v50, v51
	v_cvt_pk_bf16_f32 v74, v52, v53
	v_cvt_pk_bf16_f32 v75, v54, v55
	v_cvt_pk_bf16_f32 v76, v56, v57
	v_cvt_pk_bf16_f32 v77, v58, v59
	v_cvt_pk_bf16_f32 v78, v60, v61
	v_cvt_pk_bf16_f32 v79, v62, v63
	s_waitcnt lgkmcnt(2)
	v_mfma_f32_32x32x16_bf16 v[48:63], v[84:87], v[164:167], v[224:239]
	v_mad_u32_u24 v172, v175, 5, v174
	v_exp_f32 v32, v32
	v_exp_f32 v33, v33
	s_add_u32 m0, s66, 4096
	s_nop 0
	global_load_lds_dwordx4 v3, s[64:65] offset:0
	v_exp_f32 v34, v34
	v_exp_f32 v35, v35
	s_waitcnt lgkmcnt(1)
	v_mfma_f32_32x32x16_bf16 v[176:191], v[96:99], v[72:75], v[176:191]
	ds_read_b128 v[80:83], v104 offset:16384
	v_exp_f32 v36, v36
	v_exp_f32 v37, v37
	global_load_lds_dwordx4 v3, s[64:65] offset:1024
	v_exp_f32 v38, v38
	v_exp_f32 v39, v39
	v_exp_f32 v40, v40
	v_exp_f32 v41, v41
	ds_read_b128 v[88:91], v172 offset:0
	ds_read_b128 v[92:95], v172 offset:1024
	s_waitcnt lgkmcnt(3)
	v_mfma_f32_32x32x16_bf16 v[176:191], v[100:103], v[76:79], v[176:191]
	v_exp_f32 v42, v42
	v_exp_f32 v43, v43
	global_load_lds_dwordx4 v3, s[64:65] offset:2048
	s_add_u32 s64, s64, 28672
	s_addc_u32 s65, s65, 0
	v_exp_f32 v44, v44
	v_exp_f32 v45, v45
	v_exp_f32 v46, v46
	s_add_u32 m0, s66, 28672
	s_nop 0
	global_load_lds_dwordx4 v2, s[64:65] offset:0
	v_exp_f32 v47, v47
	v_cvt_pk_bf16_f32 v64, v32, v33
	v_cvt_pk_bf16_f32 v65, v34, v35
	v_cvt_pk_bf16_f32 v66, v36, v37
	v_cvt_pk_bf16_f32 v67, v38, v39
	v_cvt_pk_bf16_f32 v68, v40, v41
	v_cvt_pk_bf16_f32 v69, v42, v43
	v_cvt_pk_bf16_f32 v70, v44, v45
	v_cvt_pk_bf16_f32 v71, v46, v47
	s_waitcnt lgkmcnt(2)
	v_mfma_f32_32x32x16_bf16 v[32:47], v[80:83], v[168:171], v[224:239]
	v_mad_u32_u24 v173, v175, 4, v174
	v_exp_f32 v48, v48
	v_exp_f32 v49, v49
	global_load_lds_dwordx4 v2, s[64:65] offset:1024
	v_exp_f32 v50, v50
	v_exp_f32 v51, v51
	s_waitcnt lgkmcnt(1)
	v_mfma_f32_32x32x16_bf16 v[192:207], v[88:91], v[64:67], v[192:207]
	ds_read_b128 v[84:87], v104 offset:12288
	v_exp_f32 v52, v52
	v_exp_f32 v53, v53
	global_load_lds_dwordx4 v2, s[64:65] offset:2048
	v_exp_f32 v54, v54
	v_exp_f32 v55, v55
	v_exp_f32 v56, v56
	v_exp_f32 v57, v57
	ds_read_b128 v[96:99], v173 offset:0
	ds_read_b128 v[100:103], v173 offset:1024
	s_waitcnt lgkmcnt(3)
	v_mfma_f32_32x32x16_bf16 v[192:207], v[92:95], v[68:71], v[192:207]
	v_exp_f32 v58, v58
	v_exp_f32 v59, v59
	global_load_lds_dwordx4 v2, s[64:65] offset:3072
	v_exp_f32 v60, v60
	v_exp_f32 v61, v61
	v_exp_f32 v62, v62
	s_add_u32 m0, s66, 32768
	s_nop 0
	global_load_lds_dwordx4 v3, s[64:65] offset:0
	v_exp_f32 v63, v63
	v_cvt_pk_bf16_f32 v72, v48, v49
	v_cvt_pk_bf16_f32 v73, v50, v51
	v_cvt_pk_bf16_f32 v74, v52, v53
	v_cvt_pk_bf16_f32 v75, v54, v55
	v_cvt_pk_bf16_f32 v76, v56, v57
	v_cvt_pk_bf16_f32 v77, v58, v59
	v_cvt_pk_bf16_f32 v78, v60, v61
	v_cvt_pk_bf16_f32 v79, v62, v63
	s_waitcnt lgkmcnt(2)
	v_mfma_f32_32x32x16_bf16 v[48:63], v[84:87], v[164:167], v[112:127]
	v_mad_u32_u24 v172, v175, 4, v174
	v_exp_f32 v32, v32
	v_exp_f32 v33, v33
	global_load_lds_dwordx4 v3, s[64:65] offset:1024
	v_exp_f32 v34, v34
	v_exp_f32 v35, v35
	s_waitcnt lgkmcnt(1)
	v_mfma_f32_32x32x16_bf16 v[176:191], v[96:99], v[72:75], v[176:191]
	ds_read_b128 v[80:83], v104 offset:12288
	v_exp_f32 v36, v36
	v_exp_f32 v37, v37
	global_load_lds_dwordx4 v3, s[64:65] offset:2048
	s_add_u32 s64, s64, 28672
	s_addc_u32 s65, s65, 0
	v_exp_f32 v38, v38
	v_exp_f32 v39, v39
	v_exp_f32 v40, v40
	v_exp_f32 v41, v41
	ds_read_b128 v[88:91], v172 offset:0
	ds_read_b128 v[92:95], v172 offset:1024
	s_waitcnt lgkmcnt(3)
	v_mfma_f32_32x32x16_bf16 v[176:191], v[100:103], v[76:79], v[176:191]
	v_exp_f32 v42, v42
	v_exp_f32 v43, v43
	s_add_u32 m0, s66, 57344
	s_nop 0
	global_load_lds_dwordx4 v2, s[64:65] offset:0
	v_exp_f32 v44, v44
	v_exp_f32 v45, v45
	v_exp_f32 v46, v46
	global_load_lds_dwordx4 v2, s[64:65] offset:1024
	v_exp_f32 v47, v47
	v_cvt_pk_bf16_f32 v64, v32, v33
	v_cvt_pk_bf16_f32 v65, v34, v35
	v_cvt_pk_bf16_f32 v66, v36, v37
	v_cvt_pk_bf16_f32 v67, v38, v39
	v_cvt_pk_bf16_f32 v68, v40, v41
	v_cvt_pk_bf16_f32 v69, v42, v43
	v_cvt_pk_bf16_f32 v70, v44, v45
	v_cvt_pk_bf16_f32 v71, v46, v47
	s_waitcnt lgkmcnt(2)
	v_mfma_f32_32x32x16_bf16 v[32:47], v[80:83], v[168:171], v[112:127]
	v_mad_u32_u24 v173, v175, 3, v174
	v_exp_f32 v48, v48
	v_exp_f32 v49, v49
	global_load_lds_dwordx4 v2, s[64:65] offset:2048
	v_exp_f32 v50, v50
	v_exp_f32 v51, v51
	s_waitcnt lgkmcnt(1)
	v_mfma_f32_32x32x16_bf16 v[192:207], v[88:91], v[64:67], v[192:207]
	ds_read_b128 v[84:87], v104 offset:8192
	v_exp_f32 v52, v52
	v_exp_f32 v53, v53
	global_load_lds_dwordx4 v2, s[64:65] offset:3072
	v_exp_f32 v54, v54
	v_exp_f32 v55, v55
	v_exp_f32 v56, v56
	v_exp_f32 v57, v57
	ds_read_b128 v[96:99], v173 offset:0
	ds_read_b128 v[100:103], v173 offset:1024
	s_waitcnt lgkmcnt(3)
	v_mfma_f32_32x32x16_bf16 v[192:207], v[92:95], v[68:71], v[192:207]
	v_exp_f32 v58, v58
	v_exp_f32 v59, v59
	s_add_u32 m0, s66, 61440
	s_nop 0
	global_load_lds_dwordx4 v3, s[64:65] offset:0
	v_exp_f32 v60, v60
	v_exp_f32 v61, v61
	v_exp_f32 v62, v62
	global_load_lds_dwordx4 v3, s[64:65] offset:1024
	v_exp_f32 v63, v63
	v_cvt_pk_bf16_f32 v72, v48, v49
	v_cvt_pk_bf16_f32 v73, v50, v51
	v_cvt_pk_bf16_f32 v74, v52, v53
	v_cvt_pk_bf16_f32 v75, v54, v55
	v_cvt_pk_bf16_f32 v76, v56, v57
	v_cvt_pk_bf16_f32 v77, v58, v59
	v_cvt_pk_bf16_f32 v78, v60, v61
	v_cvt_pk_bf16_f32 v79, v62, v63
	s_waitcnt lgkmcnt(2)
	v_mfma_f32_32x32x16_bf16 v[48:63], v[84:87], v[164:167], v[112:127]
	v_mad_u32_u24 v172, v175, 3, v174
	v_exp_f32 v32, v32
	v_exp_f32 v33, v33
	global_load_lds_dwordx4 v3, s[64:65] offset:2048
	s_add_u32 s64, s64, 28672
	s_addc_u32 s65, s65, 0
	v_exp_f32 v34, v34
	v_exp_f32 v35, v35
	s_waitcnt lgkmcnt(1)
	v_mfma_f32_32x32x16_bf16 v[176:191], v[96:99], v[72:75], v[176:191]
	ds_read_b128 v[80:83], v104 offset:8192
	v_exp_f32 v36, v36
	v_exp_f32 v37, v37
	global_load_dwordx4 a[0:3], v2, s[72:73] offset:0
	v_exp_f32 v38, v38
	v_exp_f32 v39, v39
	v_exp_f32 v40, v40
	v_exp_f32 v41, v41
	ds_read_b128 v[88:91], v172 offset:0
	ds_read_b128 v[92:95], v172 offset:1024
	s_waitcnt lgkmcnt(3)
	v_mfma_f32_32x32x16_bf16 v[176:191], v[100:103], v[76:79], v[176:191]
	v_exp_f32 v42, v42
	v_exp_f32 v43, v43
	global_load_dwordx4 a[4:7], v2, s[74:75] offset:0
	v_exp_f32 v44, v44
	v_exp_f32 v45, v45
	v_exp_f32 v46, v46
	global_load_dwordx4 a[8:11], v2, s[72:73] offset:1024
	v_exp_f32 v47, v47
	v_cvt_pk_bf16_f32 v64, v32, v33
	v_cvt_pk_bf16_f32 v65, v34, v35
	v_cvt_pk_bf16_f32 v66, v36, v37
	v_cvt_pk_bf16_f32 v67, v38, v39
	v_cvt_pk_bf16_f32 v68, v40, v41
	v_cvt_pk_bf16_f32 v69, v42, v43
	v_cvt_pk_bf16_f32 v70, v44, v45
	v_cvt_pk_bf16_f32 v71, v46, v47
	s_waitcnt lgkmcnt(2)
	v_mfma_f32_32x32x16_bf16 v[32:47], v[80:83], v[168:171], v[240:255]
	v_mad_u32_u24 v173, v175, 2, v174
	v_exp_f32 v48, v48
	v_exp_f32 v49, v49
	global_load_dwordx4 a[12:15], v2, s[74:75] offset:1024
	v_exp_f32 v50, v50
	v_exp_f32 v51, v51
	s_waitcnt lgkmcnt(1)
	v_mfma_f32_32x32x16_bf16 v[192:207], v[88:91], v[64:67], v[192:207]
	ds_read_b128 v[84:87], v104 offset:4096
	v_exp_f32 v52, v52
	v_exp_f32 v53, v53
	global_load_dwordx4 a[16:19], v2, s[72:73] offset:2048
	v_exp_f32 v54, v54
	v_exp_f32 v55, v55
	v_exp_f32 v56, v56
	v_exp_f32 v57, v57
	ds_read_b128 v[96:99], v173 offset:0
	ds_read_b128 v[100:103], v173 offset:1024
	s_waitcnt lgkmcnt(3)
	v_mfma_f32_32x32x16_bf16 v[192:207], v[92:95], v[68:71], v[192:207]
	v_exp_f32 v58, v58
	v_exp_f32 v59, v59
	global_load_dwordx4 a[20:23], v2, s[74:75] offset:2048
	v_exp_f32 v60, v60
	v_exp_f32 v61, v61
	v_exp_f32 v62, v62
	global_load_dwordx4 a[24:27], v2, s[72:73] offset:3072
	v_exp_f32 v63, v63
	v_cvt_pk_bf16_f32 v72, v48, v49
	v_cvt_pk_bf16_f32 v73, v50, v51
	v_cvt_pk_bf16_f32 v74, v52, v53
	v_cvt_pk_bf16_f32 v75, v54, v55
	v_cvt_pk_bf16_f32 v76, v56, v57
	v_cvt_pk_bf16_f32 v77, v58, v59
	v_cvt_pk_bf16_f32 v78, v60, v61
	v_cvt_pk_bf16_f32 v79, v62, v63
	s_waitcnt lgkmcnt(2)
	v_mfma_f32_32x32x16_bf16 v[48:63], v[84:87], v[164:167], v[240:255]
	v_mad_u32_u24 v172, v175, 2, v174
	v_exp_f32 v32, v32
	v_exp_f32 v33, v33
	global_load_dwordx4 a[28:31], v2, s[74:75] offset:3072
	v_exp_f32 v34, v34
	v_exp_f32 v35, v35
	s_waitcnt lgkmcnt(1)
	v_mfma_f32_32x32x16_bf16 v[176:191], v[96:99], v[72:75], v[176:191]
	v_exp_f32 v36, v36
	v_exp_f32 v37, v37
	global_load_dwordx4 a[32:35], v3, s[72:73] offset:0
	v_exp_f32 v38, v38
	v_exp_f32 v39, v39
	v_exp_f32 v40, v40
	v_exp_f32 v41, v41
	ds_read_b128 v[88:91], v172 offset:0
	ds_read_b128 v[92:95], v172 offset:1024
	s_waitcnt lgkmcnt(2)
	v_mfma_f32_32x32x16_bf16 v[176:191], v[100:103], v[76:79], v[176:191]
	v_exp_f32 v42, v42
	v_exp_f32 v43, v43
	global_load_dwordx4 a[36:39], v3, s[74:75] offset:0
	v_exp_f32 v44, v44
	v_exp_f32 v45, v45
	v_exp_f32 v46, v46
	global_load_dwordx4 a[40:43], v3, s[72:73] offset:1024
	v_exp_f32 v47, v47
	v_cvt_pk_bf16_f32 v64, v32, v33
	v_cvt_pk_bf16_f32 v65, v34, v35
	v_cvt_pk_bf16_f32 v66, v36, v37
	v_cvt_pk_bf16_f32 v67, v38, v39
	v_cvt_pk_bf16_f32 v68, v40, v41
	v_cvt_pk_bf16_f32 v69, v42, v43
	v_cvt_pk_bf16_f32 v70, v44, v45
	v_cvt_pk_bf16_f32 v71, v46, v47
	v_mad_u32_u24 v173, v175, 1, v174
	v_exp_f32 v48, v48
	v_exp_f32 v49, v49
	global_load_dwordx4 a[44:47], v3, s[74:75] offset:1024
	v_exp_f32 v50, v50
	v_exp_f32 v51, v51
	s_waitcnt lgkmcnt(1)
	v_mfma_f32_32x32x16_bf16 v[192:207], v[88:91], v[64:67], v[192:207]
	v_exp_f32 v52, v52
	v_exp_f32 v53, v53
	global_load_dwordx4 a[48:51], v3, s[72:73] offset:2048
	v_exp_f32 v54, v54
	v_exp_f32 v55, v55
	v_exp_f32 v56, v56
	v_exp_f32 v57, v57
	ds_read_b128 v[96:99], v173 offset:0
	ds_read_b128 v[100:103], v173 offset:1024
	s_waitcnt lgkmcnt(2)
	v_mfma_f32_32x32x16_bf16 v[192:207], v[92:95], v[68:71], v[192:207]
	v_exp_f32 v58, v58
	v_exp_f32 v59, v59
	global_load_dwordx4 a[52:55], v3, s[74:75] offset:2048
	v_exp_f32 v60, v60
	v_exp_f32 v61, v61
	v_exp_f32 v62, v62
	global_load_dwordx4 a[56:59], v3, s[72:73] offset:3072
	v_exp_f32 v63, v63
	v_cvt_pk_bf16_f32 v72, v48, v49
	v_cvt_pk_bf16_f32 v73, v50, v51
	v_cvt_pk_bf16_f32 v74, v52, v53
	v_cvt_pk_bf16_f32 v75, v54, v55
	v_cvt_pk_bf16_f32 v76, v56, v57
	v_cvt_pk_bf16_f32 v77, v58, v59
	v_cvt_pk_bf16_f32 v78, v60, v61
	v_cvt_pk_bf16_f32 v79, v62, v63
	s_waitcnt lgkmcnt(1)
	v_mfma_f32_32x32x16_bf16 v[176:191], v[96:99], v[72:75], v[176:191]
	s_waitcnt lgkmcnt(0)
	v_mfma_f32_32x32x16_bf16 v[176:191], v[100:103], v[76:79], v[176:191]
L_join_21:
	s_nop 11
	v_min_f32 v23, v184, v200
	v_max_f32 v24, v184, v200
	v_cmp_o_f32 vcc, v184, v200
	s_mov_b64 s[52:53], vcc
	v_cmp_le_f32 vcc, 0x21800000, v23
	s_and_b64 s[52:53], s[52:53], vcc
	v_cmp_ge_f32 vcc, 0x5d800000, v24
	s_and_b64 s[52:53], s[52:53], vcc
	s_cmp_eq_u64 s[52:53], exec
	s_cbranch_scc0 L_fallback_0
	s_nop 1
L_norm_0:
	s_mul_i32 s46, s22, 2359296
	s_lshl_b32 s47, s60, 15
	s_add_u32 s46, s46, s47
	s_lshl_b32 s47, s23, 11
	s_add_u32 s46, s46, s47
	s_lshl_b32 s47, s63, 10
	s_add_u32 s46, s46, s47
	s_add_u32 s46, s46, 10027008
	s_add_u32 s34, s20, s46
	s_addc_u32 s35, s21, 0
	s_mul_i32 s46, s22, 2359296
	s_lshl_b32 s47, s61, 15
	s_add_u32 s46, s46, s47
	s_lshl_b32 s47, s23, 11
	s_add_u32 s46, s46, s47
	s_lshl_b32 s47, s63, 10
	s_add_u32 s46, s46, s47
	s_add_u32 s46, s46, 10027008
	s_add_u32 s36, s20, s46
	s_addc_u32 s37, s21, 0
	v_rcp_f32 v24, v184
	s_nop 0
	v_pk_mul_f32 v[176:177], v[176:177], v[24:25] op_sel_hi:[1,0]
	v_pk_mul_f32 v[178:179], v[178:179], v[24:25] op_sel_hi:[1,0]
	v_pk_mul_f32 v[180:181], v[180:181], v[24:25] op_sel_hi:[1,0]
	v_pk_mul_f32 v[182:183], v[182:183], v[24:25] op_sel_hi:[1,0]
	v_cvt_pk_bf16_f32 v148, v176, v177
	v_cvt_pk_bf16_f32 v149, v178, v179
	v_cvt_pk_bf16_f32 v150, v180, v181
	v_cvt_pk_bf16_f32 v151, v182, v183
	global_store_dwordx4 v2, v[148:151], s[34:35] sc1
	v_rcp_f32 v24, v200
	s_nop 0
	v_pk_mul_f32 v[192:193], v[192:193], v[24:25] op_sel_hi:[1,0]
	v_pk_mul_f32 v[194:195], v[194:195], v[24:25] op_sel_hi:[1,0]
	v_pk_mul_f32 v[196:197], v[196:197], v[24:25] op_sel_hi:[1,0]
	v_pk_mul_f32 v[198:199], v[198:199], v[24:25] op_sel_hi:[1,0]
	v_cvt_pk_bf16_f32 v152, v192, v193
	v_cvt_pk_bf16_f32 v153, v194, v195
	v_cvt_pk_bf16_f32 v154, v196, v197
	v_cvt_pk_bf16_f32 v155, v198, v199
	global_store_dwordx4 v2, v[152:155], s[36:37] sc1
	s_lshl_b32 s46, s22, 8
	s_lshl_b32 s47, s23, 4
	s_add_u32 s46, s46, s47
	s_lshl_b32 s47, s24, 2
	s_add_u32 s46, s46, s47
	s_add_u32 s46, s46, 12288
	s_add_u32 s38, s20, s46
	s_addc_u32 s39, s21, 0
	s_waitcnt vmcnt(0) lgkmcnt(0)
	v_mov_b32 v28, s51
	v_mov_b32 v29, 0
	s_mov_b64 exec, 1
	s_cmp_eq_u32 s25, 1
	s_cbranch_scc1 L_alt_42
	global_store_dword v29, v28, s[38:39] sc1
	s_branch L_join_43
L_alt_42:
	global_store_dword v29, v28, s[38:39]
L_join_43:
	s_mov_b64 exec, -1
	global_load_dwordx4 a[60:63], v3, s[74:75] offset:3072
	global_load_dwordx4 a[64:67], v4, s[72:73] offset:0
	global_load_dwordx4 a[68:71], v4, s[74:75] offset:0
	global_load_dwordx4 a[72:75], v4, s[72:73] offset:1024
	global_load_dwordx4 a[76:79], v4, s[74:75] offset:1024
	global_load_dwordx4 a[80:83], v4, s[72:73] offset:2048
	global_load_dwordx4 a[84:87], v4, s[74:75] offset:2048
	v_lshlrev_b32 v32, 16, v10
	v_and_b32 v33, 0xffff0000, v10
	v_lshlrev_b32 v34, 16, v11
	v_and_b32 v35, 0xffff0000, v11
	v_lshlrev_b32 v36, 16, v12
	v_and_b32 v37, 0xffff0000, v12
	v_lshlrev_b32 v38, 16, v13
	v_and_b32 v39, 0xffff0000, v13
	v_lshlrev_b32 v40, 16, v14
	v_and_b32 v41, 0xffff0000, v14
	v_lshlrev_b32 v42, 16, v15
	v_and_b32 v43, 0xffff0000, v15
	v_lshlrev_b32 v44, 16, v16
	v_and_b32 v45, 0xffff0000, v16
	v_lshlrev_b32 v46, 16, v17
	v_and_b32 v47, 0xffff0000, v17
	s_xor_b32 s40, s70, 0
	s_mul_i32 s46, s22, 2359296
	s_lshl_b32 s47, s40, 15
	s_add_u32 s46, s46, s47
	s_lshl_b32 s47, s24, 13
	s_add_u32 s46, s46, s47
	s_add_u32 s46, s46, 10027008
	s_add_u32 s30, s20, s46
	s_addc_u32 s31, s21, 0
	s_xor_b32 s40, s70, 1
	s_mul_i32 s46, s22, 2359296
	s_lshl_b32 s47, s40, 15
	s_add_u32 s46, s46, s47
	s_lshl_b32 s47, s24, 13
	s_add_u32 s46, s46, s47
	s_add_u32 s46, s46, 10027008
	s_add_u32 s32, s20, s46
	s_addc_u32 s33, s21, 0
	s_lshl_b32 s46, s22, 8
	s_add_u32 s46, s46, 12288
	s_add_u32 s38, s20, s46
	s_addc_u32 s39, s21, 0
	s_mov_b32 s49, 0
	s_nop 1
L_poll_44:
	global_load_dword v28, v1, s[38:39] sc1
	s_waitcnt vmcnt(0)
	v_cmp_ne_u32 vcc, s51, v28
	s_nop 4
	s_cbranch_vccz L_pollout_45
	s_add_u32 s49, s49, 1
	s_cmp_ge_u32 s49, s26
	s_cbranch_scc0 L_poll_44
	s_mov_b32 s26, 1
L_pollout_45:
	global_load_dwordx4 a[192:195], v2, s[30:31] offset:0
	global_load_dwordx4 a[224:227], v2, s[32:33] offset:0
	global_load_dwordx4 a[196:199], v2, s[30:31] offset:1024
	global_load_dwordx4 a[228:231], v2, s[32:33] offset:1024
	global_load_dwordx4 a[200:203], v2, s[30:31] offset:2048
	global_load_dwordx4 a[232:235], v2, s[32:33] offset:2048
	global_load_dwordx4 a[204:207], v2, s[30:31] offset:3072
	global_load_dwordx4 a[236:239], v2, s[32:33] offset:3072
	s_or_b32 s40, s48, s24
	s_nop 1
	s_cmp_lg_u32 s40, 0
	s_cbranch_scc1 L_skip_46
	v_mov_b32 v28, 0
	v_mov_b32 v29, s51
	s_mov_b64 exec, 1
	global_store_dword v28, v29, s[20:21] sc1
	s_mov_b64 exec, -1
	s_nop 4
L_skip_46:
	s_waitcnt vmcnt(7)
	v_mfma_f32_32x32x16_bf16 v[32:47], a[128:131], a[192:195], v[32:47]
	global_load_dwordx4 a[208:211], v3, s[30:31] offset:0
	global_load_dwordx4 a[240:243], v3, s[32:33] offset:0
	s_waitcnt vmcnt(8)
	v_mfma_f32_32x32x16_bf16 v[48:63], a[128:131], a[224:227], 0
	v_mfma_f32_32x32x16_bf16 v[64:79], a[160:163], a[192:195], 0
	v_mfma_f32_32x32x16_bf16 v[80:95], a[160:163], a[224:227], 0
	s_waitcnt vmcnt(7)
	v_mfma_f32_32x32x16_bf16 v[32:47], a[132:135], a[196:199], v[32:47]
	global_load_dwordx4 a[212:215], v3, s[30:31] offset:1024
	global_load_dwordx4 a[244:247], v3, s[32:33] offset:1024
	s_waitcnt vmcnt(8)
	v_mfma_f32_32x32x16_bf16 v[48:63], a[132:135], a[228:231], v[48:63]
	v_mfma_f32_32x32x16_bf16 v[64:79], a[164:167], a[196:199], v[64:79]
	v_mfma_f32_32x32x16_bf16 v[80:95], a[164:167], a[228:231], v[80:95]
	s_waitcnt vmcnt(7)
	v_mfma_f32_32x32x16_bf16 v[32:47], a[136:139], a[200:203], v[32:47]
	global_load_dwordx4 a[216:219], v3, s[30:31] offset:2048
	global_load_dwordx4 a[248:251], v3, s[32:33] offset:2048
	s_waitcnt vmcnt(8)
	v_mfma_f32_32x32x16_bf16 v[48:63], a[136:139], a[232:235], v[48:63]
	v_mfma_f32_32x32x16_bf16 v[64:79], a[168:171], a[200:203], v[64:79]
	v_mfma_f32_32x32x16_bf16 v[80:95], a[168:171], a[232:235], v[80:95]
	s_waitcnt vmcnt(7)
	v_mfma_f32_32x32x16_bf16 v[32:47], a[140:143], a[204:207], v[32:47]
	global_load_dwordx4 a[220:223], v3, s[30:31] offset:3072
	global_load_dwordx4 a[252:255], v3, s[32:33] offset:3072
	s_waitcnt vmcnt(8)
	v_mfma_f32_32x32x16_bf16 v[48:63], a[140:143], a[236:239], v[48:63]
	v_mfma_f32_32x32x16_bf16 v[64:79], a[172:175], a[204:207], v[64:79]
	v_mfma_f32_32x32x16_bf16 v[80:95], a[172:175], a[236:239], v[80:95]
	s_waitcnt vmcnt(7)
	v_mfma_f32_32x32x16_bf16 v[32:47], a[144:147], a[208:211], v[32:47]
	s_add_u32 m0, s66, 86016
	s_nop 0
	global_load_lds_dwordx4 v2, s[64:65] offset:0
	s_waitcnt vmcnt(7)
	v_mfma_f32_32x32x16_bf16 v[48:63], a[144:147], a[240:243], v[48:63]
	global_load_lds_dwordx4 v2, s[64:65] offset:1024
	v_mfma_f32_32x32x16_bf16 v[64:79], a[176:179], a[208:211], v[64:79]
	global_load_lds_dwordx4 v2, s[64:65] offset:2048
	v_mfma_f32_32x32x16_bf16 v[80:95], a[176:179], a[240:243], v[80:95]
	global_load_lds_dwordx4 v2, s[64:65] offset:3072
	s_waitcnt vmcnt(9)
	v_mfma_f32_32x32x16_bf16 v[32:47], a[148:151], a[212:215], v[32:47]
	s_add_u32 m0, s66, 90112
	s_nop 0
	global_load_lds_dwordx4 v3, s[64:65] offset:0
	s_waitcnt vmcnt(9)
	v_mfma_f32_32x32x16_bf16 v[48:63], a[148:151], a[244:247], v[48:63]
	global_load_lds_dwordx4 v3, s[64:65] offset:1024
	v_mfma_f32_32x32x16_bf16 v[64:79], a[180:183], a[212:215], v[64:79]
	global_load_lds_dwordx4 v3, s[64:65] offset:2048
	s_add_u32 s64, s64, 28672
	s_addc_u32 s65, s65, 0
	v_mfma_f32_32x32x16_bf16 v[80:95], a[180:183], a[244:247], v[80:95]
	global_load_dwordx4 a[88:91], v4, s[72:73] offset:3072
	s_waitcnt vmcnt(11)
	v_mfma_f32_32x32x16_bf16 v[32:47], a[152:155], a[216:219], v[32:47]
	global_load_dwordx4 a[92:95], v4, s[74:75] offset:3072
	s_waitcnt vmcnt(11)
	v_mfma_f32_32x32x16_bf16 v[48:63], a[152:155], a[248:251], v[48:63]
	global_load_dwordx4 a[96:99], v5, s[72:73] offset:0
	v_mfma_f32_32x32x16_bf16 v[64:79], a[184:187], a[216:219], v[64:79]
	global_load_dwordx4 a[100:103], v5, s[74:75] offset:0
	v_mfma_f32_32x32x16_bf16 v[80:95], a[184:187], a[248:251], v[80:95]
	global_load_dwordx4 a[104:107], v5, s[72:73] offset:1024
	s_waitcnt vmcnt(13)
	v_mfma_f32_32x32x16_bf16 v[32:47], a[156:159], a[220:223], v[32:47]
	global_load_dwordx4 a[108:111], v5, s[74:75] offset:1024
	s_waitcnt vmcnt(13)
	v_mfma_f32_32x32x16_bf16 v[48:63], a[156:159], a[252:255], v[48:63]
	global_load_dwordx4 a[112:115], v5, s[72:73] offset:2048
	v_mfma_f32_32x32x16_bf16 v[64:79], a[188:191], a[220:223], v[64:79]
	v_mfma_f32_32x32x16_bf16 v[80:95], a[188:191], a[252:255], v[80:95]
	s_xor_b32 s40, s24, 1
	s_mul_i32 s40, s40, 12288
	s_add_u32 s40, s40, 114688
	v_add_u32 v21, s40, v2
	s_xor_b32 s40, s24, 2
	s_mul_i32 s40, s40, 12288
	s_add_u32 s40, s40, 118784
	v_add_u32 v22, s40, v2
	s_xor_b32 s40, s24, 3
	s_mul_i32 s40, s40, 12288
	s_add_u32 s40, s40, 122880
	v_add_u32 v23, s40, v2
	ds_write_b128 v21, v[48:51] offset:0
	ds_write_b128 v21, v[52:55] offset:1024
	ds_write_b128 v21, v[56:59] offset:2048
	ds_write_b128 v21, v[60:63] offset:3072
	ds_write_b128 v22, v[64:67] offset:0
	ds_write_b128 v22, v[68:71] offset:1024
	ds_write_b128 v22, v[72:75] offset:2048
	ds_write_b128 v22, v[76:79] offset:3072
	ds_write_b128 v23, v[80:83] offset:0
	ds_write_b128 v23, v[84:87] offset:1024
	ds_write_b128 v23, v[88:91] offset:2048
	ds_write_b128 v23, v[92:95] offset:3072
	s_mul_i32 s40, s24, 12288
	s_add_u32 s40, s40, 114688
	v_add_u32 v20, s40, v2
	s_waitcnt lgkmcnt(0)
	s_barrier
	ds_read_b128 v[96:99], v20 offset:0
	ds_read_b128 v[100:103], v20 offset:1024
	ds_read_b128 v[104:107], v20 offset:2048
	ds_read_b128 v[108:111], v20 offset:3072
	ds_read_b128 v[112:115], v20 offset:4096
	ds_read_b128 v[116:119], v20 offset:5120
	ds_read_b128 v[120:123], v20 offset:6144
	ds_read_b128 v[124:127], v20 offset:7168
	ds_read_b128 v[128:131], v20 offset:8192
	ds_read_b128 v[132:135], v20 offset:9216
	ds_read_b128 v[136:139], v20 offset:10240
	ds_read_b128 v[140:143], v20 offset:11264
	s_waitcnt lgkmcnt(11)
	v_pk_add_f32 v[32:33], v[32:33], v[96:97]
	v_pk_add_f32 v[34:35], v[34:35], v[98:99]
	s_waitcnt lgkmcnt(10)
	v_pk_add_f32 v[36:37], v[36:37], v[100:101]
	v_pk_add_f32 v[38:39], v[38:39], v[102:103]
	s_waitcnt lgkmcnt(9)
	v_pk_add_f32 v[40:41], v[40:41], v[104:105]
	v_pk_add_f32 v[42:43], v[42:43], v[106:107]
	s_waitcnt lgkmcnt(8)
	v_pk_add_f32 v[44:45], v[44:45], v[108:109]
	v_pk_add_f32 v[46:47], v[46:47], v[110:111]
	s_waitcnt lgkmcnt(7)
	v_pk_add_f32 v[32:33], v[32:33], v[112:113]
	v_pk_add_f32 v[34:35], v[34:35], v[114:115]
	s_waitcnt lgkmcnt(6)
	v_pk_add_f32 v[36:37], v[36:37], v[116:117]
	v_pk_add_f32 v[38:39], v[38:39], v[118:119]
	s_waitcnt lgkmcnt(5)
	v_pk_add_f32 v[40:41], v[40:41], v[120:121]
	v_pk_add_f32 v[42:43], v[42:43], v[122:123]
	s_waitcnt lgkmcnt(4)
	v_pk_add_f32 v[44:45], v[44:45], v[124:125]
	v_pk_add_f32 v[46:47], v[46:47], v[126:127]
	s_waitcnt lgkmcnt(3)
	v_pk_add_f32 v[32:33], v[32:33], v[128:129]
	v_pk_add_f32 v[34:35], v[34:35], v[130:131]
	s_waitcnt lgkmcnt(2)
	v_pk_add_f32 v[36:37], v[36:37], v[132:133]
	v_pk_add_f32 v[38:39], v[38:39], v[134:135]
	s_waitcnt lgkmcnt(1)
	v_pk_add_f32 v[40:41], v[40:41], v[136:137]
	v_pk_add_f32 v[42:43], v[42:43], v[138:139]
	s_waitcnt lgkmcnt(0)
	v_pk_add_f32 v[44:45], v[44:45], v[140:141]
	v_pk_add_f32 v[46:47], v[46:47], v[142:143]
	v_cvt_pk_bf16_f32 v10, v32, v33
	v_cvt_pk_bf16_f32 v11, v34, v35
	v_cvt_pk_bf16_f32 v12, v36, v37
	v_cvt_pk_bf16_f32 v13, v38, v39
	v_cvt_pk_bf16_f32 v14, v40, v41
	v_cvt_pk_bf16_f32 v15, v42, v43
	v_cvt_pk_bf16_f32 v16, v44, v45
	v_cvt_pk_bf16_f32 v17, v46, v47
	s_mul_i32 s46, s22, 2359296
	s_lshl_b32 s47, s70, 15
	s_add_u32 s46, s46, s47
	s_lshl_b32 s47, s29, 11
	s_add_u32 s46, s46, s47
	s_add_u32 s46, s46, 9568256
	s_add_u32 s34, s20, s46
	s_addc_u32 s35, s21, 0
	global_store_dwordx4 v2, v[10:13], s[34:35] offset:0 sc1
	global_store_dwordx4 v2, v[14:17], s[34:35] offset:1024 sc1
	s_mul_i32 s46, s22, 2359296
	s_lshl_b32 s47, s70, 12
	s_add_u32 s46, s46, s47
	s_lshl_b32 s47, s29, 8
	s_add_u32 s46, s46, s47
	s_add_u32 s46, s46, 9977856
	s_add_u32 s36, s20, s46
	s_addc_u32 s37, s21, 0
	v_pk_add_f32 v[96:97], v[32:33], v[34:35]
	v_pk_mul_f32 v[98:99], v[32:33], v[32:33]
	v_pk_fma_f32 v[98:99], v[34:35], v[34:35], v[98:99]
	v_pk_add_f32 v[96:97], v[96:97], v[36:37]
	v_pk_fma_f32 v[98:99], v[36:37], v[36:37], v[98:99]
	v_pk_add_f32 v[96:97], v[96:97], v[38:39]
	v_pk_fma_f32 v[98:99], v[38:39], v[38:39], v[98:99]
	v_pk_add_f32 v[96:97], v[96:97], v[40:41]
	v_pk_fma_f32 v[98:99], v[40:41], v[40:41], v[98:99]
	v_pk_add_f32 v[96:97], v[96:97], v[42:43]
	v_pk_fma_f32 v[98:99], v[42:43], v[42:43], v[98:99]
	v_pk_add_f32 v[96:97], v[96:97], v[44:45]
	v_pk_fma_f32 v[98:99], v[44:45], v[44:45], v[98:99]
	v_pk_add_f32 v[96:97], v[96:97], v[46:47]
	v_pk_fma_f32 v[98:99], v[46:47], v[46:47], v[98:99]
	v_add_f32 v96, v96, v97
	v_add_f32 v98, v98, v99
	s_nop 1
	v_permlane32_swap_b32 v96, v98
	v_add_f32 v96, v96, v98
	global_store_dword v1, v96, s[36:37] sc1
	s_lshl_b32 s46, s22, 8
	s_lshl_b32 s47, s23, 4
	s_add_u32 s46, s46, s47
	s_lshl_b32 s47, s24, 2
	s_add_u32 s46, s46, s47
	s_add_u32 s46, s46, 16384
	s_add_u32 s38, s20, s46
	s_addc_u32 s39, s21, 0
	s_waitcnt vmcnt(0) lgkmcnt(0)
	v_mov_b32 v28, s51
	v_mov_b32 v29, 0
	s_mov_b64 exec, 1
	s_cmp_eq_u32 s25, 1
	s_cbranch_scc1 L_alt_47
	global_store_dword v29, v28, s[38:39] sc1
	s_branch L_join_48
L_alt_47:
	global_store_dword v29, v28, s[38:39]
L_join_48:
	s_mov_b64 exec, -1
	global_load_dwordx4 a[116:119], v5, s[74:75] offset:2048
	global_load_dwordx4 a[120:123], v5, s[72:73] offset:3072
	global_load_dwordx4 a[124:127], v5, s[74:75] offset:3072
	s_mul_i32 s46, s22, 2359296
	s_lshl_b32 s47, s24, 15
	s_add_u32 s46, s46, s47
	s_add_u32 s46, s46, 9568256
	s_add_u32 s30, s20, s46
	s_addc_u32 s31, s21, 0
	s_mul_i32 s46, s23, 7168
	s_add_u32 s46, s46, 720896
	s_add_u32 s34, s20, s46
	s_addc_u32 s35, s21, 0
	v_and_b32 v24, 15, v0
	v_bfe_u32 v25, v0, 4, 1
	v_lshlrev_b32 v24, 4, v24
	v_lshrrev_b32 v22, 5, v0
	v_lshl_add_u32 v24, v25, 9, v24
	v_mul_u32_u24 v23, 7168, v22
	v_lshl_add_u32 v20, v22, 10, v24
	v_add_u32 v21, v23, v24
	v_lshl_add_u32 v24, v22, 8, v24
	v_add_u32 v22, 57344, v21
	v_add_u32 v23, 114688, v21
	v_add_u32 v25, 4096, v24
	s_lshl_b32 s46, s22, 8
	s_add_u32 s46, s46, 16384
	s_add_u32 s38, s20, s46
	s_addc_u32 s39, s21, 0
	s_mov_b32 s49, 0
	s_nop 1
L_poll_49:
	global_load_dword v28, v1, s[38:39] sc1
	s_waitcnt vmcnt(0)
	v_cmp_ne_u32 vcc, s51, v28
	s_nop 4
	s_cbranch_vccz L_pollout_50
	s_add_u32 s49, s49, 1
	s_cmp_ge_u32 s49, s26
	s_cbranch_scc0 L_poll_49
	s_mov_b32 s26, 1
L_pollout_50:
	global_load_dwordx4 a[128:131], v20, s[30:31] offset:0
	global_load_dwordx4 a[132:135], v20, s[30:31] offset:256
	global_load_dwordx4 a[136:139], v20, s[30:31] offset:2048
	global_load_dwordx4 a[140:143], v20, s[30:31] offset:2304
	s_add_u32 s30, s30, 4096
	s_addc_u32 s31, s31, 0
	s_mul_i32 s46, s22, 2359296
	s_lshl_b32 s47, s24, 12
	s_add_u32 s46, s46, s47
	s_add_u32 s46, s46, 9977856
	s_add_u32 s32, s20, s46
	s_addc_u32 s33, s21, 0
	global_load_dword v200, v1, s[32:33] offset:0
	global_load_dword v201, v1, s[32:33] offset:256
	global_load_dword v202, v1, s[32:33] offset:512
	global_load_dword v203, v1, s[32:33] offset:768
	global_load_dword v204, v1, s[32:33] offset:1024
	global_load_dword v205, v1, s[32:33] offset:1280
	global_load_dword v206, v1, s[32:33] offset:1536
	global_load_dword v207, v1, s[32:33] offset:1792
	global_load_dword v208, v1, s[32:33] offset:2048
	global_load_dword v209, v1, s[32:33] offset:2304
	global_load_dword v210, v1, s[32:33] offset:2560
	global_load_dword v211, v1, s[32:33] offset:2816
	global_load_dword v212, v1, s[32:33] offset:3072
	global_load_dword v213, v1, s[32:33] offset:3328
	global_load_dword v214, v1, s[32:33] offset:3584
	global_load_dword v215, v1, s[32:33] offset:3840
	global_load_dwordx4 a[144:147], v20, s[30:31] offset:0
	global_load_dwordx4 a[148:151], v20, s[30:31] offset:256
	ds_read_b128 v[144:147], v21 offset:0
	ds_read_b128 v[148:151], v21 offset:256
	ds_read_b128 v[152:155], v21 offset:1024
	ds_read_b128 v[156:159], v21 offset:1280
	ds_read_b128 v[160:163], v21 offset:2048
	ds_read_b128 v[164:167], v21 offset:2304
	ds_read_b128 v[168:171], v21 offset:3072
	s_waitcnt vmcnt(21) lgkmcnt(6)
	v_mfma_f32_16x16x32_bf16 v[32:35], v[144:147], a[128:131], 0
	ds_read_b128 v[172:175], v21 offset:3328
	s_waitcnt vmcnt(20)
	v_mfma_f32_16x16x32_bf16 v[36:39], v[144:147], a[132:135], 0
	global_load_dwordx4 a[152:155], v20, s[30:31] offset:2048
	s_waitcnt lgkmcnt(6)
	v_mfma_f32_16x16x32_bf16 v[40:43], v[148:151], a[128:131], 0
	ds_read_b128 v[176:179], v21 offset:4096
	v_mfma_f32_16x16x32_bf16 v[44:47], v[148:151], a[132:135], 0
	s_waitcnt lgkmcnt(6)
	v_mfma_f32_16x16x32_bf16 v[48:51], v[152:155], a[128:131], 0
	ds_read_b128 v[180:183], v21 offset:4352
	v_mfma_f32_16x16x32_bf16 v[52:55], v[152:155], a[132:135], 0
	s_add_u32 m0, s66, 114688
	s_nop 0
	global_load_lds_dwordx4 v2, s[64:65] offset:0
	s_waitcnt lgkmcnt(6)
	v_mfma_f32_16x16x32_bf16 v[56:59], v[156:159], a[128:131], 0
	ds_read_b128 v[184:187], v21 offset:5120
	v_mfma_f32_16x16x32_bf16 v[60:63], v[156:159], a[132:135], 0
	s_waitcnt lgkmcnt(6)
	v_mfma_f32_16x16x32_bf16 v[64:67], v[160:163], a[128:131], 0
	ds_read_b128 v[188:191], v21 offset:5376
	v_mfma_f32_16x16x32_bf16 v[68:71], v[160:163], a[132:135], 0
	global_load_lds_dwordx4 v2, s[64:65] offset:1024
	s_waitcnt lgkmcnt(6)
	v_mfma_f32_16x16x32_bf16 v[72:75], v[164:167], a[128:131], 0
	ds_read_b128 v[192:195], v21 offset:6144
	v_mfma_f32_16x16x32_bf16 v[76:79], v[164:167], a[132:135], 0
	s_waitcnt lgkmcnt(6)
	v_mfma_f32_16x16x32_bf16 v[80:83], v[168:171], a[128:131], 0
	ds_read_b128 v[196:199], v21 offset:6400
	v_mfma_f32_16x16x32_bf16 v[84:87], v[168:171], a[132:135], 0
	s_waitcnt lgkmcnt(6)
	v_mfma_f32_16x16x32_bf16 v[88:91], v[172:175], a[128:131], 0
	ds_read_b128 v[144:147], v21 offset:14336
	v_mfma_f32_16x16x32_bf16 v[92:95], v[172:175], a[132:135], 0
	global_load_dwordx4 a[156:159], v20, s[30:31] offset:2304
	s_add_u32 s30, s30, 4096
	s_addc_u32 s31, s31, 0
	s_waitcnt lgkmcnt(6)
	v_mfma_f32_16x16x32_bf16 v[96:99], v[176:179], a[128:131], 0
	ds_read_b128 v[148:151], v21 offset:14592
	v_mfma_f32_16x16x32_bf16 v[100:103], v[176:179], a[132:135], 0
	s_waitcnt lgkmcnt(6)
	v_mfma_f32_16x16x32_bf16 v[104:107], v[180:183], a[128:131], 0
	ds_read_b128 v[152:155], v21 offset:15360
	v_mfma_f32_16x16x32_bf16 v[108:111], v[180:183], a[132:135], 0
	global_load_lds_dwordx4 v2, s[64:65] offset:2048
	s_waitcnt lgkmcnt(6)
	v_mfma_f32_16x16x32_bf16 v[112:115], v[184:187], a[128:131], 0
	ds_read_b128 v[156:159], v21 offset:15616
	v_mfma_f32_16x16x32_bf16 v[116:119], v[184:187], a[132:135], 0
	s_waitcnt lgkmcnt(6)
	v_mfma_f32_16x16x32_bf16 v[120:123], v[188:191], a[128:131], 0
	ds_read_b128 v[160:163], v21 offset:16384
	v_mfma_f32_16x16x32_bf16 v[124:127], v[188:191], a[132:135], 0
	global_load_lds_dwordx4 v2, s[64:65] offset:3072
	s_waitcnt lgkmcnt(6)
	v_mfma_f32_16x16x32_bf16 v[128:131], v[192:195], a[128:131], 0
	ds_read_b128 v[164:167], v21 offset:16640
	v_mfma_f32_16x16x32_bf16 v[132:135], v[192:195], a[132:135], 0
	s_waitcnt lgkmcnt(6)
	v_mfma_f32_16x16x32_bf16 v[136:139], v[196:199], a[128:131], 0
	ds_read_b128 v[168:171], v21 offset:17408
	v_mfma_f32_16x16x32_bf16 v[140:143], v[196:199], a[132:135], 0
	s_waitcnt vmcnt(25) lgkmcnt(6)
	v_mfma_f32_16x16x32_bf16 v[32:35], v[144:147], a[136:139], v[32:35]
	ds_read_b128 v[172:175], v21 offset:17664
	s_waitcnt vmcnt(24)
	v_mfma_f32_16x16x32_bf16 v[36:39], v[144:147], a[140:143], v[36:39]
	global_load_dwordx4 a[160:163], v20, s[30:31] offset:0
	s_waitcnt lgkmcnt(6)
	v_mfma_f32_16x16x32_bf16 v[40:43], v[148:151], a[136:139], v[40:43]
	ds_read_b128 v[176:179], v21 offset:18432
	v_mfma_f32_16x16x32_bf16 v[44:47], v[148:151], a[140:143], v[44:47]
	s_waitcnt lgkmcnt(6)
	v_mfma_f32_16x16x32_bf16 v[48:51], v[152:155], a[136:139], v[48:51]
	ds_read_b128 v[180:183], v21 offset:18688
	v_mfma_f32_16x16x32_bf16 v[52:55], v[152:155], a[140:143], v[52:55]
	s_add_u32 m0, s66, 118784
	s_nop 0
	global_load_lds_dwordx4 v3, s[64:65] offset:0
	s_waitcnt lgkmcnt(6)
	v_mfma_f32_16x16x32_bf16 v[56:59], v[156:159], a[136:139], v[56:59]
	ds_read_b128 v[184:187], v21 offset:19456
	v_mfma_f32_16x16x32_bf16 v[60:63], v[156:159], a[140:143], v[60:63]
	s_waitcnt lgkmcnt(6)
	v_mfma_f32_16x16x32_bf16 v[64:67], v[160:163], a[136:139], v[64:67]
	ds_read_b128 v[188:191], v21 offset:19712
	v_mfma_f32_16x16x32_bf16 v[68:71], v[160:163], a[140:143], v[68:71]
	global_load_lds_dwordx4 v3, s[64:65] offset:1024
	s_waitcnt lgkmcnt(6)
	v_mfma_f32_16x16x32_bf16 v[72:75], v[164:167], a[136:139], v[72:75]
	ds_read_b128 v[192:195], v21 offset:20480
	v_mfma_f32_16x16x32_bf16 v[76:79], v[164:167], a[140:143], v[76:79]
	s_waitcnt lgkmcnt(6)
	v_mfma_f32_16x16x32_bf16 v[80:83], v[168:171], a[136:139], v[80:83]
	ds_read_b128 v[196:199], v21 offset:20736
	v_mfma_f32_16x16x32_bf16 v[84:87], v[168:171], a[140:143], v[84:87]
	s_waitcnt lgkmcnt(6)
	v_mfma_f32_16x16x32_bf16 v[88:91], v[172:175], a[136:139], v[88:91]
	ds_read_b128 v[144:147], v21 offset:28672
	v_mfma_f32_16x16x32_bf16 v[92:95], v[172:175], a[140:143], v[92:95]
	global_load_dwordx4 a[164:167], v20, s[30:31] offset:256
	s_waitcnt lgkmcnt(6)
	v_mfma_f32_16x16x32_bf16 v[96:99], v[176:179], a[136:139], v[96:99]
	ds_read_b128 v[148:151], v21 offset:28928
	v_mfma_f32_16x16x32_bf16 v[100:103], v[176:179], a[140:143], v[100:103]
	s_waitcnt lgkmcnt(6)
	v_mfma_f32_16x16x32_bf16 v[104:107], v[180:183], a[136:139], v[104:107]
	ds_read_b128 v[152:155], v21 offset:29696
	v_mfma_f32_16x16x32_bf16 v[108:111], v[180:183], a[140:143], v[108:111]
	global_load_lds_dwordx4 v3, s[64:65] offset:2048
	s_add_u32 s64, s64, 28672
	s_addc_u32 s65, s65, 0
	s_waitcnt lgkmcnt(6)
	v_mfma_f32_16x16x32_bf16 v[112:115], v[184:187], a[136:139], v[112:115]
	ds_read_b128 v[156:159], v21 offset:29952
	v_mfma_f32_16x16x32_bf16 v[116:119], v[184:187], a[140:143], v[116:119]
	s_waitcnt lgkmcnt(6)
	v_mfma_f32_16x16x32_bf16 v[120:123], v[188:191], a[136:139], v[120:123]
	ds_read_b128 v[160:163], v21 offset:30720
	v_mfma_f32_16x16x32_bf16 v[124:127], v[188:191], a[140:143], v[124:127]
	global_load_dwordx4 a[128:131], v6, s[72:73] offset:0
	s_waitcnt lgkmcnt(6)
	v_mfma_f32_16x16x32_bf16 v[128:131], v[192:195], a[136:139], v[128:131]
	ds_read_b128 v[164:167], v21 offset:30976
	v_mfma_f32_16x16x32_bf16 v[132:135], v[192:195], a[140:143], v[132:135]
	s_waitcnt lgkmcnt(6)
	v_mfma_f32_16x16x32_bf16 v[136:139], v[196:199], a[136:139], v[136:139]
	ds_read_b128 v[168:171], v21 offset:31744
	v_mfma_f32_16x16x32_bf16 v[140:143], v[196:199], a[140:143], v[140:143]
	s_waitcnt vmcnt(13) lgkmcnt(6)
	v_mfma_f32_16x16x32_bf16 v[32:35], v[144:147], a[144:147], v[32:35]
	ds_read_b128 v[172:175], v21 offset:32000
	s_waitcnt vmcnt(12)
	v_mfma_f32_16x16x32_bf16 v[36:39], v[144:147], a[148:151], v[36:39]
	global_load_dwordx4 a[168:171], v20, s[30:31] offset:2048
	s_waitcnt lgkmcnt(6)
	v_mfma_f32_16x16x32_bf16 v[40:43], v[148:151], a[144:147], v[40:43]
	ds_read_b128 v[176:179], v21 offset:32768
	v_mfma_f32_16x16x32_bf16 v[44:47], v[148:151], a[148:151], v[44:47]
	v_pk_add_f32 v[200:201], v[200:201], v[208:209]
	s_waitcnt lgkmcnt(6)
	v_mfma_f32_16x16x32_bf16 v[48:51], v[152:155], a[144:147], v[48:51]
	ds_read_b128 v[180:183], v21 offset:33024
	v_mfma_f32_16x16x32_bf16 v[52:55], v[152:155], a[148:151], v[52:55]
	global_load_dwordx4 a[132:135], v6, s[74:75] offset:0
	s_waitcnt lgkmcnt(6)
	v_mfma_f32_16x16x32_bf16 v[56:59], v[156:159], a[144:147], v[56:59]
	ds_read_b128 v[184:187], v21 offset:33792
	v_mfma_f32_16x16x32_bf16 v[60:63], v[156:159], a[148:151], v[60:63]
	v_pk_add_f32 v[202:203], v[202:203], v[210:211]
	s_waitcnt lgkmcnt(6)
	v_mfma_f32_16x16x32_bf16 v[64:67], v[160:163], a[144:147], v[64:67]
	ds_read_b128 v[188:191], v21 offset:34048
	v_mfma_f32_16x16x32_bf16 v[68:71], v[160:163], a[148:151], v[68:71]
	global_load_dwordx4 a[136:139], v6, s[72:73] offset:1024
	s_waitcnt lgkmcnt(6)
	v_mfma_f32_16x16x32_bf16 v[72:75], v[164:167], a[144:147], v[72:75]
	ds_read_b128 v[192:195], v21 offset:34816
	v_mfma_f32_16x16x32_bf16 v[76:79], v[164:167], a[148:151], v[76:79]
	v_pk_add_f32 v[204:205], v[204:205], v[212:213]
	s_waitcnt lgkmcnt(6)
	v_mfma_f32_16x16x32_bf16 v[80:83], v[168:171], a[144:147], v[80:83]
	ds_read_b128 v[196:199], v21 offset:35072
	v_mfma_f32_16x16x32_bf16 v[84:87], v[168:171], a[148:151], v[84:87]
	s_waitcnt lgkmcnt(6)
	v_mfma_f32_16x16x32_bf16 v[88:91], v[172:175], a[144:147], v[88:91]
	ds_read_b128 v[144:147], v21 offset:43008
	v_mfma_f32_16x16x32_bf16 v[92:95], v[172:175], a[148:151], v[92:95]
	global_load_dwordx4 a[172:175], v20, s[30:31] offset:2304
	s_add_u32 s30, s30, 4096
	s_addc_u32 s31, s31, 0
	s_waitcnt lgkmcnt(6)
	v_mfma_f32_16x16x32_bf16 v[96:99], v[176:179], a[144:147], v[96:99]
	ds_read_b128 v[148:151], v21 offset:43264
	v_mfma_f32_16x16x32_bf16 v[100:103], v[176:179], a[148:151], v[100:103]
	v_pk_add_f32 v[206:207], v[206:207], v[214:215]
	s_waitcnt lgkmcnt(6)
	v_mfma_f32_16x16x32_bf16 v[104:107], v[180:183], a[144:147], v[104:107]
	ds_read_b128 v[152:155], v21 offset:44032
	v_mfma_f32_16x16x32_bf16 v[108:111], v[180:183], a[148:151], v[108:111]
	global_load_dwordx4 a[140:143], v6, s[74:75] offset:1024
	s_waitcnt lgkmcnt(6)
	v_mfma_f32_16x16x32_bf16 v[112:115], v[184:187], a[144:147], v[112:115]
	ds_read_b128 v[156:159], v21 offset:44288
	v_mfma_f32_16x16x32_bf16 v[116:119], v[184:187], a[148:151], v[116:119]
	v_pk_add_f32 v[200:201], v[200:201], v[204:205]
	s_waitcnt lgkmcnt(6)
	v_mfma_f32_16x16x32_bf16 v[120:123], v[188:191], a[144:147], v[120:123]
	ds_read_b128 v[160:163], v21 offset:45056
	v_mfma_f32_16x16x32_bf16 v[124:127], v[188:191], a[148:151], v[124:127]
	s_waitcnt lgkmcnt(6)
	v_mfma_f32_16x16x32_bf16 v[128:131], v[192:195], a[144:147], v[128:131]
	ds_read_b128 v[164:167], v21 offset:45312
	v_mfma_f32_16x16x32_bf16 v[132:135], v[192:195], a[148:151], v[132:135]
	v_pk_add_f32 v[202:203], v[202:203], v[206:207]
	s_waitcnt lgkmcnt(6)
	v_mfma_f32_16x16x32_bf16 v[136:139], v[196:199], a[144:147], v[136:139]
	ds_read_b128 v[168:171], v21 offset:46080
	v_mfma_f32_16x16x32_bf16 v[140:143], v[196:199], a[148:151], v[140:143]
	s_waitcnt vmcnt(16) lgkmcnt(6)
	v_mfma_f32_16x16x32_bf16 v[32:35], v[144:147], a[152:155], v[32:35]
	ds_read_b128 v[172:175], v21 offset:46336
	s_waitcnt vmcnt(13)
	v_mfma_f32_16x16x32_bf16 v[36:39], v[144:147], a[156:159], v[36:39]
	global_load_dwordx4 a[176:179], v20, s[30:31] offset:0
	s_waitcnt lgkmcnt(6)
	v_mfma_f32_16x16x32_bf16 v[40:43], v[148:151], a[152:155], v[40:43]
	ds_read_b128 v[176:179], v21 offset:47104
	v_mfma_f32_16x16x32_bf16 v[44:47], v[148:151], a[156:159], v[44:47]
	v_pk_add_f32 v[200:201], v[200:201], v[202:203]
	s_waitcnt lgkmcnt(6)
	v_mfma_f32_16x16x32_bf16 v[48:51], v[152:155], a[152:155], v[48:51]
	ds_read_b128 v[180:183], v21 offset:47360
	v_mfma_f32_16x16x32_bf16 v[52:55], v[152:155], a[156:159], v[52:55]
	global_load_dwordx4 a[144:147], v6, s[72:73] offset:2048
	s_waitcnt lgkmcnt(6)
	v_mfma_f32_16x16x32_bf16 v[56:59], v[156:159], a[152:155], v[56:59]
	ds_read_b128 v[184:187], v21 offset:48128
	v_mfma_f32_16x16x32_bf16 v[60:63], v[156:159], a[156:159], v[60:63]
	v_add_f32 v200, v200, v201
	s_waitcnt lgkmcnt(6)
	v_mfma_f32_16x16x32_bf16 v[64:67], v[160:163], a[152:155], v[64:67]
	ds_read_b128 v[188:191], v21 offset:48384
	v_mfma_f32_16x16x32_bf16 v[68:71], v[160:163], a[156:159], v[68:71]
	global_load_dwordx4 a[148:151], v6, s[74:75] offset:2048
	s_waitcnt lgkmcnt(6)
	v_mfma_f32_16x16x32_bf16 v[72:75], v[164:167], a[152:155], v[72:75]
	ds_read_b128 v[192:195], v21 offset:49152
	v_mfma_f32_16x16x32_bf16 v[76:79], v[164:167], a[156:159], v[76:79]
	v_mov_b32 v201, v200
	s_waitcnt lgkmcnt(6)
	v_mfma_f32_16x16x32_bf16 v[80:83], v[168:171], a[152:155], v[80:83]
	ds_read_b128 v[196:199], v21 offset:49408
	v_mfma_f32_16x16x32_bf16 v[84:87], v[168:171], a[156:159], v[84:87]
	s_barrier
	s_waitcnt lgkmcnt(6)
	v_mfma_f32_16x16x32_bf16 v[88:91], v[172:175], a[152:155], v[88:91]
	ds_read_b128 v[144:147], v22 offset:0
	v_mfma_f32_16x16x32_bf16 v[92:95], v[172:175], a[156:159], v[92:95]
	global_load_dwordx4 a[180:183], v20, s[30:31] offset:256
	s_waitcnt lgkmcnt(6)
	v_mfma_f32_16x16x32_bf16 v[96:99], v[176:179], a[152:155], v[96:99]
	ds_read_b128 v[148:151], v22 offset:256
	v_mfma_f32_16x16x32_bf16 v[100:103], v[176:179], a[156:159], v[100:103]
	v_permlane32_swap_b32 v200, v201
	s_waitcnt lgkmcnt(6)
	v_mfma_f32_16x16x32_bf16 v[104:107], v[180:183], a[152:155], v[104:107]
	ds_read_b128 v[152:155], v22 offset:1024
	v_mfma_f32_16x16x32_bf16 v[108:111], v[180:183], a[156:159], v[108:111]
	s_add_u32 m0, s66, 0
	s_nop 0
	global_load_lds_dwordx4 v2, s[64:65] offset:0
	s_waitcnt lgkmcnt(6)
	v_mfma_f32_16x16x32_bf16 v[112:115], v[184:187], a[152:155], v[112:115]
	ds_read_b128 v[156:159], v22 offset:1280
	v_mfma_f32_16x16x32_bf16 v[116:119], v[184:187], a[156:159], v[116:119]
	v_mul_f32 v200, 0xbb000000, v200
	s_waitcnt lgkmcnt(6)
	v_mfma_f32_16x16x32_bf16 v[120:123], v[188:191], a[152:155], v[120:123]
	ds_read_b128 v[160:163], v22 offset:2048
	v_mfma_f32_16x16x32_bf16 v[124:127], v[188:191], a[156:159], v[124:127]
	global_load_lds_dwordx4 v2, s[64:65] offset:1024
	s_waitcnt lgkmcnt(6)
	v_mfma_f32_16x16x32_bf16 v[128:131], v[192:195], a[152:155], v[128:131]
	ds_read_b128 v[164:167], v22 offset:2304
	v_mfma_f32_16x16x32_bf16 v[132:135], v[192:195], a[156:159], v[132:135]
	v_mul_f32 v201, 0x3b000000, v201
	s_waitcnt lgkmcnt(6)
	v_mfma_f32_16x16x32_bf16 v[136:139], v[196:199], a[152:155], v[136:139]
	ds_read_b128 v[168:171], v22 offset:3072
	v_mfma_f32_16x16x32_bf16 v[140:143], v[196:199], a[156:159], v[140:143]
	s_waitcnt vmcnt(16) lgkmcnt(6)
	v_mfma_f32_16x16x32_bf16 v[32:35], v[144:147], a[160:163], v[32:35]
	ds_read_b128 v[172:175], v22 offset:3328
	s_waitcnt vmcnt(13)
	v_mfma_f32_16x16x32_bf16 v[36:39], v[144:147], a[164:167], v[36:39]
	global_load_dwordx4 a[184:187], v20, s[30:31] offset:2048
	s_waitcnt lgkmcnt(6)
	v_mfma_f32_16x16x32_bf16 v[40:43], v[148:151], a[160:163], v[40:43]
	ds_read_b128 v[176:179], v22 offset:4096
	v_mfma_f32_16x16x32_bf16 v[44:47], v[148:151], a[164:167], v[44:47]
	v_cvt_pk_bf16_f32 v202, v200, v200
	s_waitcnt lgkmcnt(6)
	v_mfma_f32_16x16x32_bf16 v[48:51], v[152:155], a[160:163], v[48:51]
	ds_read_b128 v[180:183], v22 offset:4352
	v_mfma_f32_16x16x32_bf16 v[52:55], v[152:155], a[164:167], v[52:55]
	global_load_lds_dwordx4 v2, s[64:65] offset:2048
	s_waitcnt lgkmcnt(6)
	v_mfma_f32_16x16x32_bf16 v[56:59], v[156:159], a[160:163], v[56:59]
	ds_read_b128 v[184:187], v22 offset:5120
	v_mfma_f32_16x16x32_bf16 v[60:63], v[156:159], a[164:167], v[60:63]
	v_fma_f32 v201, -v200, v200, v201
	s_waitcnt lgkmcnt(6)
	v_mfma_f32_16x16x32_bf16 v[64:67], v[160:163], a[160:163], v[64:67]
	ds_read_b128 v[188:191], v22 offset:5376
	v_mfma_f32_16x16x32_bf16 v[68:71], v[160:163], a[164:167], v[68:71]
	global_load_lds_dwordx4 v2, s[64:65] offset:3072
	s_waitcnt lgkmcnt(6)
	v_mfma_f32_16x16x32_bf16 v[72:75], v[164:167], a[160:163], v[72:75]
	ds_read_b128 v[192:195], v22 offset:6144
	v_mfma_f32_16x16x32_bf16 v[76:79], v[164:167], a[164:167], v[76:79]
	v_lshlrev_b32 v202, 16, v202
	s_waitcnt lgkmcnt(6)
	v_mfma_f32_16x16x32_bf16 v[80:83], v[168:171], a[160:163], v[80:83]
	ds_read_b128 v[196:199], v22 offset:6400
	v_mfma_f32_16x16x32_bf16 v[84:87], v[168:171], a[164:167], v[84:87]
	s_waitcnt lgkmcnt(6)
	v_mfma_f32_16x16x32_bf16 v[88:91], v[172:175], a[160:163], v[88:91]
	ds_read_b128 v[144:147], v22 offset:14336
	v_mfma_f32_16x16x32_bf16 v[92:95], v[172:175], a[164:167], v[92:95]
	global_load_dwordx4 a[188:191], v20, s[30:31] offset:2304
	s_add_u32 s30, s30, 4096
	s_addc_u32 s31, s31, 0
	s_waitcnt lgkmcnt(6)
	v_mfma_f32_16x16x32_bf16 v[96:99], v[176:179], a[160:163], v[96:99]
	ds_read_b128 v[148:151], v22 offset:14592
	v_mfma_f32_16x16x32_bf16 v[100:103], v[176:179], a[164:167], v[100:103]
	v_max_f32 v201, 0, v201
	s_waitcnt lgkmcnt(6)
	v_mfma_f32_16x16x32_bf16 v[104:107], v[180:183], a[160:163], v[104:107]
	ds_read_b128 v[152:155], v22 offset:15360
	v_mfma_f32_16x16x32_bf16 v[108:111], v[180:183], a[164:167], v[108:111]
	s_add_u32 m0, s66, 4096
	s_nop 0
	global_load_lds_dwordx4 v3, s[64:65] offset:0
	s_waitcnt lgkmcnt(6)
	v_mfma_f32_16x16x32_bf16 v[112:115], v[184:187], a[160:163], v[112:115]
	ds_read_b128 v[156:159], v22 offset:15616
	v_mfma_f32_16x16x32_bf16 v[116:119], v[184:187], a[164:167], v[116:119]
	v_sub_f32 v202, v200, v202
	s_waitcnt lgkmcnt(6)
	v_mfma_f32_16x16x32_bf16 v[120:123], v[188:191], a[160:163], v[120:123]
	ds_read_b128 v[160:163], v22 offset:16384
	v_mfma_f32_16x16x32_bf16 v[124:127], v[188:191], a[164:167], v[124:127]
	global_load_lds_dwordx4 v3, s[64:65] offset:1024
	s_waitcnt lgkmcnt(6)
	v_mfma_f32_16x16x32_bf16 v[128:131], v[192:195], a[160:163], v[128:131]
	ds_read_b128 v[164:167], v22 offset:16640
	v_mfma_f32_16x16x32_bf16 v[132:135], v[192:195], a[164:167], v[132:135]
	v_add_f32 v201, 0x3727c5ac, v201
	s_waitcnt lgkmcnt(6)
	v_mfma_f32_16x16x32_bf16 v[136:139], v[196:199], a[160:163], v[136:139]
	ds_read_b128 v[168:171], v22 offset:17408
	v_mfma_f32_16x16x32_bf16 v[140:143], v[196:199], a[164:167], v[140:143]
	s_waitcnt vmcnt(16) lgkmcnt(6)
	v_mfma_f32_16x16x32_bf16 v[32:35], v[144:147], a[168:171], v[32:35]
	ds_read_b128 v[172:175], v22 offset:17664
	s_waitcnt vmcnt(13)
	v_mfma_f32_16x16x32_bf16 v[36:39], v[144:147], a[172:175], v[36:39]
	global_load_dwordx4 a[192:195], v20, s[30:31] offset:0
	s_waitcnt lgkmcnt(6)
	v_mfma_f32_16x16x32_bf16 v[40:43], v[148:151], a[168:171], v[40:43]
	ds_read_b128 v[176:179], v22 offset:18432
	v_mfma_f32_16x16x32_bf16 v[44:47], v[148:151], a[172:175], v[44:47]
	v_cvt_pk_bf16_f32 v203, v200, v202
	s_waitcnt lgkmcnt(6)
	v_mfma_f32_16x16x32_bf16 v[48:51], v[152:155], a[168:171], v[48:51]
	ds_read_b128 v[180:183], v22 offset:18688
	v_mfma_f32_16x16x32_bf16 v[52:55], v[152:155], a[172:175], v[52:55]
	global_load_lds_dwordx4 v3, s[64:65] offset:2048
	s_add_u32 s64, s64, 28672
	s_addc_u32 s65, s65, 0
	s_waitcnt lgkmcnt(6)
	v_mfma_f32_16x16x32_bf16 v[56:59], v[156:159], a[168:171], v[56:59]
	ds_read_b128 v[184:187], v22 offset:19456
	v_mfma_f32_16x16x32_bf16 v[60:63], v[156:159], a[172:175], v[60:63]
	v_rsq_f32 v216, v201
	s_waitcnt lgkmcnt(6)
	v_mfma_f32_16x16x32_bf16 v[64:67], v[160:163], a[168:171], v[64:67]
	ds_read_b128 v[188:191], v22 offset:19712
	v_mfma_f32_16x16x32_bf16 v[68:71], v[160:163], a[172:175], v[68:71]
	global_load_dwordx4 a[152:155], v6, s[72:73] offset:3072
	s_waitcnt lgkmcnt(6)
	v_mfma_f32_16x16x32_bf16 v[72:75], v[164:167], a[168:171], v[72:75]
	ds_read_b128 v[192:195], v22 offset:20480
	v_mfma_f32_16x16x32_bf16 v[76:79], v[164:167], a[172:175], v[76:79]
	v_mul_f32 v216, v216, v216
	s_waitcnt lgkmcnt(6)
	v_mfma_f32_16x16x32_bf16 v[80:83], v[168:171], a[168:171], v[80:83]
	ds_read_b128 v[196:199], v22 offset:20736
	v_mfma_f32_16x16x32_bf16 v[84:87], v[168:171], a[172:175], v[84:87]
	s_barrier
	s_waitcnt lgkmcnt(6)
	v_mfma_f32_16x16x32_bf16 v[88:91], v[172:175], a[168:171], v[88:91]
	ds_read_b128 v[144:147], v22 offset:28672
	v_mfma_f32_16x16x32_bf16 v[92:95], v[172:175], a[172:175], v[92:95]
	global_load_dwordx4 a[196:199], v20, s[30:31] offset:256
	s_waitcnt lgkmcnt(6)
	v_mfma_f32_16x16x32_bf16 v[96:99], v[176:179], a[168:171], v[96:99]
	ds_read_b128 v[148:151], v22 offset:28928
	v_mfma_f32_16x16x32_bf16 v[100:103], v[176:179], a[172:175], v[100:103]
	v_mov_b32 v204, v203
	s_waitcnt lgkmcnt(6)
	v_mfma_f32_16x16x32_bf16 v[104:107], v[180:183], a[168:171], v[104:107]
	ds_read_b128 v[152:155], v22 offset:29696
	v_mfma_f32_16x16x32_bf16 v[108:111], v[180:183], a[172:175], v[108:111]
	s_add_u32 m0, s66, 28672
	s_nop 0
	global_load_lds_dwordx4 v2, s[64:65] offset:0
	s_waitcnt lgkmcnt(6)
	v_mfma_f32_16x16x32_bf16 v[112:115], v[184:187], a[168:171], v[112:115]
	ds_read_b128 v[156:159], v22 offset:29952
	v_mfma_f32_16x16x32_bf16 v[116:119], v[184:187], a[172:175], v[116:119]
	v_mov_b32 v208, v203
	s_waitcnt lgkmcnt(6)
	v_mfma_f32_16x16x32_bf16 v[120:123], v[188:191], a[168:171], v[120:123]
	ds_read_b128 v[160:163], v22 offset:30720
	v_mfma_f32_16x16x32_bf16 v[124:127], v[188:191], a[172:175], v[124:127]
	global_load_lds_dwordx4 v2, s[64:65] offset:1024
	s_waitcnt lgkmcnt(6)
	v_mfma_f32_16x16x32_bf16 v[128:131], v[192:195], a[168:171], v[128:131]
	ds_read_b128 v[164:167], v22 offset:30976
	v_mfma_f32_16x16x32_bf16 v[132:135], v[192:195], a[172:175], v[132:135]
	v_mov_b32 v246, v216
	s_waitcnt lgkmcnt(6)
	v_mfma_f32_16x16x32_bf16 v[136:139], v[196:199], a[168:171], v[136:139]
	ds_read_b128 v[168:171], v22 offset:31744
	v_mfma_f32_16x16x32_bf16 v[140:143], v[196:199], a[172:175], v[140:143]
	s_waitcnt vmcnt(17) lgkmcnt(6)
	v_mfma_f32_16x16x32_bf16 v[32:35], v[144:147], a[176:179], v[32:35]
	ds_read_b128 v[172:175], v22 offset:32000
	s_waitcnt vmcnt(14)
	v_mfma_f32_16x16x32_bf16 v[36:39], v[144:147], a[180:183], v[36:39]
	global_load_dwordx4 a[200:203], v20, s[30:31] offset:2048
	s_waitcnt lgkmcnt(6)
	v_mfma_f32_16x16x32_bf16 v[40:43], v[148:151], a[176:179], v[40:43]
	ds_read_b128 v[176:179], v22 offset:32768
	v_mfma_f32_16x16x32_bf16 v[44:47], v[148:151], a[180:183], v[44:47]
	v_permlane16_swap_b32 v204, v208
	s_waitcnt lgkmcnt(6)
	v_mfma_f32_16x16x32_bf16 v[48:51], v[152:155], a[176:179], v[48:51]
	ds_read_b128 v[180:183], v22 offset:33024
	v_mfma_f32_16x16x32_bf16 v[52:55], v[152:155], a[180:183], v[52:55]
	global_load_lds_dwordx4 v2, s[64:65] offset:2048
	s_waitcnt lgkmcnt(6)
	v_mfma_f32_16x16x32_bf16 v[56:59], v[156:159], a[176:179], v[56:59]
	ds_read_b128 v[184:187], v22 offset:33792
	v_mfma_f32_16x16x32_bf16 v[60:63], v[156:159], a[180:183], v[60:63]
	v_permlane16_swap_b32 v216, v246
	s_waitcnt lgkmcnt(6)
	v_mfma_f32_16x16x32_bf16 v[64:67], v[160:163], a[176:179], v[64:67]
	ds_read_b128 v[188:191], v22 offset:34048
	v_mfma_f32_16x16x32_bf16 v[68:71], v[160:163], a[180:183], v[68:71]
	global_load_lds_dwordx4 v2, s[64:65] offset:3072
	s_waitcnt lgkmcnt(6)
	v_mfma_f32_16x16x32_bf16 v[72:75], v[164:167], a[176:179], v[72:75]
	ds_read_b128 v[192:195], v22 offset:34816
	v_mfma_f32_16x16x32_bf16 v[76:79], v[164:167], a[180:183], v[76:79]
	v_mov_b32 v206, 0
	s_waitcnt lgkmcnt(6)
	v_mfma_f32_16x16x32_bf16 v[80:83], v[168:171], a[176:179], v[80:83]
	ds_read_b128 v[196:199], v22 offset:35072
	v_mfma_f32_16x16x32_bf16 v[84:87], v[168:171], a[180:183], v[84:87]
	s_waitcnt lgkmcnt(6)
	v_mfma_f32_16x16x32_bf16 v[88:91], v[172:175], a[176:179], v[88:91]
	ds_read_b128 v[144:147], v22 offset:43008
	v_mfma_f32_16x16x32_bf16 v[92:95], v[172:175], a[180:183], v[92:95]
	global_load_dwordx4 a[204:207], v20, s[30:31] offset:2304
	s_add_u32 s30, s30, 4096
	s_addc_u32 s31, s31, 0
	s_waitcnt lgkmcnt(6)
	v_mfma_f32_16x16x32_bf16 v[96:99], v[176:179], a[176:179], v[96:99]
	ds_read_b128 v[148:151], v22 offset:43264
	v_mfma_f32_16x16x32_bf16 v[100:103], v[176:179], a[180:183], v[100:103]
	v_mov_b32 v207, 0
	s_waitcnt lgkmcnt(6)
	v_mfma_f32_16x16x32_bf16 v[104:107], v[180:183], a[176:179], v[104:107]
	ds_read_b128 v[152:155], v22 offset:44032
	v_mfma_f32_16x16x32_bf16 v[108:111], v[180:183], a[180:183], v[108:111]
	s_add_u32 m0, s66, 32768
	s_nop 0
	global_load_lds_dwordx4 v3, s[64:65] offset:0
	s_waitcnt lgkmcnt(6)
	v_mfma_f32_16x16x32_bf16 v[112:115], v[184:187], a[176:179], v[112:115]
	ds_read_b128 v[156:159], v22 offset:44288
	v_mfma_f32_16x16x32_bf16 v[116:119], v[184:187], a[180:183], v[116:119]
	v_mov_b32 v210, 0
	s_waitcnt lgkmcnt(6)
	v_mfma_f32_16x16x32_bf16 v[120:123], v[188:191], a[176:179], v[120:123]
	ds_read_b128 v[160:163], v22 offset:45056
	v_mfma_f32_16x16x32_bf16 v[124:127], v[188:191], a[180:183], v[124:127]
	global_load_lds_dwordx4 v3, s[64:65] offset:1024
	s_waitcnt lgkmcnt(6)
	v_mfma_f32_16x16x32_bf16 v[128:131], v[192:195], a[176:179], v[128:131]
	ds_read_b128 v[164:167], v22 offset:45312
	v_mfma_f32_16x16x32_bf16 v[132:135], v[192:195], a[180:183], v[132:135]
	v_mov_b32 v211, 0
	s_waitcnt lgkmcnt(6)
	v_mfma_f32_16x16x32_bf16 v[136:139], v[196:199], a[176:179], v[136:139]
	ds_read_b128 v[168:171], v22 offset:46080
	v_mfma_f32_16x16x32_bf16 v[140:143], v[196:199], a[180:183], v[140:143]
	s_waitcnt vmcnt(17) lgkmcnt(6)
	v_mfma_f32_16x16x32_bf16 v[32:35], v[144:147], a[184:187], v[32:35]
	ds_read_b128 v[172:175], v22 offset:46336
	s_waitcnt vmcnt(14)
	v_mfma_f32_16x16x32_bf16 v[36:39], v[144:147], a[188:191], v[36:39]
	global_load_dwordx4 a[208:211], v20, s[30:31] offset:0
	s_waitcnt lgkmcnt(6)
	v_mfma_f32_16x16x32_bf16 v[40:43], v[148:151], a[184:187], v[40:43]
	ds_read_b128 v[176:179], v22 offset:47104
	v_mfma_f32_16x16x32_bf16 v[44:47], v[148:151], a[188:191], v[44:47]
	v_mov_b32 v205, v204
	s_waitcnt lgkmcnt(6)
	v_mfma_f32_16x16x32_bf16 v[48:51], v[152:155], a[184:187], v[48:51]
	ds_read_b128 v[180:183], v22 offset:47360
	v_mfma_f32_16x16x32_bf16 v[52:55], v[152:155], a[188:191], v[52:55]
	global_load_lds_dwordx4 v3, s[64:65] offset:2048
	s_add_u32 s64, s64, 28672
	s_addc_u32 s65, s65, 0
	s_waitcnt lgkmcnt(6)
	v_mfma_f32_16x16x32_bf16 v[56:59], v[156:159], a[184:187], v[56:59]
	ds_read_b128 v[184:187], v22 offset:48128
	v_mfma_f32_16x16x32_bf16 v[60:63], v[156:159], a[188:191], v[60:63]
	v_mov_b32 v209, v208
	s_waitcnt lgkmcnt(6)
	v_mfma_f32_16x16x32_bf16 v[64:67], v[160:163], a[184:187], v[64:67]
	ds_read_b128 v[188:191], v22 offset:48384
	v_mfma_f32_16x16x32_bf16 v[68:71], v[160:163], a[188:191], v[68:71]
	global_load_dwordx4 a[156:159], v6, s[74:75] offset:3072
	s_waitcnt lgkmcnt(6)
	v_mfma_f32_16x16x32_bf16 v[72:75], v[164:167], a[184:187], v[72:75]
	ds_read_b128 v[192:195], v22 offset:49152
	v_mfma_f32_16x16x32_bf16 v[76:79], v[164:167], a[188:191], v[76:79]
	v_mov_b32 v212, v204
	s_waitcnt lgkmcnt(6)
	v_mfma_f32_16x16x32_bf16 v[80:83], v[168:171], a[184:187], v[80:83]
	ds_read_b128 v[196:199], v22 offset:49408
	v_mfma_f32_16x16x32_bf16 v[84:87], v[168:171], a[188:191], v[84:87]
	s_barrier
	s_waitcnt lgkmcnt(6)
	v_mfma_f32_16x16x32_bf16 v[88:91], v[172:175], a[184:187], v[88:91]
	ds_read_b128 v[144:147], v23 offset:0
	v_mfma_f32_16x16x32_bf16 v[92:95], v[172:175], a[188:191], v[92:95]
	global_load_dwordx4 a[212:215], v20, s[30:31] offset:256
	s_waitcnt lgkmcnt(6)
	v_mfma_f32_16x16x32_bf16 v[96:99], v[176:179], a[184:187], v[96:99]
	ds_read_b128 v[148:151], v23 offset:256
	v_mfma_f32_16x16x32_bf16 v[100:103], v[176:179], a[188:191], v[100:103]
	v_mov_b32 v213, v204
	s_waitcnt lgkmcnt(6)
	v_mfma_f32_16x16x32_bf16 v[104:107], v[180:183], a[184:187], v[104:107]
	ds_read_b128 v[152:155], v23 offset:1024
	v_mfma_f32_16x16x32_bf16 v[108:111], v[180:183], a[188:191], v[108:111]
	s_add_u32 m0, s66, 57344
	s_nop 0
	global_load_lds_dwordx4 v2, s[64:65] offset:0
	s_waitcnt lgkmcnt(6)
	v_mfma_f32_16x16x32_bf16 v[112:115], v[184:187], a[184:187], v[112:115]
	ds_read_b128 v[156:159], v23 offset:1280
	v_mfma_f32_16x16x32_bf16 v[116:119], v[184:187], a[188:191], v[116:119]
	s_waitcnt lgkmcnt(6)
	v_mfma_f32_16x16x32_bf16 v[120:123], v[188:191], a[184:187], v[120:123]
	ds_read_b128 v[160:163], v23 offset:2048
	v_mfma_f32_16x16x32_bf16 v[124:127], v[188:191], a[188:191], v[124:127]
	global_load_lds_dwordx4 v2, s[64:65] offset:1024
	s_waitcnt lgkmcnt(6)
	v_mfma_f32_16x16x32_bf16 v[128:131], v[192:195], a[184:187], v[128:131]
	ds_read_b128 v[164:167], v23 offset:2304
	v_mfma_f32_16x16x32_bf16 v[132:135], v[192:195], a[188:191], v[132:135]
	s_waitcnt lgkmcnt(6)
	v_mfma_f32_16x16x32_bf16 v[136:139], v[196:199], a[184:187], v[136:139]
	ds_read_b128 v[168:171], v23 offset:3072
	v_mfma_f32_16x16x32_bf16 v[140:143], v[196:199], a[188:191], v[140:143]
	s_waitcnt vmcnt(17) lgkmcnt(6)
	v_mfma_f32_16x16x32_bf16 v[32:35], v[144:147], a[192:195], v[32:35]
	ds_read_b128 v[172:175], v23 offset:3328
	s_waitcnt vmcnt(14)
	v_mfma_f32_16x16x32_bf16 v[36:39], v[144:147], a[196:199], v[36:39]
	global_load_dwordx4 a[216:219], v20, s[30:31] offset:2048
	s_waitcnt lgkmcnt(6)
	v_mfma_f32_16x16x32_bf16 v[40:43], v[148:151], a[192:195], v[40:43]
	ds_read_b128 v[176:179], v23 offset:4096
	v_mfma_f32_16x16x32_bf16 v[44:47], v[148:151], a[196:199], v[44:47]
	s_waitcnt lgkmcnt(6)
	v_mfma_f32_16x16x32_bf16 v[48:51], v[152:155], a[192:195], v[48:51]
	ds_read_b128 v[180:183], v23 offset:4352
	v_mfma_f32_16x16x32_bf16 v[52:55], v[152:155], a[196:199], v[52:55]
	global_load_lds_dwordx4 v2, s[64:65] offset:2048
	s_waitcnt lgkmcnt(6)
	v_mfma_f32_16x16x32_bf16 v[56:59], v[156:159], a[192:195], v[56:59]
	ds_read_b128 v[184:187], v23 offset:5120
	v_mfma_f32_16x16x32_bf16 v[60:63], v[156:159], a[196:199], v[60:63]
	s_waitcnt lgkmcnt(6)
	v_mfma_f32_16x16x32_bf16 v[64:67], v[160:163], a[192:195], v[64:67]
	ds_read_b128 v[188:191], v23 offset:5376
	v_mfma_f32_16x16x32_bf16 v[68:71], v[160:163], a[196:199], v[68:71]
	global_load_lds_dwordx4 v2, s[64:65] offset:3072
	s_waitcnt lgkmcnt(6)
	v_mfma_f32_16x16x32_bf16 v[72:75], v[164:167], a[192:195], v[72:75]
	ds_read_b128 v[192:195], v23 offset:6144
	v_mfma_f32_16x16x32_bf16 v[76:79], v[164:167], a[196:199], v[76:79]
	s_waitcnt lgkmcnt(6)
	v_mfma_f32_16x16x32_bf16 v[80:83], v[168:171], a[192:195], v[80:83]
	ds_read_b128 v[196:199], v23 offset:6400
	v_mfma_f32_16x16x32_bf16 v[84:87], v[168:171], a[196:199], v[84:87]
	s_waitcnt lgkmcnt(6)
	v_mfma_f32_16x16x32_bf16 v[88:91], v[172:175], a[192:195], v[88:91]
	ds_read_b128 v[144:147], v23 offset:14336
	v_mfma_f32_16x16x32_bf16 v[92:95], v[172:175], a[196:199], v[92:95]
	global_load_dwordx4 a[220:223], v20, s[30:31] offset:2304
	s_add_u32 s30, s30, 4096
	s_addc_u32 s31, s31, 0
	s_waitcnt lgkmcnt(6)
	v_mfma_f32_16x16x32_bf16 v[96:99], v[176:179], a[192:195], v[96:99]
	ds_read_b128 v[148:151], v23 offset:14592
	v_mfma_f32_16x16x32_bf16 v[100:103], v[176:179], a[196:199], v[100:103]
	s_waitcnt lgkmcnt(6)
	v_mfma_f32_16x16x32_bf16 v[104:107], v[180:183], a[192:195], v[104:107]
	ds_read_b128 v[152:155], v23 offset:15360
	v_mfma_f32_16x16x32_bf16 v[108:111], v[180:183], a[196:199], v[108:111]
	s_add_u32 m0, s66, 61440
	s_nop 0
	global_load_lds_dwordx4 v3, s[64:65] offset:0
	s_waitcnt lgkmcnt(6)
	v_mfma_f32_16x16x32_bf16 v[112:115], v[184:187], a[192:195], v[112:115]
	ds_read_b128 v[156:159], v23 offset:15616
	v_mfma_f32_16x16x32_bf16 v[116:119], v[184:187], a[196:199], v[116:119]
	s_waitcnt lgkmcnt(6)
	v_mfma_f32_16x16x32_bf16 v[120:123], v[188:191], a[192:195], v[120:123]
	ds_read_b128 v[160:163], v23 offset:16384
	v_mfma_f32_16x16x32_bf16 v[124:127], v[188:191], a[196:199], v[124:127]
	global_load_lds_dwordx4 v3, s[64:65] offset:1024
	s_waitcnt lgkmcnt(6)
	v_mfma_f32_16x16x32_bf16 v[128:131], v[192:195], a[192:195], v[128:131]
	ds_read_b128 v[164:167], v23 offset:16640
	v_mfma_f32_16x16x32_bf16 v[132:135], v[192:195], a[196:199], v[132:135]
	s_waitcnt lgkmcnt(6)
	v_mfma_f32_16x16x32_bf16 v[136:139], v[196:199], a[192:195], v[136:139]
	ds_read_b128 v[168:171], v23 offset:17408
	v_mfma_f32_16x16x32_bf16 v[140:143], v[196:199], a[196:199], v[140:143]
	s_waitcnt vmcnt(17) lgkmcnt(6)
	v_mfma_f32_16x16x32_bf16 v[32:35], v[144:147], a[200:203], v[32:35]
	ds_read_b128 v[172:175], v23 offset:17664
	s_waitcnt vmcnt(14)
	v_mfma_f32_16x16x32_bf16 v[36:39], v[144:147], a[204:207], v[36:39]
	global_load_dwordx4 a[224:227], v20, s[30:31] offset:0
	s_waitcnt lgkmcnt(6)
	v_mfma_f32_16x16x32_bf16 v[40:43], v[148:151], a[200:203], v[40:43]
	ds_read_b128 v[176:179], v23 offset:18432
	v_mfma_f32_16x16x32_bf16 v[44:47], v[148:151], a[204:207], v[44:47]
	s_waitcnt lgkmcnt(6)
	v_mfma_f32_16x16x32_bf16 v[48:51], v[152:155], a[200:203], v[48:51]
	ds_read_b128 v[180:183], v23 offset:18688
	v_mfma_f32_16x16x32_bf16 v[52:55], v[152:155], a[204:207], v[52:55]
	global_load_lds_dwordx4 v3, s[64:65] offset:2048
	s_add_u32 s64, s64, 28672
	s_addc_u32 s65, s65, 0
	s_waitcnt lgkmcnt(6)
	v_mfma_f32_16x16x32_bf16 v[56:59], v[156:159], a[200:203], v[56:59]
	ds_read_b128 v[184:187], v23 offset:19456
	v_mfma_f32_16x16x32_bf16 v[60:63], v[156:159], a[204:207], v[60:63]
	s_waitcnt lgkmcnt(6)
	v_mfma_f32_16x16x32_bf16 v[64:67], v[160:163], a[200:203], v[64:67]
	ds_read_b128 v[188:191], v23 offset:19712
	v_mfma_f32_16x16x32_bf16 v[68:71], v[160:163], a[204:207], v[68:71]
	global_load_dwordx4 a[160:163], v7, s[72:73] offset:0
	s_waitcnt lgkmcnt(6)
	v_mfma_f32_16x16x32_bf16 v[72:75], v[164:167], a[200:203], v[72:75]
	ds_read_b128 v[192:195], v23 offset:20480
	v_mfma_f32_16x16x32_bf16 v[76:79], v[164:167], a[204:207], v[76:79]
	s_waitcnt lgkmcnt(6)
	v_mfma_f32_16x16x32_bf16 v[80:83], v[168:171], a[200:203], v[80:83]
	ds_read_b128 v[196:199], v23 offset:20736
	v_mfma_f32_16x16x32_bf16 v[84:87], v[168:171], a[204:207], v[84:87]
	s_barrier
	s_waitcnt lgkmcnt(6)
	v_mfma_f32_16x16x32_bf16 v[88:91], v[172:175], a[200:203], v[88:91]
	ds_read_b128 v[144:147], v21 offset:0
	v_mfma_f32_16x16x32_bf16 v[92:95], v[172:175], a[204:207], v[92:95]
	global_load_dwordx4 a[228:231], v20, s[30:31] offset:256
	s_waitcnt lgkmcnt(6)
	v_mfma_f32_16x16x32_bf16 v[96:99], v[176:179], a[200:203], v[96:99]
	ds_read_b128 v[148:151], v21 offset:256
	v_mfma_f32_16x16x32_bf16 v[100:103], v[176:179], a[204:207], v[100:103]
	s_waitcnt lgkmcnt(6)
	v_mfma_f32_16x16x32_bf16 v[104:107], v[180:183], a[200:203], v[104:107]
	ds_read_b128 v[152:155], v21 offset:1024
	v_mfma_f32_16x16x32_bf16 v[108:111], v[180:183], a[204:207], v[108:111]
	global_load_dwordx4 v[218:221], v2, s[34:35] offset:0
	s_waitcnt lgkmcnt(6)
	v_mfma_f32_16x16x32_bf16 v[112:115], v[184:187], a[200:203], v[112:115]
	ds_read_b128 v[156:159], v21 offset:1280
	v_mfma_f32_16x16x32_bf16 v[116:119], v[184:187], a[204:207], v[116:119]
	s_waitcnt lgkmcnt(6)
	v_mfma_f32_16x16x32_bf16 v[120:123], v[188:191], a[200:203], v[120:123]
	ds_read_b128 v[160:163], v21 offset:2048
	v_mfma_f32_16x16x32_bf16 v[124:127], v[188:191], a[204:207], v[124:127]
	global_load_dwordx4 v[222:225], v2, s[34:35] offset:1024
	s_waitcnt lgkmcnt(6)
	v_mfma_f32_16x16x32_bf16 v[128:131], v[192:195], a[200:203], v[128:131]
	ds_read_b128 v[164:167], v21 offset:2304
	v_mfma_f32_16x16x32_bf16 v[132:135], v[192:195], a[204:207], v[132:135]
	s_waitcnt lgkmcnt(6)
	v_mfma_f32_16x16x32_bf16 v[136:139], v[196:199], a[200:203], v[136:139]
	ds_read_b128 v[168:171], v21 offset:3072
	v_mfma_f32_16x16x32_bf16 v[140:143], v[196:199], a[204:207], v[140:143]
	s_waitcnt vmcnt(17) lgkmcnt(6)
	v_mfma_f32_16x16x32_bf16 v[32:35], v[144:147], a[208:211], v[32:35]
	ds_read_b128 v[172:175], v21 offset:3328
	s_waitcnt vmcnt(14)
	v_mfma_f32_16x16x32_bf16 v[36:39], v[144:147], a[212:215], v[36:39]
	global_load_dwordx4 a[232:235], v20, s[30:31] offset:2048
	s_waitcnt lgkmcnt(6)
	v_mfma_f32_16x16x32_bf16 v[40:43], v[148:151], a[208:211], v[40:43]
	ds_read_b128 v[176:179], v21 offset:4096
	v_mfma_f32_16x16x32_bf16 v[44:47], v[148:151], a[212:215], v[44:47]
	s_waitcnt lgkmcnt(6)
	v_mfma_f32_16x16x32_bf16 v[48:51], v[152:155], a[208:211], v[48:51]
	ds_read_b128 v[180:183], v21 offset:4352
	v_mfma_f32_16x16x32_bf16 v[52:55], v[152:155], a[212:215], v[52:55]
	global_load_dwordx4 v[226:229], v2, s[34:35] offset:2048
	s_waitcnt lgkmcnt(6)
	v_mfma_f32_16x16x32_bf16 v[56:59], v[156:159], a[208:211], v[56:59]
	ds_read_b128 v[184:187], v21 offset:5120
	v_mfma_f32_16x16x32_bf16 v[60:63], v[156:159], a[212:215], v[60:63]
	s_waitcnt lgkmcnt(6)
	v_mfma_f32_16x16x32_bf16 v[64:67], v[160:163], a[208:211], v[64:67]
	ds_read_b128 v[188:191], v21 offset:5376
	v_mfma_f32_16x16x32_bf16 v[68:71], v[160:163], a[212:215], v[68:71]
	global_load_dwordx4 v[230:233], v2, s[34:35] offset:3072
	s_waitcnt lgkmcnt(6)
	v_mfma_f32_16x16x32_bf16 v[72:75], v[164:167], a[208:211], v[72:75]
	ds_read_b128 v[192:195], v21 offset:6144
	v_mfma_f32_16x16x32_bf16 v[76:79], v[164:167], a[212:215], v[76:79]
	s_waitcnt lgkmcnt(6)
	v_mfma_f32_16x16x32_bf16 v[80:83], v[168:171], a[208:211], v[80:83]
	ds_read_b128 v[196:199], v21 offset:6400
	v_mfma_f32_16x16x32_bf16 v[84:87], v[168:171], a[212:215], v[84:87]
	s_waitcnt lgkmcnt(6)
	v_mfma_f32_16x16x32_bf16 v[88:91], v[172:175], a[208:211], v[88:91]
	ds_read_b128 v[144:147], v21 offset:14336
	v_mfma_f32_16x16x32_bf16 v[92:95], v[172:175], a[212:215], v[92:95]
	global_load_dwordx4 a[236:239], v20, s[30:31] offset:2304
	s_add_u32 s30, s30, 4096
	s_addc_u32 s31, s31, 0
	s_waitcnt lgkmcnt(6)
	v_mfma_f32_16x16x32_bf16 v[96:99], v[176:179], a[208:211], v[96:99]
	ds_read_b128 v[148:151], v21 offset:14592
	v_mfma_f32_16x16x32_bf16 v[100:103], v[176:179], a[212:215], v[100:103]
	s_waitcnt lgkmcnt(6)
	v_mfma_f32_16x16x32_bf16 v[104:107], v[180:183], a[208:211], v[104:107]
	ds_read_b128 v[152:155], v21 offset:15360
	v_mfma_f32_16x16x32_bf16 v[108:111], v[180:183], a[212:215], v[108:111]
	global_load_dwordx4 v[234:237], v3, s[34:35] offset:0
	s_waitcnt lgkmcnt(6)
	v_mfma_f32_16x16x32_bf16 v[112:115], v[184:187], a[208:211], v[112:115]
	ds_read_b128 v[156:159], v21 offset:15616
	v_mfma_f32_16x16x32_bf16 v[116:119], v[184:187], a[212:215], v[116:119]
	s_waitcnt lgkmcnt(6)
	v_mfma_f32_16x16x32_bf16 v[120:123], v[188:191], a[208:211], v[120:123]
	ds_read_b128 v[160:163], v21 offset:16384
	v_mfma_f32_16x16x32_bf16 v[124:127], v[188:191], a[212:215], v[124:127]
	global_load_dwordx4 v[238:241], v3, s[34:35] offset:1024
	s_waitcnt lgkmcnt(6)
	v_mfma_f32_16x16x32_bf16 v[128:131], v[192:195], a[208:211], v[128:131]
	ds_read_b128 v[164:167], v21 offset:16640
	v_mfma_f32_16x16x32_bf16 v[132:135], v[192:195], a[212:215], v[132:135]
	s_waitcnt lgkmcnt(6)
	v_mfma_f32_16x16x32_bf16 v[136:139], v[196:199], a[208:211], v[136:139]
	ds_read_b128 v[168:171], v21 offset:17408
	v_mfma_f32_16x16x32_bf16 v[140:143], v[196:199], a[212:215], v[140:143]
	s_waitcnt vmcnt(17) lgkmcnt(6)
	v_mfma_f32_16x16x32_bf16 v[32:35], v[144:147], a[216:219], v[32:35]
	ds_read_b128 v[172:175], v21 offset:17664
	s_waitcnt vmcnt(14)
	v_mfma_f32_16x16x32_bf16 v[36:39], v[144:147], a[220:223], v[36:39]
	global_load_dwordx4 a[240:243], v20, s[30:31] offset:0
	s_waitcnt lgkmcnt(6)
	v_mfma_f32_16x16x32_bf16 v[40:43], v[148:151], a[216:219], v[40:43]
	ds_read_b128 v[176:179], v21 offset:18432
	v_mfma_f32_16x16x32_bf16 v[44:47], v[148:151], a[220:223], v[44:47]
	s_waitcnt lgkmcnt(6)
	v_mfma_f32_16x16x32_bf16 v[48:51], v[152:155], a[216:219], v[48:51]
	ds_read_b128 v[180:183], v21 offset:18688
	v_mfma_f32_16x16x32_bf16 v[52:55], v[152:155], a[220:223], v[52:55]
	global_load_dwordx4 v[242:245], v3, s[34:35] offset:2048
	s_waitcnt lgkmcnt(6)
	v_mfma_f32_16x16x32_bf16 v[56:59], v[156:159], a[216:219], v[56:59]
	ds_read_b128 v[184:187], v21 offset:19456
	v_mfma_f32_16x16x32_bf16 v[60:63], v[156:159], a[220:223], v[60:63]
	s_waitcnt lgkmcnt(6)
	v_mfma_f32_16x16x32_bf16 v[64:67], v[160:163], a[216:219], v[64:67]
	ds_read_b128 v[188:191], v21 offset:19712
	v_mfma_f32_16x16x32_bf16 v[68:71], v[160:163], a[220:223], v[68:71]
	global_load_dwordx4 a[164:167], v7, s[74:75] offset:0
	s_waitcnt lgkmcnt(6)
	v_mfma_f32_16x16x32_bf16 v[72:75], v[164:167], a[216:219], v[72:75]
	ds_read_b128 v[192:195], v21 offset:20480
	v_mfma_f32_16x16x32_bf16 v[76:79], v[164:167], a[220:223], v[76:79]
	s_waitcnt lgkmcnt(6)
	v_mfma_f32_16x16x32_bf16 v[80:83], v[168:171], a[216:219], v[80:83]
	ds_read_b128 v[196:199], v21 offset:20736
	v_mfma_f32_16x16x32_bf16 v[84:87], v[168:171], a[220:223], v[84:87]
	s_barrier
	s_waitcnt lgkmcnt(6)
	v_mfma_f32_16x16x32_bf16 v[88:91], v[172:175], a[216:219], v[88:91]
	ds_read_b128 v[144:147], v21 offset:28672
	v_mfma_f32_16x16x32_bf16 v[92:95], v[172:175], a[220:223], v[92:95]
	global_load_dwordx4 a[244:247], v20, s[30:31] offset:256
	s_waitcnt lgkmcnt(6)
	v_mfma_f32_16x16x32_bf16 v[96:99], v[176:179], a[216:219], v[96:99]
	ds_read_b128 v[148:151], v21 offset:28928
	v_mfma_f32_16x16x32_bf16 v[100:103], v[176:179], a[220:223], v[100:103]
	s_waitcnt lgkmcnt(6)
	v_mfma_f32_16x16x32_bf16 v[104:107], v[180:183], a[216:219], v[104:107]
	ds_read_b128 v[152:155], v21 offset:29696
	v_mfma_f32_16x16x32_bf16 v[108:111], v[180:183], a[220:223], v[108:111]
	global_load_dwordx4 a[168:171], v7, s[72:73] offset:1024
	s_waitcnt lgkmcnt(6)
	v_mfma_f32_16x16x32_bf16 v[112:115], v[184:187], a[216:219], v[112:115]
	ds_read_b128 v[156:159], v21 offset:29952
	v_mfma_f32_16x16x32_bf16 v[116:119], v[184:187], a[220:223], v[116:119]
	s_waitcnt lgkmcnt(6)
	v_mfma_f32_16x16x32_bf16 v[120:123], v[188:191], a[216:219], v[120:123]
	ds_read_b128 v[160:163], v21 offset:30720
	v_mfma_f32_16x16x32_bf16 v[124:127], v[188:191], a[220:223], v[124:127]
	global_load_dwordx4 a[172:175], v7, s[74:75] offset:1024
	s_waitcnt lgkmcnt(6)
	v_mfma_f32_16x16x32_bf16 v[128:131], v[192:195], a[216:219], v[128:131]
	ds_read_b128 v[164:167], v21 offset:30976
	v_mfma_f32_16x16x32_bf16 v[132:135], v[192:195], a[220:223], v[132:135]
	s_waitcnt lgkmcnt(6)
	v_mfma_f32_16x16x32_bf16 v[136:139], v[196:199], a[216:219], v[136:139]
	ds_read_b128 v[168:171], v21 offset:31744
	v_mfma_f32_16x16x32_bf16 v[140:143], v[196:199], a[220:223], v[140:143]
	s_waitcnt vmcnt(17) lgkmcnt(6)
	v_mfma_f32_16x16x32_bf16 v[32:35], v[144:147], a[224:227], v[32:35]
	ds_read_b128 v[172:175], v21 offset:32000
	s_waitcnt vmcnt(14)
	v_mfma_f32_16x16x32_bf16 v[36:39], v[144:147], a[228:231], v[36:39]
	global_load_dwordx4 a[248:251], v20, s[30:31] offset:2048
	s_waitcnt lgkmcnt(6)
	v_mfma_f32_16x16x32_bf16 v[40:43], v[148:151], a[224:227], v[40:43]
	ds_read_b128 v[176:179], v21 offset:32768
	v_mfma_f32_16x16x32_bf16 v[44:47], v[148:151], a[228:231], v[44:47]
	s_waitcnt lgkmcnt(6)
	v_mfma_f32_16x16x32_bf16 v[48:51], v[152:155], a[224:227], v[48:51]
	ds_read_b128 v[180:183], v21 offset:33024
	v_mfma_f32_16x16x32_bf16 v[52:55], v[152:155], a[228:231], v[52:55]
	global_load_dwordx4 a[176:179], v7, s[72:73] offset:2048
	s_waitcnt lgkmcnt(6)
	v_mfma_f32_16x16x32_bf16 v[56:59], v[156:159], a[224:227], v[56:59]
	ds_read_b128 v[184:187], v21 offset:33792
	v_mfma_f32_16x16x32_bf16 v[60:63], v[156:159], a[228:231], v[60:63]
	s_waitcnt lgkmcnt(6)
	v_mfma_f32_16x16x32_bf16 v[64:67], v[160:163], a[224:227], v[64:67]
	ds_read_b128 v[188:191], v21 offset:34048
	v_mfma_f32_16x16x32_bf16 v[68:71], v[160:163], a[228:231], v[68:71]
	global_load_dwordx4 a[180:183], v7, s[74:75] offset:2048
	s_waitcnt lgkmcnt(6)
	v_mfma_f32_16x16x32_bf16 v[72:75], v[164:167], a[224:227], v[72:75]
	ds_read_b128 v[192:195], v21 offset:34816
	v_mfma_f32_16x16x32_bf16 v[76:79], v[164:167], a[228:231], v[76:79]
	s_waitcnt lgkmcnt(6)
	v_mfma_f32_16x16x32_bf16 v[80:83], v[168:171], a[224:227], v[80:83]
	ds_read_b128 v[196:199], v21 offset:35072
	v_mfma_f32_16x16x32_bf16 v[84:87], v[168:171], a[228:231], v[84:87]
	s_waitcnt lgkmcnt(6)
	v_mfma_f32_16x16x32_bf16 v[88:91], v[172:175], a[224:227], v[88:91]
	ds_read_b128 v[144:147], v21 offset:43008
	v_mfma_f32_16x16x32_bf16 v[92:95], v[172:175], a[228:231], v[92:95]
	global_load_dwordx4 a[252:255], v20, s[30:31] offset:2304
	s_waitcnt lgkmcnt(6)
	v_mfma_f32_16x16x32_bf16 v[96:99], v[176:179], a[224:227], v[96:99]
	ds_read_b128 v[148:151], v21 offset:43264
	v_mfma_f32_16x16x32_bf16 v[100:103], v[176:179], a[228:231], v[100:103]
	s_waitcnt lgkmcnt(6)
	v_mfma_f32_16x16x32_bf16 v[104:107], v[180:183], a[224:227], v[104:107]
	ds_read_b128 v[152:155], v21 offset:44032
	v_mfma_f32_16x16x32_bf16 v[108:111], v[180:183], a[228:231], v[108:111]
	global_load_dwordx4 a[184:187], v7, s[72:73] offset:3072
	s_waitcnt lgkmcnt(6)
	v_mfma_f32_16x16x32_bf16 v[112:115], v[184:187], a[224:227], v[112:115]
	ds_read_b128 v[156:159], v21 offset:44288
	v_mfma_f32_16x16x32_bf16 v[116:119], v[184:187], a[228:231], v[116:119]
	s_waitcnt lgkmcnt(6)
	v_mfma_f32_16x16x32_bf16 v[120:123], v[188:191], a[224:227], v[120:123]
	ds_read_b128 v[160:163], v21 offset:45056
	v_mfma_f32_16x16x32_bf16 v[124:127], v[188:191], a[228:231], v[124:127]
	global_load_dwordx4 a[188:191], v7, s[74:75] offset:3072
	s_waitcnt lgkmcnt(6)
	v_mfma_f32_16x16x32_bf16 v[128:131], v[192:195], a[224:227], v[128:131]
	ds_read_b128 v[164:167], v21 offset:45312
	v_mfma_f32_16x16x32_bf16 v[132:135], v[192:195], a[228:231], v[132:135]
	s_waitcnt lgkmcnt(6)
	v_mfma_f32_16x16x32_bf16 v[136:139], v[196:199], a[224:227], v[136:139]
	ds_read_b128 v[168:171], v21 offset:46080
	v_mfma_f32_16x16x32_bf16 v[140:143], v[196:199], a[228:231], v[140:143]
	s_waitcnt vmcnt(17) lgkmcnt(6)
	v_mfma_f32_16x16x32_bf16 v[32:35], v[144:147], a[232:235], v[32:35]
	ds_read_b128 v[172:175], v21 offset:46336
	s_waitcnt vmcnt(14)
	v_mfma_f32_16x16x32_bf16 v[36:39], v[144:147], a[236:239], v[36:39]
	global_load_dwordx4 a[192:195], v8, s[72:73] offset:0
	s_waitcnt lgkmcnt(6)
	v_mfma_f32_16x16x32_bf16 v[40:43], v[148:151], a[232:235], v[40:43]
	ds_read_b128 v[176:179], v21 offset:47104
	v_mfma_f32_16x16x32_bf16 v[44:47], v[148:151], a[236:239], v[44:47]
	s_waitcnt lgkmcnt(6)
	v_mfma_f32_16x16x32_bf16 v[48:51], v[152:155], a[232:235], v[48:51]
	ds_read_b128 v[180:183], v21 offset:47360
	v_mfma_f32_16x16x32_bf16 v[52:55], v[152:155], a[236:239], v[52:55]
	global_load_dwordx4 a[196:199], v8, s[74:75] offset:0
	s_waitcnt lgkmcnt(6)
	v_mfma_f32_16x16x32_bf16 v[56:59], v[156:159], a[232:235], v[56:59]
	ds_read_b128 v[184:187], v21 offset:48128
	v_mfma_f32_16x16x32_bf16 v[60:63], v[156:159], a[236:239], v[60:63]
	s_waitcnt lgkmcnt(6)
	v_mfma_f32_16x16x32_bf16 v[64:67], v[160:163], a[232:235], v[64:67]
	ds_read_b128 v[188:191], v21 offset:48384
	v_mfma_f32_16x16x32_bf16 v[68:71], v[160:163], a[236:239], v[68:71]
	global_load_dwordx4 a[200:203], v8, s[72:73] offset:1024
	s_waitcnt lgkmcnt(6)
	v_mfma_f32_16x16x32_bf16 v[72:75], v[164:167], a[232:235], v[72:75]
	ds_read_b128 v[192:195], v21 offset:49152
	v_mfma_f32_16x16x32_bf16 v[76:79], v[164:167], a[236:239], v[76:79]
	s_waitcnt lgkmcnt(6)
	v_mfma_f32_16x16x32_bf16 v[80:83], v[168:171], a[232:235], v[80:83]
	ds_read_b128 v[196:199], v21 offset:49408
	v_mfma_f32_16x16x32_bf16 v[84:87], v[168:171], a[236:239], v[84:87]
	s_barrier
	s_waitcnt lgkmcnt(6)
	v_mfma_f32_16x16x32_bf16 v[88:91], v[172:175], a[232:235], v[88:91]
	ds_read_b128 v[144:147], v22 offset:0
	v_mfma_f32_16x16x32_bf16 v[92:95], v[172:175], a[236:239], v[92:95]
	global_load_dwordx4 a[204:207], v8, s[74:75] offset:1024
	s_waitcnt lgkmcnt(6)
	v_mfma_f32_16x16x32_bf16 v[96:99], v[176:179], a[232:235], v[96:99]
	ds_read_b128 v[148:151], v22 offset:256
	v_mfma_f32_16x16x32_bf16 v[100:103], v[176:179], a[236:239], v[100:103]
	s_waitcnt lgkmcnt(6)
	v_mfma_f32_16x16x32_bf16 v[104:107], v[180:183], a[232:235], v[104:107]
	ds_read_b128 v[152:155], v22 offset:1024
	v_mfma_f32_16x16x32_bf16 v[108:111], v[180:183], a[236:239], v[108:111]
	global_load_dwordx4 a[208:211], v8, s[72:73] offset:2048
	s_waitcnt lgkmcnt(6)
	v_mfma_f32_16x16x32_bf16 v[112:115], v[184:187], a[232:235], v[112:115]
	ds_read_b128 v[156:159], v22 offset:1280
	v_mfma_f32_16x16x32_bf16 v[116:119], v[184:187], a[236:239], v[116:119]
	s_waitcnt lgkmcnt(6)
	v_mfma_f32_16x16x32_bf16 v[120:123], v[188:191], a[232:235], v[120:123]
	ds_read_b128 v[160:163], v22 offset:2048
	v_mfma_f32_16x16x32_bf16 v[124:127], v[188:191], a[236:239], v[124:127]
	global_load_dwordx4 a[212:215], v8, s[74:75] offset:2048
	s_waitcnt lgkmcnt(6)
	v_mfma_f32_16x16x32_bf16 v[128:131], v[192:195], a[232:235], v[128:131]
	ds_read_b128 v[164:167], v22 offset:2304
	v_mfma_f32_16x16x32_bf16 v[132:135], v[192:195], a[236:239], v[132:135]
	s_waitcnt lgkmcnt(6)
	v_mfma_f32_16x16x32_bf16 v[136:139], v[196:199], a[232:235], v[136:139]
	ds_read_b128 v[168:171], v22 offset:3072
	v_mfma_f32_16x16x32_bf16 v[140:143], v[196:199], a[236:239], v[140:143]
	s_waitcnt vmcnt(17) lgkmcnt(6)
	v_mfma_f32_16x16x32_bf16 v[32:35], v[144:147], a[240:243], v[32:35]
	ds_read_b128 v[172:175], v22 offset:3328
	s_waitcnt vmcnt(14)
	v_mfma_f32_16x16x32_bf16 v[36:39], v[144:147], a[244:247], v[36:39]
	global_load_dwordx4 a[216:219], v8, s[72:73] offset:3072
	s_waitcnt lgkmcnt(6)
	v_mfma_f32_16x16x32_bf16 v[40:43], v[148:151], a[240:243], v[40:43]
	ds_read_b128 v[176:179], v22 offset:4096
	v_mfma_f32_16x16x32_bf16 v[44:47], v[148:151], a[244:247], v[44:47]
	s_waitcnt lgkmcnt(6)
	v_mfma_f32_16x16x32_bf16 v[48:51], v[152:155], a[240:243], v[48:51]
	ds_read_b128 v[180:183], v22 offset:4352
	v_mfma_f32_16x16x32_bf16 v[52:55], v[152:155], a[244:247], v[52:55]
	global_load_dwordx4 a[220:223], v8, s[74:75] offset:3072
	s_waitcnt lgkmcnt(6)
	v_mfma_f32_16x16x32_bf16 v[56:59], v[156:159], a[240:243], v[56:59]
	ds_read_b128 v[184:187], v22 offset:5120
	v_mfma_f32_16x16x32_bf16 v[60:63], v[156:159], a[244:247], v[60:63]
	s_waitcnt lgkmcnt(6)
	v_mfma_f32_16x16x32_bf16 v[64:67], v[160:163], a[240:243], v[64:67]
	ds_read_b128 v[188:191], v22 offset:5376
	v_mfma_f32_16x16x32_bf16 v[68:71], v[160:163], a[244:247], v[68:71]
	s_waitcnt lgkmcnt(6)
	v_mfma_f32_16x16x32_bf16 v[72:75], v[164:167], a[240:243], v[72:75]
	ds_read_b128 v[192:195], v22 offset:6144
	v_mfma_f32_16x16x32_bf16 v[76:79], v[164:167], a[244:247], v[76:79]
	s_waitcnt lgkmcnt(6)
	v_mfma_f32_16x16x32_bf16 v[80:83], v[168:171], a[240:243], v[80:83]
	ds_read_b128 v[196:199], v22 offset:6400
	v_mfma_f32_16x16x32_bf16 v[84:87], v[168:171], a[244:247], v[84:87]
	s_waitcnt lgkmcnt(6)
	v_mfma_f32_16x16x32_bf16 v[88:91], v[172:175], a[240:243], v[88:91]
	ds_read_b128 v[144:147], v22 offset:14336
	v_mfma_f32_16x16x32_bf16 v[92:95], v[172:175], a[244:247], v[92:95]
	s_waitcnt lgkmcnt(6)
	v_mfma_f32_16x16x32_bf16 v[96:99], v[176:179], a[240:243], v[96:99]
	ds_read_b128 v[148:151], v22 offset:14592
	v_mfma_f32_16x16x32_bf16 v[100:103], v[176:179], a[244:247], v[100:103]
	s_waitcnt lgkmcnt(6)
	v_mfma_f32_16x16x32_bf16 v[104:107], v[180:183], a[240:243], v[104:107]
	ds_read_b128 v[152:155], v22 offset:15360
	v_mfma_f32_16x16x32_bf16 v[108:111], v[180:183], a[244:247], v[108:111]
	s_waitcnt lgkmcnt(6)
	v_mfma_f32_16x16x32_bf16 v[112:115], v[184:187], a[240:243], v[112:115]
	ds_read_b128 v[156:159], v22 offset:15616
	v_mfma_f32_16x16x32_bf16 v[116:119], v[184:187], a[244:247], v[116:119]
	s_waitcnt lgkmcnt(6)
	v_mfma_f32_16x16x32_bf16 v[120:123], v[188:191], a[240:243], v[120:123]
	ds_read_b128 v[160:163], v22 offset:16384
	v_mfma_f32_16x16x32_bf16 v[124:127], v[188:191], a[244:247], v[124:127]
	s_waitcnt lgkmcnt(6)
	v_mfma_f32_16x16x32_bf16 v[128:131], v[192:195], a[240:243], v[128:131]
	ds_read_b128 v[164:167], v22 offset:16640
	v_mfma_f32_16x16x32_bf16 v[132:135], v[192:195], a[244:247], v[132:135]
	s_waitcnt lgkmcnt(6)
	v_mfma_f32_16x16x32_bf16 v[136:139], v[196:199], a[240:243], v[136:139]
	ds_read_b128 v[168:171], v22 offset:17408
	v_mfma_f32_16x16x32_bf16 v[140:143], v[196:199], a[244:247], v[140:143]
	s_waitcnt vmcnt(13) lgkmcnt(6)
	v_mfma_f32_16x16x32_bf16 v[32:35], v[144:147], a[248:251], v[32:35]
	ds_read_b128 v[172:175], v22 offset:17664
	s_waitcnt vmcnt(10)
	v_mfma_f32_16x16x32_bf16 v[36:39], v[144:147], a[252:255], v[36:39]
	s_waitcnt lgkmcnt(6)
	v_mfma_f32_16x16x32_bf16 v[40:43], v[148:151], a[248:251], v[40:43]
	ds_read_b128 v[176:179], v22 offset:18432
	v_mfma_f32_16x16x32_bf16 v[44:47], v[148:151], a[252:255], v[44:47]
	s_waitcnt lgkmcnt(6)
	v_mfma_f32_16x16x32_bf16 v[48:51], v[152:155], a[248:251], v[48:51]
	ds_read_b128 v[180:183], v22 offset:18688
	v_mfma_f32_16x16x32_bf16 v[52:55], v[152:155], a[252:255], v[52:55]
	s_waitcnt lgkmcnt(6)
	v_mfma_f32_16x16x32_bf16 v[56:59], v[156:159], a[248:251], v[56:59]
	ds_read_b128 v[184:187], v22 offset:19456
	v_mfma_f32_16x16x32_bf16 v[60:63], v[156:159], a[252:255], v[60:63]
	s_waitcnt lgkmcnt(6)
	v_mfma_f32_16x16x32_bf16 v[64:67], v[160:163], a[248:251], v[64:67]
	ds_read_b128 v[188:191], v22 offset:19712
	v_mfma_f32_16x16x32_bf16 v[68:71], v[160:163], a[252:255], v[68:71]
	s_waitcnt lgkmcnt(6)
	v_mfma_f32_16x16x32_bf16 v[72:75], v[164:167], a[248:251], v[72:75]
	ds_read_b128 v[192:195], v22 offset:20480
	v_mfma_f32_16x16x32_bf16 v[76:79], v[164:167], a[252:255], v[76:79]
	s_waitcnt lgkmcnt(6)
	v_mfma_f32_16x16x32_bf16 v[80:83], v[168:171], a[248:251], v[80:83]
	ds_read_b128 v[196:199], v22 offset:20736
	v_mfma_f32_16x16x32_bf16 v[84:87], v[168:171], a[252:255], v[84:87]
	s_waitcnt lgkmcnt(6)
	v_mfma_f32_16x16x32_bf16 v[88:91], v[172:175], a[248:251], v[88:91]
	v_mfma_f32_16x16x32_bf16 v[92:95], v[172:175], a[252:255], v[92:95]
	s_waitcnt lgkmcnt(5)
	v_mfma_f32_16x16x32_bf16 v[96:99], v[176:179], a[248:251], v[96:99]
	v_mfma_f32_16x16x32_bf16 v[100:103], v[176:179], a[252:255], v[100:103]
	s_waitcnt lgkmcnt(4)
	v_mfma_f32_16x16x32_bf16 v[104:107], v[180:183], a[248:251], v[104:107]
	v_mfma_f32_16x16x32_bf16 v[108:111], v[180:183], a[252:255], v[108:111]
	s_waitcnt lgkmcnt(3)
	v_mfma_f32_16x16x32_bf16 v[112:115], v[184:187], a[248:251], v[112:115]
	v_mfma_f32_16x16x32_bf16 v[116:119], v[184:187], a[252:255], v[116:119]
	s_waitcnt lgkmcnt(2)
	v_mfma_f32_16x16x32_bf16 v[120:123], v[188:191], a[248:251], v[120:123]
	v_mfma_f32_16x16x32_bf16 v[124:127], v[188:191], a[252:255], v[124:127]
	s_waitcnt lgkmcnt(1)
	v_mfma_f32_16x16x32_bf16 v[128:131], v[192:195], a[248:251], v[128:131]
	v_mfma_f32_16x16x32_bf16 v[132:135], v[192:195], a[252:255], v[132:135]
	s_waitcnt lgkmcnt(0)
	v_mfma_f32_16x16x32_bf16 v[136:139], v[196:199], a[248:251], v[136:139]
	v_mfma_f32_16x16x32_bf16 v[140:143], v[196:199], a[252:255], v[140:143]
	s_mul_i32 s46, s22, 2359296
	s_mul_i32 s47, s24, 114688
	s_add_u32 s46, s46, s47
	s_mul_i32 s47, s23, 7168
	s_add_u32 s46, s46, s47
	s_add_u32 s46, s46, 10813440
	s_add_u32 s30, s20, s46
	s_addc_u32 s31, s21, 0
	v_mfma_f32_16x16x32_bf16 v[32:35], v[218:221], v[204:207], v[32:35]
	v_mfma_f32_16x16x32_bf16 v[36:39], v[218:221], v[208:211], v[36:39]
	v_mfma_f32_16x16x32_bf16 v[40:43], v[218:221], v[210:213], v[40:43]
	v_mfma_f32_16x16x32_bf16 v[44:47], v[218:221], v[206:209], v[44:47]
	v_mfma_f32_16x16x32_bf16 v[48:51], v[222:225], v[204:207], v[48:51]
	v_mfma_f32_16x16x32_bf16 v[52:55], v[222:225], v[208:211], v[52:55]
	v_mfma_f32_16x16x32_bf16 v[56:59], v[222:225], v[210:213], v[56:59]
	v_mfma_f32_16x16x32_bf16 v[60:63], v[222:225], v[206:209], v[60:63]
	v_mfma_f32_16x16x32_bf16 v[64:67], v[226:229], v[204:207], v[64:67]
	s_nop 5
	v_pk_mul_f32 v[32:33], v[32:33], v[40:41]
	v_mfma_f32_16x16x32_bf16 v[68:71], v[226:229], v[208:211], v[68:71]
	v_pk_mul_f32 v[34:35], v[34:35], v[42:43]
	v_pk_mul_f32 v[36:37], v[36:37], v[44:45]
	v_pk_mul_f32 v[38:39], v[38:39], v[46:47]
	v_pk_mul_f32 v[32:33], v[32:33], v[216:217] op_sel_hi:[1,0]
	v_mfma_f32_16x16x32_bf16 v[72:75], v[226:229], v[210:213], v[72:75]
	v_pk_mul_f32 v[34:35], v[34:35], v[216:217] op_sel_hi:[1,0]
	v_pk_mul_f32 v[36:37], v[36:37], v[246:247] op_sel_hi:[1,0]
	v_pk_mul_f32 v[38:39], v[38:39], v[246:247] op_sel_hi:[1,0]
	v_cvt_pk_bf16_f32 v144, v32, v33
	v_mfma_f32_16x16x32_bf16 v[76:79], v[226:229], v[206:209], v[76:79]
	v_cvt_pk_bf16_f32 v146, v36, v37
	v_cvt_pk_bf16_f32 v145, v34, v35
	v_cvt_pk_bf16_f32 v147, v38, v39
	v_mfma_f32_16x16x32_bf16 v[80:83], v[230:233], v[204:207], v[80:83]
	v_permlane32_swap_b32 v144, v146
	v_permlane32_swap_b32 v145, v147
	global_store_dwordx4 v24, v[144:147], s[30:31] offset:0 sc1
	v_pk_mul_f32 v[48:49], v[48:49], v[56:57]
	v_mfma_f32_16x16x32_bf16 v[84:87], v[230:233], v[208:211], v[84:87]
	v_pk_mul_f32 v[50:51], v[50:51], v[58:59]
	v_pk_mul_f32 v[52:53], v[52:53], v[60:61]
	v_pk_mul_f32 v[54:55], v[54:55], v[62:63]
	v_pk_mul_f32 v[48:49], v[48:49], v[216:217] op_sel_hi:[1,0]
	v_mfma_f32_16x16x32_bf16 v[88:91], v[230:233], v[210:213], v[88:91]
	v_pk_mul_f32 v[50:51], v[50:51], v[216:217] op_sel_hi:[1,0]
	v_pk_mul_f32 v[52:53], v[52:53], v[246:247] op_sel_hi:[1,0]
	v_pk_mul_f32 v[54:55], v[54:55], v[246:247] op_sel_hi:[1,0]
	v_cvt_pk_bf16_f32 v148, v48, v49
	v_mfma_f32_16x16x32_bf16 v[92:95], v[230:233], v[206:209], v[92:95]
	v_cvt_pk_bf16_f32 v150, v52, v53
	v_cvt_pk_bf16_f32 v149, v50, v51
	v_cvt_pk_bf16_f32 v151, v54, v55
	v_mfma_f32_16x16x32_bf16 v[96:99], v[234:237], v[204:207], v[96:99]
	v_permlane32_swap_b32 v148, v150
	v_permlane32_swap_b32 v149, v151
	global_store_dwordx4 v24, v[148:151], s[30:31] offset:1024 sc1
	v_pk_mul_f32 v[64:65], v[64:65], v[72:73]
	v_mfma_f32_16x16x32_bf16 v[100:103], v[234:237], v[208:211], v[100:103]
	v_pk_mul_f32 v[66:67], v[66:67], v[74:75]
	v_pk_mul_f32 v[68:69], v[68:69], v[76:77]
	v_pk_mul_f32 v[70:71], v[70:71], v[78:79]
	v_pk_mul_f32 v[64:65], v[64:65], v[216:217] op_sel_hi:[1,0]
	v_mfma_f32_16x16x32_bf16 v[104:107], v[234:237], v[210:213], v[104:107]
	v_pk_mul_f32 v[66:67], v[66:67], v[216:217] op_sel_hi:[1,0]
	v_pk_mul_f32 v[68:69], v[68:69], v[246:247] op_sel_hi:[1,0]
	v_pk_mul_f32 v[70:71], v[70:71], v[246:247] op_sel_hi:[1,0]
	v_cvt_pk_bf16_f32 v152, v64, v65
	v_mfma_f32_16x16x32_bf16 v[108:111], v[234:237], v[206:209], v[108:111]
	v_cvt_pk_bf16_f32 v154, v68, v69
	v_cvt_pk_bf16_f32 v153, v66, v67
	v_cvt_pk_bf16_f32 v155, v70, v71
	v_mfma_f32_16x16x32_bf16 v[112:115], v[238:241], v[204:207], v[112:115]
	v_permlane32_swap_b32 v152, v154
	v_permlane32_swap_b32 v153, v155
	global_store_dwordx4 v24, v[152:155], s[30:31] offset:2048 sc1
	v_pk_mul_f32 v[80:81], v[80:81], v[88:89]
	v_mfma_f32_16x16x32_bf16 v[116:119], v[238:241], v[208:211], v[116:119]
	v_pk_mul_f32 v[82:83], v[82:83], v[90:91]
	v_pk_mul_f32 v[84:85], v[84:85], v[92:93]
	v_pk_mul_f32 v[86:87], v[86:87], v[94:95]
	v_pk_mul_f32 v[80:81], v[80:81], v[216:217] op_sel_hi:[1,0]
	v_mfma_f32_16x16x32_bf16 v[120:123], v[238:241], v[210:213], v[120:123]
	v_pk_mul_f32 v[82:83], v[82:83], v[216:217] op_sel_hi:[1,0]
	v_pk_mul_f32 v[84:85], v[84:85], v[246:247] op_sel_hi:[1,0]
	v_pk_mul_f32 v[86:87], v[86:87], v[246:247] op_sel_hi:[1,0]
	v_cvt_pk_bf16_f32 v156, v80, v81
	v_mfma_f32_16x16x32_bf16 v[124:127], v[238:241], v[206:209], v[124:127]
	v_cvt_pk_bf16_f32 v158, v84, v85
	v_cvt_pk_bf16_f32 v157, v82, v83
	v_cvt_pk_bf16_f32 v159, v86, v87
	v_mfma_f32_16x16x32_bf16 v[128:131], v[242:245], v[204:207], v[128:131]
	v_permlane32_swap_b32 v156, v158
	v_permlane32_swap_b32 v157, v159
	global_store_dwordx4 v24, v[156:159], s[30:31] offset:3072 sc1
	v_pk_mul_f32 v[96:97], v[96:97], v[104:105]
	v_mfma_f32_16x16x32_bf16 v[132:135], v[242:245], v[208:211], v[132:135]
	v_pk_mul_f32 v[98:99], v[98:99], v[106:107]
	v_pk_mul_f32 v[100:101], v[100:101], v[108:109]
	v_pk_mul_f32 v[102:103], v[102:103], v[110:111]
	v_pk_mul_f32 v[96:97], v[96:97], v[216:217] op_sel_hi:[1,0]
	v_mfma_f32_16x16x32_bf16 v[136:139], v[242:245], v[210:213], v[136:139]
	v_pk_mul_f32 v[98:99], v[98:99], v[216:217] op_sel_hi:[1,0]
	v_pk_mul_f32 v[100:101], v[100:101], v[246:247] op_sel_hi:[1,0]
	v_pk_mul_f32 v[102:103], v[102:103], v[246:247] op_sel_hi:[1,0]
	v_cvt_pk_bf16_f32 v160, v96, v97
	v_mfma_f32_16x16x32_bf16 v[140:143], v[242:245], v[206:209], v[140:143]
	v_cvt_pk_bf16_f32 v162, v100, v101
	v_cvt_pk_bf16_f32 v161, v98, v99
	v_cvt_pk_bf16_f32 v163, v102, v103
	v_permlane32_swap_b32 v160, v162
	s_nop 0
	v_permlane32_swap_b32 v161, v163
	global_store_dwordx4 v25, v[160:163], s[30:31] offset:0 sc1
	v_pk_mul_f32 v[112:113], v[112:113], v[120:121]
	v_pk_mul_f32 v[114:115], v[114:115], v[122:123]
	v_pk_mul_f32 v[116:117], v[116:117], v[124:125]
	v_pk_mul_f32 v[118:119], v[118:119], v[126:127]
	v_pk_mul_f32 v[112:113], v[112:113], v[216:217] op_sel_hi:[1,0]
	v_pk_mul_f32 v[114:115], v[114:115], v[216:217] op_sel_hi:[1,0]
	v_pk_mul_f32 v[116:117], v[116:117], v[246:247] op_sel_hi:[1,0]
	v_pk_mul_f32 v[118:119], v[118:119], v[246:247] op_sel_hi:[1,0]
	v_cvt_pk_bf16_f32 v164, v112, v113
	v_cvt_pk_bf16_f32 v166, v116, v117
	v_cvt_pk_bf16_f32 v165, v114, v115
	v_cvt_pk_bf16_f32 v167, v118, v119
	v_permlane32_swap_b32 v164, v166
	s_nop 0
	v_permlane32_swap_b32 v165, v167
	global_store_dwordx4 v25, v[164:167], s[30:31] offset:1024 sc1
	v_pk_mul_f32 v[128:129], v[128:129], v[136:137]
	v_pk_mul_f32 v[130:131], v[130:131], v[138:139]
	v_pk_mul_f32 v[132:133], v[132:133], v[140:141]
	v_pk_mul_f32 v[134:135], v[134:135], v[142:143]
	v_pk_mul_f32 v[128:129], v[128:129], v[216:217] op_sel_hi:[1,0]
	v_pk_mul_f32 v[130:131], v[130:131], v[216:217] op_sel_hi:[1,0]
	v_pk_mul_f32 v[132:133], v[132:133], v[246:247] op_sel_hi:[1,0]
	v_pk_mul_f32 v[134:135], v[134:135], v[246:247] op_sel_hi:[1,0]
	v_cvt_pk_bf16_f32 v168, v128, v129
	v_cvt_pk_bf16_f32 v170, v132, v133
	v_cvt_pk_bf16_f32 v169, v130, v131
	v_cvt_pk_bf16_f32 v171, v134, v135
	v_permlane32_swap_b32 v168, v170
	s_nop 0
	v_permlane32_swap_b32 v169, v171
	global_store_dwordx4 v25, v[168:171], s[30:31] offset:2048 sc1
	s_lshl_b32 s46, s22, 8
	s_lshl_b32 s47, s23, 4
	s_add_u32 s46, s46, s47
	s_lshl_b32 s47, s24, 2
	s_add_u32 s46, s46, s47
	s_add_u32 s46, s46, 20480
	s_add_u32 s38, s20, s46
	s_addc_u32 s39, s21, 0
	s_waitcnt vmcnt(0) lgkmcnt(0)
	v_mov_b32 v28, s51
	v_mov_b32 v29, 0
	s_mov_b64 exec, 1
	s_cmp_eq_u32 s25, 1
	s_cbranch_scc1 L_alt_51
	global_store_dword v29, v28, s[38:39] sc1
	s_branch L_join_52
L_alt_51:
	global_store_dword v29, v28, s[38:39]
L_join_52:
	s_mov_b64 exec, -1
	v_lshlrev_b32 v32, 16, v10
	v_and_b32 v33, 0xffff0000, v10
	v_lshlrev_b32 v34, 16, v11
	v_and_b32 v35, 0xffff0000, v11
	v_lshlrev_b32 v36, 16, v12
	v_and_b32 v37, 0xffff0000, v12
	v_lshlrev_b32 v38, 16, v13
	v_and_b32 v39, 0xffff0000, v13
	v_lshlrev_b32 v40, 16, v14
	v_and_b32 v41, 0xffff0000, v14
	v_lshlrev_b32 v42, 16, v15
	v_and_b32 v43, 0xffff0000, v15
	v_lshlrev_b32 v44, 16, v16
	v_and_b32 v45, 0xffff0000, v16
	v_lshlrev_b32 v46, 16, v17
	v_and_b32 v47, 0xffff0000, v17
	s_xor_b32 s40, s70, 0
	s_mul_i32 s46, s22, 2359296
	s_mul_i32 s47, s40, 114688
	s_add_u32 s46, s46, s47
	s_mul_i32 s47, s24, 28672
	s_add_u32 s46, s46, s47
	s_add_u32 s46, s46, 10813440
	s_add_u32 s30, s20, s46
	s_addc_u32 s31, s21, 0
	s_xor_b32 s40, s70, 1
	s_mul_i32 s46, s22, 2359296
	s_mul_i32 s47, s40, 114688
	s_add_u32 s46, s46, s47
	s_mul_i32 s47, s24, 28672
	s_add_u32 s46, s46, s47
	s_add_u32 s46, s46, 10813440
	s_add_u32 s32, s20, s46
	s_addc_u32 s33, s21, 0
	s_lshl_b32 s46, s22, 8
	s_add_u32 s46, s46, 20480
	s_add_u32 s38, s20, s46
	s_addc_u32 s39, s21, 0
	s_mov_b32 s49, 0
	s_nop 1
L_poll_53:
	global_load_dword v28, v1, s[38:39] sc1
	s_waitcnt vmcnt(0)
	v_cmp_ne_u32 vcc, s51, v28
	s_nop 4
	s_cbranch_vccz L_pollout_54
	s_add_u32 s49, s49, 1
	s_cmp_ge_u32 s49, s26
	s_cbranch_scc0 L_poll_53
	s_mov_b32 s26, 1
L_pollout_54:
	global_load_dwordx4 v[96:99], v2, s[30:31] offset:0
	global_load_dwordx4 v[100:103], v2, s[32:33] offset:0
	global_load_dwordx4 v[104:107], v2, s[30:31] offset:1024
	global_load_dwordx4 v[108:111], v2, s[32:33] offset:1024
	global_load_dwordx4 v[112:115], v2, s[30:31] offset:2048
	global_load_dwordx4 v[116:119], v2, s[32:33] offset:2048
	global_load_dwordx4 v[120:123], v2, s[30:31] offset:3072
	global_load_dwordx4 v[124:127], v2, s[32:33] offset:3072
	global_load_dwordx4 v[128:131], v3, s[30:31] offset:0
	global_load_dwordx4 v[132:135], v3, s[32:33] offset:0
	s_waitcnt vmcnt(9)
	v_mfma_f32_32x32x16_bf16 v[32:47], a[0:3], v[96:99], v[32:47]
	global_load_dwordx4 v[136:139], v3, s[30:31] offset:1024
	s_waitcnt vmcnt(9)
	v_mfma_f32_32x32x16_bf16 v[48:63], a[0:3], v[100:103], 0
	v_mfma_f32_32x32x16_bf16 v[64:79], a[4:7], v[96:99], 0
	global_load_dwordx4 v[140:143], v3, s[32:33] offset:1024
	v_mfma_f32_32x32x16_bf16 v[80:95], a[4:7], v[100:103], 0
	s_waitcnt vmcnt(9)
	v_mfma_f32_32x32x16_bf16 v[32:47], a[8:11], v[104:107], v[32:47]
	global_load_dwordx4 v[144:147], v3, s[30:31] offset:2048
	s_waitcnt vmcnt(9)
	v_mfma_f32_32x32x16_bf16 v[48:63], a[8:11], v[108:111], v[48:63]
	v_mfma_f32_32x32x16_bf16 v[64:79], a[12:15], v[104:107], v[64:79]
	global_load_dwordx4 v[148:151], v3, s[32:33] offset:2048
	v_mfma_f32_32x32x16_bf16 v[80:95], a[12:15], v[108:111], v[80:95]
	s_waitcnt vmcnt(9)
	v_mfma_f32_32x32x16_bf16 v[32:47], a[16:19], v[112:115], v[32:47]
	global_load_dwordx4 v[152:155], v3, s[30:31] offset:3072
	s_waitcnt vmcnt(9)
	v_mfma_f32_32x32x16_bf16 v[48:63], a[16:19], v[116:119], v[48:63]
	v_mfma_f32_32x32x16_bf16 v[64:79], a[20:23], v[112:115], v[64:79]
	global_load_dwordx4 v[156:159], v3, s[32:33] offset:3072
	v_mfma_f32_32x32x16_bf16 v[80:95], a[20:23], v[116:119], v[80:95]
	s_waitcnt vmcnt(9)
	v_mfma_f32_32x32x16_bf16 v[32:47], a[24:27], v[120:123], v[32:47]
	global_load_dwordx4 v[160:163], v4, s[30:31] offset:0
	s_waitcnt vmcnt(9)
	v_mfma_f32_32x32x16_bf16 v[48:63], a[24:27], v[124:127], v[48:63]
	v_mfma_f32_32x32x16_bf16 v[64:79], a[28:31], v[120:123], v[64:79]
	global_load_dwordx4 v[164:167], v4, s[32:33] offset:0
	v_mfma_f32_32x32x16_bf16 v[80:95], a[28:31], v[124:127], v[80:95]
	s_waitcnt vmcnt(9)
	v_mfma_f32_32x32x16_bf16 v[32:47], a[32:35], v[128:131], v[32:47]
	global_load_dwordx4 v[168:171], v4, s[30:31] offset:1024
	s_waitcnt vmcnt(9)
	v_mfma_f32_32x32x16_bf16 v[48:63], a[32:35], v[132:135], v[48:63]
	v_mfma_f32_32x32x16_bf16 v[64:79], a[36:39], v[128:131], v[64:79]
	global_load_dwordx4 v[172:175], v4, s[32:33] offset:1024
	v_mfma_f32_32x32x16_bf16 v[80:95], a[36:39], v[132:135], v[80:95]
	s_mul_i32 s46, s23, 98304
	s_mul_i32 s47, s24, 24576
	s_add_u32 s46, s46, s47
	s_add_u32 s46, s46, 1048576
	s_add_u32 s58, s20, s46
	s_addc_u32 s59, s21, 0
	s_mul_i32 s67, s24, 24576
	s_add_u32 m0, s67, 0
	s_nop 0
	global_load_lds_dwordx4 v2, s[58:59] offset:0
	s_waitcnt vmcnt(10)
	v_mfma_f32_32x32x16_bf16 v[32:47], a[40:43], v[136:139], v[32:47]
	global_load_dwordx4 v[176:179], v4, s[30:31] offset:2048
	s_waitcnt vmcnt(10)
	v_mfma_f32_32x32x16_bf16 v[48:63], a[40:43], v[140:143], v[48:63]
	v_mfma_f32_32x32x16_bf16 v[64:79], a[44:47], v[136:139], v[64:79]
	global_load_dwordx4 v[180:183], v4, s[32:33] offset:2048
	v_mfma_f32_32x32x16_bf16 v[80:95], a[44:47], v[140:143], v[80:95]
	global_load_lds_dwordx4 v2, s[58:59] offset:1024
	s_waitcnt vmcnt(11)
	v_mfma_f32_32x32x16_bf16 v[32:47], a[48:51], v[144:147], v[32:47]
	global_load_dwordx4 v[184:187], v4, s[30:31] offset:3072
	s_waitcnt vmcnt(11)
	v_mfma_f32_32x32x16_bf16 v[48:63], a[48:51], v[148:151], v[48:63]
	v_mfma_f32_32x32x16_bf16 v[64:79], a[52:55], v[144:147], v[64:79]
	global_load_dwordx4 v[188:191], v4, s[32:33] offset:3072
	v_mfma_f32_32x32x16_bf16 v[80:95], a[52:55], v[148:151], v[80:95]
	global_load_lds_dwordx4 v2, s[58:59] offset:2048
	s_waitcnt vmcnt(12)
	v_mfma_f32_32x32x16_bf16 v[32:47], a[56:59], v[152:155], v[32:47]
	global_load_dwordx4 v[192:195], v5, s[30:31] offset:0
	s_waitcnt vmcnt(12)
	v_mfma_f32_32x32x16_bf16 v[48:63], a[56:59], v[156:159], v[48:63]
	v_mfma_f32_32x32x16_bf16 v[64:79], a[60:63], v[152:155], v[64:79]
	global_load_dwordx4 v[196:199], v5, s[32:33] offset:0
	v_mfma_f32_32x32x16_bf16 v[80:95], a[60:63], v[156:159], v[80:95]
	global_load_lds_dwordx4 v2, s[58:59] offset:3072
	s_waitcnt vmcnt(13)
	v_mfma_f32_32x32x16_bf16 v[32:47], a[64:67], v[160:163], v[32:47]
	global_load_dwordx4 v[200:203], v5, s[30:31] offset:1024
	s_waitcnt vmcnt(13)
	v_mfma_f32_32x32x16_bf16 v[48:63], a[64:67], v[164:167], v[48:63]
	v_mfma_f32_32x32x16_bf16 v[64:79], a[68:71], v[160:163], v[64:79]
	global_load_dwordx4 v[204:207], v5, s[32:33] offset:1024
	v_mfma_f32_32x32x16_bf16 v[80:95], a[68:71], v[164:167], v[80:95]
	s_add_u32 m0, s67, 4096
	s_nop 0
	global_load_lds_dwordx4 v3, s[58:59] offset:0
	s_waitcnt vmcnt(14)
	v_mfma_f32_32x32x16_bf16 v[32:47], a[72:75], v[168:171], v[32:47]
	global_load_dwordx4 v[208:211], v5, s[30:31] offset:2048
	s_waitcnt vmcnt(14)
	v_mfma_f32_32x32x16_bf16 v[48:63], a[72:75], v[172:175], v[48:63]
	v_mfma_f32_32x32x16_bf16 v[64:79], a[76:79], v[168:171], v[64:79]
	global_load_dwordx4 v[212:215], v5, s[32:33] offset:2048
	v_mfma_f32_32x32x16_bf16 v[80:95], a[76:79], v[172:175], v[80:95]
	global_load_lds_dwordx4 v3, s[58:59] offset:1024
	s_waitcnt vmcnt(14)
	v_mfma_f32_32x32x16_bf16 v[32:47], a[80:83], v[176:179], v[32:47]
	global_load_dwordx4 v[216:219], v5, s[30:31] offset:3072
	s_waitcnt vmcnt(14)
	v_mfma_f32_32x32x16_bf16 v[48:63], a[80:83], v[180:183], v[48:63]
	v_mfma_f32_32x32x16_bf16 v[64:79], a[84:87], v[176:179], v[64:79]
	global_load_dwordx4 v[220:223], v5, s[32:33] offset:3072
	v_mfma_f32_32x32x16_bf16 v[80:95], a[84:87], v[180:183], v[80:95]
	global_load_lds_dwordx4 v3, s[58:59] offset:2048
	s_waitcnt vmcnt(14)
	v_mfma_f32_32x32x16_bf16 v[32:47], a[88:91], v[184:187], v[32:47]
	global_load_dwordx4 v[224:227], v6, s[30:31] offset:0
	s_waitcnt vmcnt(14)
	v_mfma_f32_32x32x16_bf16 v[48:63], a[88:91], v[188:191], v[48:63]
	v_mfma_f32_32x32x16_bf16 v[64:79], a[92:95], v[184:187], v[64:79]
	global_load_dwordx4 v[228:231], v6, s[32:33] offset:0
	v_mfma_f32_32x32x16_bf16 v[80:95], a[92:95], v[188:191], v[80:95]
	global_load_lds_dwordx4 v3, s[58:59] offset:3072
	s_waitcnt vmcnt(14)
	v_mfma_f32_32x32x16_bf16 v[32:47], a[96:99], v[192:195], v[32:47]
	global_load_dwordx4 v[232:235], v6, s[30:31] offset:1024
	s_waitcnt vmcnt(14)
	v_mfma_f32_32x32x16_bf16 v[48:63], a[96:99], v[196:199], v[48:63]
	v_mfma_f32_32x32x16_bf16 v[64:79], a[100:103], v[192:195], v[64:79]
	global_load_dwordx4 v[236:239], v6, s[32:33] offset:1024
	v_mfma_f32_32x32x16_bf16 v[80:95], a[100:103], v[196:199], v[80:95]
	s_add_u32 m0, s67, 8192
	s_nop 0
	global_load_lds_dwordx4 v4, s[58:59] offset:0
	s_waitcnt vmcnt(14)
	v_mfma_f32_32x32x16_bf16 v[32:47], a[104:107], v[200:203], v[32:47]
	global_load_dwordx4 v[240:243], v6, s[30:31] offset:2048
	s_waitcnt vmcnt(14)
	v_mfma_f32_32x32x16_bf16 v[48:63], a[104:107], v[204:207], v[48:63]
	v_mfma_f32_32x32x16_bf16 v[64:79], a[108:111], v[200:203], v[64:79]
	global_load_dwordx4 v[244:247], v6, s[32:33] offset:2048
	v_mfma_f32_32x32x16_bf16 v[80:95], a[108:111], v[204:207], v[80:95]
	global_load_lds_dwordx4 v4, s[58:59] offset:1024
	s_waitcnt vmcnt(14)
	v_mfma_f32_32x32x16_bf16 v[32:47], a[112:115], v[208:211], v[32:47]
	global_load_dwordx4 v[248:251], v6, s[30:31] offset:3072
	s_waitcnt vmcnt(14)
	v_mfma_f32_32x32x16_bf16 v[48:63], a[112:115], v[212:215], v[48:63]
	v_mfma_f32_32x32x16_bf16 v[64:79], a[116:119], v[208:211], v[64:79]
	global_load_dwordx4 v[252:255], v6, s[32:33] offset:3072
	v_mfma_f32_32x32x16_bf16 v[80:95], a[116:119], v[212:215], v[80:95]
	global_load_lds_dwordx4 v4, s[58:59] offset:2048
	s_waitcnt vmcnt(14)
	v_mfma_f32_32x32x16_bf16 v[32:47], a[120:123], v[216:219], v[32:47]
	global_load_dwordx4 v[96:99], v7, s[30:31] offset:0
	s_waitcnt vmcnt(14)
	v_mfma_f32_32x32x16_bf16 v[48:63], a[120:123], v[220:223], v[48:63]
	v_mfma_f32_32x32x16_bf16 v[64:79], a[124:127], v[216:219], v[64:79]
	global_load_dwordx4 v[100:103], v7, s[32:33] offset:0
	v_mfma_f32_32x32x16_bf16 v[80:95], a[124:127], v[220:223], v[80:95]
	global_load_lds_dwordx4 v4, s[58:59] offset:3072
	s_waitcnt vmcnt(14)
	v_mfma_f32_32x32x16_bf16 v[32:47], a[128:131], v[224:227], v[32:47]
	global_load_dwordx4 v[104:107], v7, s[30:31] offset:1024
	s_waitcnt vmcnt(14)
	v_mfma_f32_32x32x16_bf16 v[48:63], a[128:131], v[228:231], v[48:63]
	v_mfma_f32_32x32x16_bf16 v[64:79], a[132:135], v[224:227], v[64:79]
	global_load_dwordx4 v[108:111], v7, s[32:33] offset:1024
	v_mfma_f32_32x32x16_bf16 v[80:95], a[132:135], v[228:231], v[80:95]
	s_add_u32 m0, s67, 12288
	s_nop 0
	global_load_lds_dwordx4 v5, s[58:59] offset:0
	s_waitcnt vmcnt(14)
	v_mfma_f32_32x32x16_bf16 v[32:47], a[136:139], v[232:235], v[32:47]
	global_load_dwordx4 v[112:115], v7, s[30:31] offset:2048
	s_waitcnt vmcnt(14)
	v_mfma_f32_32x32x16_bf16 v[48:63], a[136:139], v[236:239], v[48:63]
	v_mfma_f32_32x32x16_bf16 v[64:79], a[140:143], v[232:235], v[64:79]
	global_load_dwordx4 v[116:119], v7, s[32:33] offset:2048
	v_mfma_f32_32x32x16_bf16 v[80:95], a[140:143], v[236:239], v[80:95]
	global_load_lds_dwordx4 v5, s[58:59] offset:1024
	s_waitcnt vmcnt(14)
	v_mfma_f32_32x32x16_bf16 v[32:47], a[144:147], v[240:243], v[32:47]
	global_load_dwordx4 v[120:123], v7, s[30:31] offset:3072
	s_waitcnt vmcnt(14)
	v_mfma_f32_32x32x16_bf16 v[48:63], a[144:147], v[244:247], v[48:63]
	v_mfma_f32_32x32x16_bf16 v[64:79], a[148:151], v[240:243], v[64:79]
	global_load_dwordx4 v[124:127], v7, s[32:33] offset:3072
	v_mfma_f32_32x32x16_bf16 v[80:95], a[148:151], v[244:247], v[80:95]
	global_load_lds_dwordx4 v5, s[58:59] offset:2048
	s_waitcnt vmcnt(14)
	v_mfma_f32_32x32x16_bf16 v[32:47], a[152:155], v[248:251], v[32:47]
	global_load_dwordx4 v[128:131], v8, s[30:31] offset:0
	s_waitcnt vmcnt(14)
	v_mfma_f32_32x32x16_bf16 v[48:63], a[152:155], v[252:255], v[48:63]
	v_mfma_f32_32x32x16_bf16 v[64:79], a[156:159], v[248:251], v[64:79]
	global_load_dwordx4 v[132:135], v8, s[32:33] offset:0
	v_mfma_f32_32x32x16_bf16 v[80:95], a[156:159], v[252:255], v[80:95]
	global_load_lds_dwordx4 v5, s[58:59] offset:3072
	s_waitcnt vmcnt(14)
	v_mfma_f32_32x32x16_bf16 v[32:47], a[160:163], v[96:99], v[32:47]
	global_load_dwordx4 v[136:139], v8, s[30:31] offset:1024
	s_waitcnt vmcnt(14)
	v_mfma_f32_32x32x16_bf16 v[48:63], a[160:163], v[100:103], v[48:63]
	v_mfma_f32_32x32x16_bf16 v[64:79], a[164:167], v[96:99], v[64:79]
	global_load_dwordx4 v[140:143], v8, s[32:33] offset:1024
	v_mfma_f32_32x32x16_bf16 v[80:95], a[164:167], v[100:103], v[80:95]
	s_add_u32 m0, s67, 16384
	s_nop 0
	global_load_lds_dwordx4 v6, s[58:59] offset:0
	s_waitcnt vmcnt(14)
	v_mfma_f32_32x32x16_bf16 v[32:47], a[168:171], v[104:107], v[32:47]
	global_load_dwordx4 v[144:147], v8, s[30:31] offset:2048
	s_waitcnt vmcnt(14)
	v_mfma_f32_32x32x16_bf16 v[48:63], a[168:171], v[108:111], v[48:63]
	v_mfma_f32_32x32x16_bf16 v[64:79], a[172:175], v[104:107], v[64:79]
	global_load_dwordx4 v[148:151], v8, s[32:33] offset:2048
	v_mfma_f32_32x32x16_bf16 v[80:95], a[172:175], v[108:111], v[80:95]
	global_load_lds_dwordx4 v6, s[58:59] offset:1024
	s_waitcnt vmcnt(14)
	v_mfma_f32_32x32x16_bf16 v[32:47], a[176:179], v[112:115], v[32:47]
	global_load_dwordx4 v[152:155], v8, s[30:31] offset:3072
	s_waitcnt vmcnt(14)
	v_mfma_f32_32x32x16_bf16 v[48:63], a[176:179], v[116:119], v[48:63]
	v_mfma_f32_32x32x16_bf16 v[64:79], a[180:183], v[112:115], v[64:79]
	global_load_dwordx4 v[156:159], v8, s[32:33] offset:3072
	v_mfma_f32_32x32x16_bf16 v[80:95], a[180:183], v[116:119], v[80:95]
	global_load_lds_dwordx4 v6, s[58:59] offset:2048
	s_waitcnt vmcnt(14)
	v_mfma_f32_32x32x16_bf16 v[32:47], a[184:187], v[120:123], v[32:47]
	s_waitcnt vmcnt(13)
	v_mfma_f32_32x32x16_bf16 v[48:63], a[184:187], v[124:127], v[48:63]
	v_mfma_f32_32x32x16_bf16 v[64:79], a[188:191], v[120:123], v[64:79]
	v_mfma_f32_32x32x16_bf16 v[80:95], a[188:191], v[124:127], v[80:95]
	global_load_lds_dwordx4 v6, s[58:59] offset:3072
	s_waitcnt vmcnt(12)
	v_mfma_f32_32x32x16_bf16 v[32:47], a[192:195], v[128:131], v[32:47]
	s_waitcnt vmcnt(11)
	v_mfma_f32_32x32x16_bf16 v[48:63], a[192:195], v[132:135], v[48:63]
	v_mfma_f32_32x32x16_bf16 v[64:79], a[196:199], v[128:131], v[64:79]
	v_mfma_f32_32x32x16_bf16 v[80:95], a[196:199], v[132:135], v[80:95]
	s_add_u32 m0, s67, 20480
	s_nop 0
	global_load_lds_dwordx4 v7, s[58:59] offset:0
	s_waitcnt vmcnt(10)
	v_mfma_f32_32x32x16_bf16 v[32:47], a[200:203], v[136:139], v[32:47]
	s_waitcnt vmcnt(9)
	v_mfma_f32_32x32x16_bf16 v[48:63], a[200:203], v[140:143], v[48:63]
	v_mfma_f32_32x32x16_bf16 v[64:79], a[204:207], v[136:139], v[64:79]
	v_mfma_f32_32x32x16_bf16 v[80:95], a[204:207], v[140:143], v[80:95]
	global_load_lds_dwordx4 v7, s[58:59] offset:1024
	s_waitcnt vmcnt(8)
	v_mfma_f32_32x32x16_bf16 v[32:47], a[208:211], v[144:147], v[32:47]
	s_waitcnt vmcnt(7)
	v_mfma_f32_32x32x16_bf16 v[48:63], a[208:211], v[148:151], v[48:63]
	v_mfma_f32_32x32x16_bf16 v[64:79], a[212:215], v[144:147], v[64:79]
	v_mfma_f32_32x32x16_bf16 v[80:95], a[212:215], v[148:151], v[80:95]
	global_load_lds_dwordx4 v7, s[58:59] offset:2048
	s_waitcnt vmcnt(6)
	v_mfma_f32_32x32x16_bf16 v[32:47], a[216:219], v[152:155], v[32:47]
	s_waitcnt vmcnt(5)
	v_mfma_f32_32x32x16_bf16 v[48:63], a[216:219], v[156:159], v[48:63]
	v_mfma_f32_32x32x16_bf16 v[64:79], a[220:223], v[152:155], v[64:79]
	v_mfma_f32_32x32x16_bf16 v[80:95], a[220:223], v[156:159], v[80:95]
	global_load_lds_dwordx4 v7, s[58:59] offset:3072
	s_xor_b32 s40, s24, 1
	s_mul_i32 s40, s40, 12288
	s_add_u32 s40, s40, 114688
	v_add_u32 v21, s40, v2
	s_xor_b32 s40, s24, 2
	s_mul_i32 s40, s40, 12288
	s_add_u32 s40, s40, 118784
	v_add_u32 v22, s40, v2
	s_xor_b32 s40, s24, 3
	s_mul_i32 s40, s40, 12288
	s_add_u32 s40, s40, 122880
	v_add_u32 v23, s40, v2
	ds_write_b128 v21, v[48:51] offset:0
	ds_write_b128 v21, v[52:55] offset:1024
	ds_write_b128 v21, v[56:59] offset:2048
	ds_write_b128 v21, v[60:63] offset:3072
	ds_write_b128 v22, v[64:67] offset:0
	ds_write_b128 v22, v[68:71] offset:1024
	ds_write_b128 v22, v[72:75] offset:2048
	ds_write_b128 v22, v[76:79] offset:3072
	ds_write_b128 v23, v[80:83] offset:0
	ds_write_b128 v23, v[84:87] offset:1024
	ds_write_b128 v23, v[88:91] offset:2048
	ds_write_b128 v23, v[92:95] offset:3072
	s_mul_i32 s40, s24, 12288
	s_add_u32 s40, s40, 114688
	v_add_u32 v20, s40, v2
	s_waitcnt lgkmcnt(0)
	s_barrier
	ds_read_b128 v[96:99], v20 offset:0
	ds_read_b128 v[100:103], v20 offset:1024
	ds_read_b128 v[104:107], v20 offset:2048
	ds_read_b128 v[108:111], v20 offset:3072
	ds_read_b128 v[112:115], v20 offset:4096
	ds_read_b128 v[116:119], v20 offset:5120
	ds_read_b128 v[120:123], v20 offset:6144
	ds_read_b128 v[124:127], v20 offset:7168
	ds_read_b128 v[128:131], v20 offset:8192
	ds_read_b128 v[132:135], v20 offset:9216
	ds_read_b128 v[136:139], v20 offset:10240
	ds_read_b128 v[140:143], v20 offset:11264
	s_waitcnt lgkmcnt(11)
	v_pk_add_f32 v[32:33], v[32:33], v[96:97]
	v_pk_add_f32 v[34:35], v[34:35], v[98:99]
	s_waitcnt lgkmcnt(10)
	v_pk_add_f32 v[36:37], v[36:37], v[100:101]
	v_pk_add_f32 v[38:39], v[38:39], v[102:103]
	s_waitcnt lgkmcnt(9)
	v_pk_add_f32 v[40:41], v[40:41], v[104:105]
	v_pk_add_f32 v[42:43], v[42:43], v[106:107]
	s_waitcnt lgkmcnt(8)
	v_pk_add_f32 v[44:45], v[44:45], v[108:109]
	v_pk_add_f32 v[46:47], v[46:47], v[110:111]
	s_waitcnt lgkmcnt(7)
	v_pk_add_f32 v[32:33], v[32:33], v[112:113]
	v_pk_add_f32 v[34:35], v[34:35], v[114:115]
	s_waitcnt lgkmcnt(6)
	v_pk_add_f32 v[36:37], v[36:37], v[116:117]
	v_pk_add_f32 v[38:39], v[38:39], v[118:119]
	s_waitcnt lgkmcnt(5)
	v_pk_add_f32 v[40:41], v[40:41], v[120:121]
	v_pk_add_f32 v[42:43], v[42:43], v[122:123]
	s_waitcnt lgkmcnt(4)
	v_pk_add_f32 v[44:45], v[44:45], v[124:125]
	v_pk_add_f32 v[46:47], v[46:47], v[126:127]
	s_waitcnt lgkmcnt(3)
	v_pk_add_f32 v[32:33], v[32:33], v[128:129]
	v_pk_add_f32 v[34:35], v[34:35], v[130:131]
	s_waitcnt lgkmcnt(2)
	v_pk_add_f32 v[36:37], v[36:37], v[132:133]
	v_pk_add_f32 v[38:39], v[38:39], v[134:135]
	s_waitcnt lgkmcnt(1)
	v_pk_add_f32 v[40:41], v[40:41], v[136:137]
	v_pk_add_f32 v[42:43], v[42:43], v[138:139]
	s_waitcnt lgkmcnt(0)
	v_pk_add_f32 v[44:45], v[44:45], v[140:141]
	v_pk_add_f32 v[46:47], v[46:47], v[142:143]
	v_cvt_pk_bf16_f32 v10, v32, v33
	v_cvt_pk_bf16_f32 v11, v34, v35
	v_cvt_pk_bf16_f32 v12, v36, v37
	v_cvt_pk_bf16_f32 v13, v38, v39
	v_cvt_pk_bf16_f32 v14, v40, v41
	v_cvt_pk_bf16_f32 v15, v42, v43
	v_cvt_pk_bf16_f32 v16, v44, v45
	v_cvt_pk_bf16_f32 v17, v46, v47
	s_mul_i32 s46, s22, 2359296
	s_lshl_b32 s47, s70, 15
	s_add_u32 s46, s46, s47
	s_lshl_b32 s47, s29, 11
	s_add_u32 s46, s46, s47
	s_add_u32 s46, s46, 9699328
	s_add_u32 s34, s20, s46
	s_addc_u32 s35, s21, 0
	global_store_dwordx4 v2, v[10:13], s[34:35] offset:0 sc1
	global_store_dwordx4 v2, v[14:17], s[34:35] offset:1024 sc1
	s_mul_i32 s46, s22, 2359296
	s_lshl_b32 s47, s70, 12
	s_add_u32 s46, s46, s47
	s_lshl_b32 s47, s29, 8
	s_add_u32 s46, s46, s47
	s_add_u32 s46, s46, 9994240
	s_add_u32 s36, s20, s46
	s_addc_u32 s37, s21, 0
	v_pk_add_f32 v[96:97], v[32:33], v[34:35]
	v_pk_mul_f32 v[98:99], v[32:33], v[32:33]
	v_pk_fma_f32 v[98:99], v[34:35], v[34:35], v[98:99]
	v_pk_add_f32 v[96:97], v[96:97], v[36:37]
	v_pk_fma_f32 v[98:99], v[36:37], v[36:37], v[98:99]
	v_pk_add_f32 v[96:97], v[96:97], v[38:39]
	v_pk_fma_f32 v[98:99], v[38:39], v[38:39], v[98:99]
	v_pk_add_f32 v[96:97], v[96:97], v[40:41]
	v_pk_fma_f32 v[98:99], v[40:41], v[40:41], v[98:99]
	v_pk_add_f32 v[96:97], v[96:97], v[42:43]
	v_pk_fma_f32 v[98:99], v[42:43], v[42:43], v[98:99]
	v_pk_add_f32 v[96:97], v[96:97], v[44:45]
	v_pk_fma_f32 v[98:99], v[44:45], v[44:45], v[98:99]
	v_pk_add_f32 v[96:97], v[96:97], v[46:47]
	v_pk_fma_f32 v[98:99], v[46:47], v[46:47], v[98:99]
	v_add_f32 v96, v96, v97
	v_add_f32 v98, v98, v99
	s_nop 1
	v_permlane32_swap_b32 v96, v98
	v_add_f32 v96, v96, v98
	global_store_dword v1, v96, s[36:37] sc1
	s_lshl_b32 s46, s22, 8
	s_lshl_b32 s47, s23, 4
	s_add_u32 s46, s46, s47
	s_lshl_b32 s47, s24, 2
	s_add_u32 s46, s46, s47
	s_add_u32 s46, s46, 24576
	s_add_u32 s38, s20, s46
	s_addc_u32 s39, s21, 0
	s_waitcnt vmcnt(0) lgkmcnt(0)
	v_mov_b32 v28, s51
	v_mov_b32 v29, 0
	s_mov_b64 exec, 1
	s_cmp_eq_u32 s25, 1
	s_cbranch_scc1 L_alt_55
	global_store_dword v29, v28, s[38:39] sc1
	s_branch L_join_56
L_alt_55:
	global_store_dword v29, v28, s[38:39]
L_join_56:
	s_mov_b64 exec, -1
	global_load_dwordx4 a[128:131], v2, s[76:77] offset:0
	global_load_dwordx4 a[160:163], v2, s[78:79] offset:0
	global_load_dwordx4 a[132:135], v2, s[76:77] offset:1024
	global_load_dwordx4 a[164:167], v2, s[78:79] offset:1024
	s_mul_i32 s46, s23, 3072
	s_add_u32 s46, s46, 655360
	s_add_u32 s34, s20, s46
	s_addc_u32 s35, s21, 0
	v_and_b32 v27, 31, v0
	v_lshlrev_b32 v27, 3, v27
	v_lshrrev_b32 v26, 5, v0
	v_lshl_add_u32 v27, v26, 9, v27
	global_load_dwordx2 v[176:177], v27, s[34:35] offset:0
	global_load_dwordx2 v[178:179], v27, s[34:35] offset:256
	global_load_dwordx2 v[180:181], v27, s[34:35] offset:1024
	global_load_dwordx2 v[182:183], v27, s[34:35] offset:1280
	global_load_dwordx2 v[184:185], v27, s[34:35] offset:2048
	global_load_dwordx2 v[186:187], v27, s[34:35] offset:2304
	v_and_b32 v20, 31, v0
	v_lshrrev_b32 v21, 5, v0
	v_mov_b32 v105, 0xf149f2ca
	v_lshlrev_b32 v22, 2, v21
	v_sub_u32 v22, v20, v22
	s_cmp_ge_u32 s22, 1
	s_cselect_b32 s40, 0, 0xf149f2ca
	v_cmp_gt_i32 vcc, 0, v22
	s_nop 1
	v_cndmask_b32 v208, 0, v105, vcc
	v_mov_b32 v224, s40
	v_sub_f32 v240, v105, v208
	v_cmp_gt_i32 vcc, 1, v22
	s_nop 1
	v_cndmask_b32 v209, 0, v105, vcc
	v_mov_b32 v225, s40
	v_sub_f32 v241, v105, v209
	v_cmp_gt_i32 vcc, 2, v22
	s_nop 1
	v_cndmask_b32 v210, 0, v105, vcc
	v_mov_b32 v226, s40
	v_sub_f32 v242, v105, v210
	v_cmp_gt_i32 vcc, 3, v22
	s_nop 1
	v_cndmask_b32 v211, 0, v105, vcc
	v_mov_b32 v227, s40
	v_sub_f32 v243, v105, v211
	v_cmp_gt_i32 vcc, 8, v22
	s_nop 1
	v_cndmask_b32 v212, 0, v105, vcc
	v_mov_b32 v228, s40
	v_sub_f32 v244, v105, v212
	v_cmp_gt_i32 vcc, 9, v22
	s_nop 1
	v_cndmask_b32 v213, 0, v105, vcc
	v_mov_b32 v229, s40
	v_sub_f32 v245, v105, v213
	v_cmp_gt_i32 vcc, 10, v22
	s_nop 1
	v_cndmask_b32 v214, 0, v105, vcc
	v_mov_b32 v230, s40
	v_sub_f32 v246, v105, v214
	v_cmp_gt_i32 vcc, 11, v22
	s_nop 1
	v_cndmask_b32 v215, 0, v105, vcc
	v_mov_b32 v231, s40
	v_sub_f32 v247, v105, v215
	v_cmp_gt_i32 vcc, 16, v22
	s_nop 1
	v_cndmask_b32 v216, 0, v105, vcc
	v_mov_b32 v232, s40
	v_sub_f32 v248, v105, v216
	v_cmp_gt_i32 vcc, 17, v22
	s_nop 1
	v_cndmask_b32 v217, 0, v105, vcc
	v_mov_b32 v233, s40
	v_sub_f32 v249, v105, v217
	v_cmp_gt_i32 vcc, 18, v22
	s_nop 1
	v_cndmask_b32 v218, 0, v105, vcc
	v_mov_b32 v234, s40
	v_sub_f32 v250, v105, v218
	v_cmp_gt_i32 vcc, 19, v22
	s_nop 1
	v_cndmask_b32 v219, 0, v105, vcc
	v_mov_b32 v235, s40
	v_sub_f32 v251, v105, v219
	v_cmp_gt_i32 vcc, 24, v22
	s_nop 1
	v_cndmask_b32 v220, 0, v105, vcc
	v_mov_b32 v236, s40
	v_sub_f32 v252, v105, v220
	v_cmp_gt_i32 vcc, 25, v22
	s_nop 1
	v_cndmask_b32 v221, 0, v105, vcc
	v_mov_b32 v237, s40
	v_sub_f32 v253, v105, v221
	v_cmp_gt_i32 vcc, 26, v22
	s_nop 1
	v_cndmask_b32 v222, 0, v105, vcc
	v_mov_b32 v238, s40
	v_sub_f32 v254, v105, v222
	v_cmp_gt_i32 vcc, 27, v22
	s_nop 1
	v_cndmask_b32 v223, 0, v105, vcc
	v_mov_b32 v239, s40
	v_sub_f32 v255, v105, v223
	s_cmp_ge_u32 s22, 2
	s_cbranch_scc1 L_oldok_57
	v_mov_b32 v240, v105
	v_mov_b32 v241, v105
	v_mov_b32 v242, v105
	v_mov_b32 v243, v105
	v_mov_b32 v244, v105
	v_mov_b32 v245, v105
	v_mov_b32 v246, v105
	v_mov_b32 v247, v105
	v_mov_b32 v248, v105
	v_mov_b32 v249, v105
	v_mov_b32 v250, v105
	v_mov_b32 v251, v105
	v_mov_b32 v252, v105
	v_mov_b32 v253, v105
	v_mov_b32 v254, v105
	v_mov_b32 v255, v105
L_oldok_57:
	v_mov_b32 v24, 0x3f803f80
	v_mov_b32 v25, 0x3f803f80
	v_mov_b32 v26, 0x3f803f80
	v_mov_b32 v27, 0x3f803f80
	v_add_u32 v23, 147456, v2
	s_and_b32 s63, s24, 1
	s_lshr_b32 s60, s24, 1
	s_sub_u32 s61, 3, s60
	s_lshl_b32 s40, s63, 10
	s_add_u32 s40, s40, 98304
	v_add_u32 v104, s40, v2
	v_and_b32 v30, 15, v20
	v_subrev_u32 v30, 4, v30
	v_cmp_gt_u32 vcc, 8, v30
	v_mov_b32 v28, 64
	s_nop 0
	v_cndmask_b32 v28, 0, v28, vcc
	v_add_u32 v28, 147456, v28
	s_lshl_b32 s40, s63, 8
	s_add_u32 s40, s40, 100352
	v_add_u32 v29, s40, v2
	v_mov_b32 v30, 4096
	v_cmp_gt_u32 vcc, 16, v20
	s_nop 1
	v_cndmask_b32 v174, v28, v29, vcc
	v_cndmask_b32 v175, 0, v30, vcc
	s_mul_i32 s46, s23, 229376
	s_mul_i32 s47, s24, 7168
	s_add_u32 s46, s46, s47
	s_add_u32 s46, s46, 3145728
	s_add_u32 s64, s20, s46
	s_addc_u32 s65, s21, 0
	s_mul_i32 s66, s24, 7168
	s_mul_i32 s46, s22, 2359296
	s_lshl_b32 s47, s24, 15
	s_add_u32 s46, s46, s47
	s_add_u32 s46, s46, 9699328
	s_add_u32 s30, s20, s46
	s_addc_u32 s31, s21, 0
	s_lshl_b32 s46, s22, 8
	s_add_u32 s46, s46, 24576
	s_add_u32 s38, s20, s46
	s_addc_u32 s39, s21, 0
	s_mov_b32 s49, 0
	s_nop 1
L_poll_58:
	global_load_dword v28, v1, s[38:39] sc1
	s_waitcnt vmcnt(0)
	v_cmp_ne_u32 vcc, s51, v28
	s_nop 4
	s_cbranch_vccz L_pollout_59
	s_add_u32 s49, s49, 1
	s_cmp_ge_u32 s49, s26
	s_cbranch_scc0 L_poll_58
	s_mov_b32 s26, 1
L_pollout_59:
	global_load_dwordx4 a[0:3], v2, s[30:31] offset:0
	global_load_dwordx4 a[4:7], v2, s[30:31] offset:1024
	global_load_dwordx4 a[8:11], v2, s[30:31] offset:2048
	global_load_dwordx4 a[12:15], v2, s[30:31] offset:3072
	s_mul_i32 s46, s22, 2359296
	s_lshl_b32 s47, s24, 12
	s_add_u32 s46, s46, s47
	s_add_u32 s46, s46, 9994240
	s_add_u32 s32, s20, s46
	s_addc_u32 s33, s21, 0
	global_load_dword v112, v1, s[32:33] offset:0
	global_load_dword v113, v1, s[32:33] offset:256
	global_load_dword v114, v1, s[32:33] offset:512
	global_load_dword v115, v1, s[32:33] offset:768
	global_load_dword v116, v1, s[32:33] offset:1024
	global_load_dword v117, v1, s[32:33] offset:1280
	global_load_dword v118, v1, s[32:33] offset:1536
	global_load_dword v119, v1, s[32:33] offset:1792
	global_load_dword v120, v1, s[32:33] offset:2048
	global_load_dword v121, v1, s[32:33] offset:2304
	global_load_dword v122, v1, s[32:33] offset:2560
	global_load_dword v123, v1, s[32:33] offset:2816
	global_load_dword v124, v1, s[32:33] offset:3072
	global_load_dword v125, v1, s[32:33] offset:3328
	global_load_dword v126, v1, s[32:33] offset:3584
	global_load_dword v127, v1, s[32:33] offset:3840
	global_load_dwordx4 a[16:19], v3, s[30:31] offset:0
	global_load_dwordx4 a[20:23], v3, s[30:31] offset:1024
	global_load_dwordx4 a[24:27], v3, s[30:31] offset:2048
	global_load_dwordx4 a[28:31], v3, s[30:31] offset:3072
	ds_write_b128 v23, v[24:27]
	ds_write_b128 v23, v[24:27] offset:1024
	ds_read_b128 v[80:83], v2 offset:0
	ds_read_b128 v[84:87], v2 offset:1024
	ds_read_b128 v[88:91], v2 offset:3072
	ds_read_b128 v[92:95], v2 offset:4096
	ds_read_b128 v[96:99], v2 offset:6144
	s_waitcnt vmcnt(23) lgkmcnt(4)
	v_mfma_f32_32x32x16_bf16 v[32:47], v[80:83], a[0:3], 0
	global_load_dwordx4 a[32:35], v4, s[30:31] offset:0
	ds_read_b128 v[100:103], v2 offset:7168
	s_waitcnt lgkmcnt(4)
	v_mfma_f32_32x32x16_bf16 v[48:63], a[0:3], v[84:87], 0
	ds_read_b128 v[80:83], v2 offset:9216
	s_waitcnt vmcnt(23) lgkmcnt(4)
	v_mfma_f32_32x32x16_bf16 v[32:47], v[88:91], a[4:7], v[32:47]
	global_load_dwordx4 a[36:39], v4, s[30:31] offset:1024
	ds_read_b128 v[84:87], v2 offset:10240
	s_waitcnt lgkmcnt(4)
	v_mfma_f32_32x32x16_bf16 v[48:63], a[4:7], v[92:95], v[48:63]
	ds_read_b128 v[88:91], v2 offset:12288
	s_waitcnt vmcnt(23) lgkmcnt(4)
	v_mfma_f32_32x32x16_bf16 v[32:47], v[96:99], a[8:11], v[32:47]
	global_load_dwordx4 a[40:43], v4, s[30:31] offset:2048
	ds_read_b128 v[92:95], v2 offset:13312
	s_waitcnt lgkmcnt(4)
	v_mfma_f32_32x32x16_bf16 v[48:63], a[8:11], v[100:103], v[48:63]
	ds_read_b128 v[96:99], v2 offset:15360
	s_waitcnt vmcnt(23) lgkmcnt(4)
	v_mfma_f32_32x32x16_bf16 v[32:47], v[80:83], a[12:15], v[32:47]
	global_load_dwordx4 a[44:47], v4, s[30:31] offset:3072
	ds_read_b128 v[100:103], v2 offset:16384
	s_waitcnt lgkmcnt(4)
	v_mfma_f32_32x32x16_bf16 v[48:63], a[12:15], v[84:87], v[48:63]
	ds_read_b128 v[80:83], v2 offset:18432
	s_waitcnt vmcnt(7) lgkmcnt(4)
	v_mfma_f32_32x32x16_bf16 v[32:47], v[88:91], a[16:19], v[32:47]
	global_load_dwordx4 a[48:51], v5, s[30:31] offset:0
	v_pk_add_f32 v[112:113], v[112:113], v[120:121]
	ds_read_b128 v[84:87], v2 offset:19456
	s_waitcnt lgkmcnt(4)
	v_mfma_f32_32x32x16_bf16 v[48:63], a[16:19], v[92:95], v[48:63]
	v_pk_add_f32 v[114:115], v[114:115], v[122:123]
	ds_read_b128 v[88:91], v2 offset:21504
	s_waitcnt vmcnt(7) lgkmcnt(4)
	v_mfma_f32_32x32x16_bf16 v[32:47], v[96:99], a[20:23], v[32:47]
	global_load_dwordx4 a[52:55], v5, s[30:31] offset:1024
	v_pk_add_f32 v[116:117], v[116:117], v[124:125]
	ds_read_b128 v[92:95], v2 offset:22528
	s_waitcnt lgkmcnt(4)
	v_mfma_f32_32x32x16_bf16 v[48:63], a[20:23], v[100:103], v[48:63]
	v_pk_add_f32 v[118:119], v[118:119], v[126:127]
	ds_read_b128 v[96:99], v2 offset:24576
	s_waitcnt vmcnt(7) lgkmcnt(4)
	v_mfma_f32_32x32x16_bf16 v[32:47], v[80:83], a[24:27], v[32:47]
	global_load_dwordx4 a[56:59], v5, s[30:31] offset:2048
	v_pk_add_f32 v[112:113], v[112:113], v[116:117]
	ds_read_b128 v[100:103], v2 offset:25600
	s_waitcnt lgkmcnt(4)
	v_mfma_f32_32x32x16_bf16 v[48:63], a[24:27], v[84:87], v[48:63]
	v_pk_add_f32 v[114:115], v[114:115], v[118:119]
	ds_read_b128 v[80:83], v2 offset:27648
	s_waitcnt vmcnt(7) lgkmcnt(4)
	v_mfma_f32_32x32x16_bf16 v[32:47], v[88:91], a[28:31], v[32:47]
	global_load_dwordx4 a[60:63], v5, s[30:31] offset:3072
	v_pk_add_f32 v[112:113], v[112:113], v[114:115]
	ds_read_b128 v[84:87], v2 offset:28672
	s_waitcnt lgkmcnt(4)
	v_mfma_f32_32x32x16_bf16 v[48:63], a[28:31], v[92:95], v[48:63]
	v_add_f32 v112, v112, v113
	ds_read_b128 v[88:91], v2 offset:30720
	s_waitcnt vmcnt(7) lgkmcnt(4)
	v_mfma_f32_32x32x16_bf16 v[32:47], v[96:99], a[32:35], v[32:47]
	global_load_dwordx4 a[64:67], v6, s[30:31] offset:0
	v_mov_b32 v113, v112
	ds_read_b128 v[92:95], v2 offset:31744
	s_waitcnt lgkmcnt(4)
	v_mfma_f32_32x32x16_bf16 v[48:63], a[32:35], v[100:103], v[48:63]
	v_permlane32_swap_b32 v112, v113
	ds_read_b128 v[96:99], v2 offset:33792
	s_waitcnt vmcnt(7) lgkmcnt(4)
	v_mfma_f32_32x32x16_bf16 v[32:47], v[80:83], a[36:39], v[32:47]
	global_load_dwordx4 a[68:71], v6, s[30:31] offset:1024
	v_mul_f32 v112, 0xbb000000, v112
	ds_read_b128 v[100:103], v2 offset:34816
	s_waitcnt lgkmcnt(4)
	v_mfma_f32_32x32x16_bf16 v[48:63], a[36:39], v[84:87], v[48:63]
	v_mul_f32 v113, 0x3b000000, v113
	ds_read_b128 v[80:83], v2 offset:36864
	s_waitcnt vmcnt(7) lgkmcnt(4)
	v_mfma_f32_32x32x16_bf16 v[32:47], v[88:91], a[40:43], v[32:47]
	global_load_dwordx4 a[72:75], v6, s[30:31] offset:2048
	v_cvt_pk_bf16_f32 v114, v112, v112
	ds_read_b128 v[84:87], v2 offset:37888
	s_waitcnt lgkmcnt(4)
	v_mfma_f32_32x32x16_bf16 v[48:63], a[40:43], v[92:95], v[48:63]
	v_fma_f32 v113, -v112, v112, v113
	ds_read_b128 v[88:91], v2 offset:39936
	s_waitcnt vmcnt(7) lgkmcnt(4)
	v_mfma_f32_32x32x16_bf16 v[32:47], v[96:99], a[44:47], v[32:47]
	global_load_dwordx4 a[76:79], v6, s[30:31] offset:3072
	v_lshlrev_b32 v114, 16, v114
	ds_read_b128 v[92:95], v2 offset:40960
	s_waitcnt lgkmcnt(4)
	v_mfma_f32_32x32x16_bf16 v[48:63], a[44:47], v[100:103], v[48:63]
	v_max_f32 v113, 0, v113
	ds_read_b128 v[96:99], v2 offset:43008
	s_waitcnt vmcnt(7) lgkmcnt(4)
	v_mfma_f32_32x32x16_bf16 v[32:47], v[80:83], a[48:51], v[32:47]
	global_load_dwordx4 a[80:83], v7, s[30:31] offset:0
	v_sub_f32 v114, v112, v114
	ds_read_b128 v[100:103], v2 offset:44032
	s_waitcnt lgkmcnt(4)
	v_mfma_f32_32x32x16_bf16 v[48:63], a[48:51], v[84:87], v[48:63]
	v_add_f32 v113, 0x3727c5ac, v113
	ds_read_b128 v[80:83], v2 offset:46080
	s_waitcnt vmcnt(7) lgkmcnt(4)
	v_mfma_f32_32x32x16_bf16 v[32:47], v[88:91], a[52:55], v[32:47]
	global_load_dwordx4 a[84:87], v7, s[30:31] offset:1024
	v_cvt_pk_bf16_f32 v188, v112, v114
	ds_read_b128 v[84:87], v2 offset:47104
	s_waitcnt lgkmcnt(4)
	v_mfma_f32_32x32x16_bf16 v[48:63], a[52:55], v[92:95], v[48:63]
	v_rsq_f32 v128, v113
	ds_read_b128 v[88:91], v2 offset:49152
	s_waitcnt vmcnt(7) lgkmcnt(4)
	v_mfma_f32_32x32x16_bf16 v[32:47], v[96:99], a[56:59], v[32:47]
	global_load_dwordx4 a[88:91], v7, s[30:31] offset:2048
	v_mov_b32 v189, v188
	ds_read_b128 v[92:95], v2 offset:50176
	s_waitcnt lgkmcnt(4)
	v_mfma_f32_32x32x16_bf16 v[48:63], a[56:59], v[100:103], v[48:63]
	v_mov_b32 v190, v188
	ds_read_b128 v[96:99], v2 offset:52224
	s_waitcnt vmcnt(7) lgkmcnt(4)
	v_mfma_f32_32x32x16_bf16 v[32:47], v[80:83], a[60:63], v[32:47]
	global_load_dwordx4 a[92:95], v7, s[30:31] offset:3072
	v_mov_b32 v191, v188
	ds_read_b128 v[100:103], v2 offset:53248
	s_waitcnt lgkmcnt(4)
	v_mfma_f32_32x32x16_bf16 v[48:63], a[60:63], v[84:87], v[48:63]
	v_mul_f32 v130, 0x3eb8aa3b, v128
	ds_read_b128 v[80:83], v2 offset:55296
	s_waitcnt vmcnt(7) lgkmcnt(4)
	v_mfma_f32_32x32x16_bf16 v[32:47], v[88:91], a[64:67], v[32:47]
	global_load_dwordx4 a[96:99], v8, s[30:31] offset:0
	s_lshl_b32 s40, s24, 8
	s_add_u32 s40, s40, 149504
	ds_read_b128 v[84:87], v2 offset:56320
	s_waitcnt lgkmcnt(4)
	v_mfma_f32_32x32x16_bf16 v[48:63], a[64:67], v[92:95], v[48:63]
	v_add_u32 v23, s40, v1
	ds_read_b128 v[88:91], v18 offset:1024
	s_waitcnt vmcnt(7) lgkmcnt(4)
	v_mfma_f32_32x32x16_bf16 v[32:47], v[96:99], a[68:71], v[32:47]
	global_load_dwordx4 a[100:103], v8, s[30:31] offset:1024
	v_lshlrev_b32 v28, 4, v21
	ds_read_b128 v[92:95], v18 offset:2048
	s_waitcnt lgkmcnt(4)
	v_mfma_f32_32x32x16_bf16 v[48:63], a[68:71], v[100:103], v[48:63]
	ds_write_b32 v23, v128
	ds_read_b128 v[96:99], v18 offset:4096
	s_waitcnt vmcnt(7) lgkmcnt(5)
	v_mfma_f32_32x32x16_bf16 v[32:47], v[80:83], a[72:75], v[32:47]
	global_load_dwordx4 a[104:107], v8, s[30:31] offset:2048
	v_add_u32 v28, s40, v28
	ds_read_b128 v[100:103], v18 offset:5120
	s_waitcnt lgkmcnt(5)
	v_mfma_f32_32x32x16_bf16 v[48:63], a[72:75], v[84:87], v[48:63]
	ds_read_b128 v[132:135], v28 offset:0
	ds_read_b128 v[80:83], v18 offset:7168
	s_waitcnt vmcnt(7) lgkmcnt(6)
	v_mfma_f32_32x32x16_bf16 v[32:47], v[88:91], a[76:79], v[32:47]
	global_load_dwordx4 a[108:111], v8, s[30:31] offset:3072
	ds_read_b128 v[136:139], v28 offset:32
	ds_read_b128 v[84:87], v18 offset:8192
	s_waitcnt lgkmcnt(7)
	v_mfma_f32_32x32x16_bf16 v[48:63], a[76:79], v[92:95], v[48:63]
	ds_read_b128 v[140:143], v28 offset:64
	ds_read_b128 v[88:91], v18 offset:10240
	s_waitcnt vmcnt(7) lgkmcnt(7)
	v_mfma_f32_32x32x16_bf16 v[32:47], v[96:99], a[80:83], v[32:47]
	global_load_dwordx4 a[112:115], v9, s[30:31] offset:0
	ds_read_b128 v[144:147], v28 offset:96
	ds_read_b128 v[92:95], v18 offset:11264
	s_waitcnt lgkmcnt(8)
	v_mfma_f32_32x32x16_bf16 v[48:63], a[80:83], v[100:103], v[48:63]
	ds_read_b128 v[96:99], v18 offset:13312
	s_waitcnt vmcnt(7) lgkmcnt(7)
	v_mfma_f32_32x32x16_bf16 v[32:47], v[80:83], a[84:87], v[32:47]
	global_load_dwordx4 a[116:119], v9, s[30:31] offset:1024
	ds_read_b128 v[100:103], v18 offset:14336
	s_waitcnt lgkmcnt(6)
	v_mfma_f32_32x32x16_bf16 v[48:63], a[84:87], v[84:87], v[48:63]
	ds_read_b128 v[80:83], v18 offset:16384
	s_waitcnt vmcnt(7) lgkmcnt(5)
	v_mfma_f32_32x32x16_bf16 v[32:47], v[88:91], a[88:91], v[32:47]
	global_load_dwordx4 a[120:123], v9, s[30:31] offset:2048
	ds_read_b128 v[84:87], v18 offset:17408
	s_waitcnt lgkmcnt(4)
	v_mfma_f32_32x32x16_bf16 v[48:63], a[88:91], v[92:95], v[48:63]
	ds_read_b128 v[88:91], v18 offset:19456
	s_waitcnt vmcnt(7) lgkmcnt(4)
	v_mfma_f32_32x32x16_bf16 v[32:47], v[96:99], a[92:95], v[32:47]
	global_load_dwordx4 a[124:127], v9, s[30:31] offset:3072
	ds_read_b128 v[92:95], v18 offset:20480
	s_waitcnt lgkmcnt(4)
	v_mfma_f32_32x32x16_bf16 v[48:63], a[92:95], v[100:103], v[48:63]
	ds_read_b128 v[96:99], v18 offset:22528
	s_waitcnt vmcnt(7) lgkmcnt(4)
	v_mfma_f32_32x32x16_bf16 v[32:47], v[80:83], a[96:99], v[32:47]
	ds_read_b128 v[100:103], v18 offset:23552
	s_waitcnt lgkmcnt(4)
	v_mfma_f32_32x32x16_bf16 v[48:63], a[96:99], v[84:87], v[48:63]
	ds_read_b128 v[80:83], v18 offset:25600
	s_waitcnt vmcnt(6) lgkmcnt(4)
	v_mfma_f32_32x32x16_bf16 v[32:47], v[88:91], a[100:103], v[32:47]
	ds_read_b128 v[84:87], v18 offset:26624
	s_waitcnt lgkmcnt(4)
	v_mfma_f32_32x32x16_bf16 v[48:63], a[100:103], v[92:95], v[48:63]
	ds_read_b128 v[88:91], v18 offset:28672
	s_waitcnt vmcnt(5) lgkmcnt(4)
	v_mfma_f32_32x32x16_bf16 v[32:47], v[96:99], a[104:107], v[32:47]
	ds_read_b128 v[92:95], v18 offset:29696
	s_waitcnt lgkmcnt(4)
	v_mfma_f32_32x32x16_bf16 v[48:63], a[104:107], v[100:103], v[48:63]
	ds_read_b128 v[96:99], v18 offset:31744
	s_waitcnt vmcnt(4) lgkmcnt(4)
	v_mfma_f32_32x32x16_bf16 v[32:47], v[80:83], a[108:111], v[32:47]
	ds_read_b128 v[100:103], v18 offset:32768
	s_waitcnt lgkmcnt(4)
	v_mfma_f32_32x32x16_bf16 v[48:63], a[108:111], v[84:87], v[48:63]
	ds_read_b128 v[80:83], v18 offset:34816
	s_waitcnt vmcnt(3) lgkmcnt(4)
	v_mfma_f32_32x32x16_bf16 v[32:47], v[88:91], a[112:115], v[32:47]
	ds_read_b128 v[84:87], v18 offset:35840
	s_waitcnt lgkmcnt(4)
	v_mfma_f32_32x32x16_bf16 v[48:63], a[112:115], v[92:95], v[48:63]
	ds_read_b128 v[88:91], v18 offset:37888
	s_waitcnt vmcnt(2) lgkmcnt(4)
	v_mfma_f32_32x32x16_bf16 v[32:47], v[96:99], a[116:119], v[32:47]
	ds_read_b128 v[92:95], v18 offset:38912
	s_waitcnt lgkmcnt(4)
	v_mfma_f32_32x32x16_bf16 v[48:63], a[116:119], v[100:103], v[48:63]
	s_waitcnt vmcnt(1) lgkmcnt(3)
	v_mfma_f32_32x32x16_bf16 v[32:47], v[80:83], a[120:123], v[32:47]
	s_waitcnt lgkmcnt(2)
	v_mfma_f32_32x32x16_bf16 v[48:63], a[120:123], v[84:87], v[48:63]
	s_waitcnt vmcnt(0) lgkmcnt(1)
	v_mfma_f32_32x32x16_bf16 v[32:47], v[88:91], a[124:127], v[32:47]
	s_waitcnt lgkmcnt(0)
	v_mfma_f32_32x32x16_bf16 v[48:63], a[124:127], v[92:95], v[48:63]
	v_mfma_f32_32x32x16_bf16 v[32:47], v[176:179], v[188:191], v[32:47]
	v_mfma_f32_32x32x16_bf16 v[48:63], v[188:191], v[180:183], v[48:63]
	ds_read_b128 v[80:83], v2 offset:2048
	ds_read_b128 v[84:87], v2 offset:5120
	ds_read_b128 v[88:91], v2 offset:8192
	s_nop 7
	v_pk_mul_f32 v[32:33], v[32:33], v[128:129] op_sel_hi:[1,0]
	v_pk_mul_f32 v[34:35], v[34:35], v[128:129] op_sel_hi:[1,0]
	v_pk_mul_f32 v[36:37], v[36:37], v[128:129] op_sel_hi:[1,0]
	v_pk_mul_f32 v[38:39], v[38:39], v[128:129] op_sel_hi:[1,0]
	v_pk_mul_f32 v[40:41], v[40:41], v[128:129] op_sel_hi:[1,0]
	v_pk_mul_f32 v[42:43], v[42:43], v[128:129] op_sel_hi:[1,0]
	v_pk_mul_f32 v[44:45], v[44:45], v[128:129] op_sel_hi:[1,0]
	v_pk_mul_f32 v[46:47], v[46:47], v[128:129] op_sel_hi:[1,0]
	v_cvt_pk_bf16_f32 v148, v32, v33
	v_cvt_pk_bf16_f32 v149, v34, v35
	v_cvt_pk_bf16_f32 v150, v36, v37
	v_cvt_pk_bf16_f32 v151, v38, v39
	v_cvt_pk_bf16_f32 v152, v40, v41
	v_cvt_pk_bf16_f32 v153, v42, v43
	v_cvt_pk_bf16_f32 v154, v44, v45
	v_cvt_pk_bf16_f32 v155, v46, v47
	s_lshl_b32 s40, s24, 12
	s_add_u32 s40, s40, 131072
	v_add_u32 v23, s40, v2
	s_mul_i32 s46, s22, 2359296
	s_lshl_b32 s47, s24, 16
	s_add_u32 s46, s46, s47
	s_lshl_b32 s47, s23, 12
	s_add_u32 s46, s46, s47
	s_add_u32 s46, s46, 10551296
	s_add_u32 s34, s20, s46
	s_addc_u32 s35, s21, 0
	global_store_dwordx4 v2, v[148:151], s[34:35] offset:0 sc1
	ds_write_b128 v23, v[148:151] offset:0
	global_store_dwordx4 v2, v[152:155], s[34:35] offset:1024 sc1
	ds_write_b128 v23, v[152:155] offset:1024
	v_pk_mul_f32 v[48:49], v[48:49], v[132:133]
	v_pk_mul_f32 v[50:51], v[50:51], v[134:135]
	v_pk_mul_f32 v[52:53], v[52:53], v[136:137]
	v_pk_mul_f32 v[54:55], v[54:55], v[138:139]
	v_pk_mul_f32 v[56:57], v[56:57], v[140:141]
	v_pk_mul_f32 v[58:59], v[58:59], v[142:143]
	v_pk_mul_f32 v[60:61], v[60:61], v[144:145]
	v_pk_mul_f32 v[62:63], v[62:63], v[146:147]
	v_cvt_pk_bf16_f32 v156, v48, v49
	v_cvt_pk_bf16_f32 v157, v50, v51
	v_cvt_pk_bf16_f32 v158, v52, v53
	v_cvt_pk_bf16_f32 v159, v54, v55
	v_cvt_pk_bf16_f32 v160, v56, v57
	v_cvt_pk_bf16_f32 v161, v58, v59
	v_cvt_pk_bf16_f32 v162, v60, v61
	v_cvt_pk_bf16_f32 v163, v62, v63
	global_store_dwordx4 v2, v[156:159], s[34:35] offset:2048 sc1
	ds_write_b128 v23, v[156:159] offset:2048
	global_store_dwordx4 v2, v[160:163], s[34:35] offset:3072 sc1
	ds_write_b128 v23, v[160:163] offset:3072
	s_lshl_b32 s46, s23, 13
	s_lshl_b32 s47, s27, 7
	s_add_u32 s46, s46, s47
	s_add_u32 s46, s46, 50987008
	s_add_u32 s38, s20, s46
	s_addc_u32 s39, s21, 0
	ds_read_b128 v[92:95], v2 offset:11264
	s_waitcnt lgkmcnt(7)
	v_mfma_f32_32x32x16_bf16 v[64:79], v[80:83], a[0:3], 0
	s_lshl_b32 s40, s24, 1
	s_add_u32 s40, s40, 0
	s_lshl_b32 s41, s22, 2
	global_load_dwordx4 a[136:139], v2, s[76:77] offset:2048
	ds_read_b128 v[80:83], v2 offset:14336
	s_waitcnt lgkmcnt(7)
	v_mfma_f32_32x32x16_bf16 v[64:79], v[84:87], a[4:7], v[64:79]
	s_add_u32 s42, s41, s40
	s_sub_u32 s42, s42, 8
	s_and_b32 s40, s40, 3
	ds_read_b128 v[84:87], v2 offset:17408
	s_waitcnt lgkmcnt(7)
	v_mfma_f32_32x32x16_bf16 v[64:79], v[88:91], a[8:11], v[64:79]
	s_add_u32 s41, s41, s40
	s_cmp_lt_i32 s42, 0
	s_cselect_b32 s44, s41, s42
	global_load_dwordx4 a[168:171], v2, s[78:79] offset:2048
	ds_read_b128 v[88:91], v2 offset:20480
	s_waitcnt lgkmcnt(3)
	v_mfma_f32_32x32x16_bf16 v[64:79], v[92:95], a[12:15], v[64:79]
	s_lshr_b32 s41, s44, 2
	s_and_b32 s42, s44, 3
	s_mul_i32 s46, s41, 2359296
	ds_read_b128 v[92:95], v2 offset:23552
	s_waitcnt lgkmcnt(3)
	v_mfma_f32_32x32x16_bf16 v[64:79], v[80:83], a[16:19], v[64:79]
	s_lshl_b32 s47, s42, 16
	s_add_u32 s46, s46, s47
	s_lshl_b32 s47, s23, 12
	global_load_dwordx4 a[140:143], v2, s[76:77] offset:3072
	ds_read_b128 v[80:83], v2 offset:26624
	s_waitcnt lgkmcnt(3)
	v_mfma_f32_32x32x16_bf16 v[64:79], v[84:87], a[20:23], v[64:79]
	s_add_u32 s46, s46, s47
	s_add_u32 s46, s46, 10551296
	s_add_u32 s34, s20, s46
	ds_read_b128 v[84:87], v2 offset:29696
	s_waitcnt lgkmcnt(3)
	v_mfma_f32_32x32x16_bf16 v[64:79], v[88:91], a[24:27], v[64:79]
	s_addc_u32 s35, s21, 0
	s_lshl_b32 s40, s24, 1
	s_add_u32 s40, s40, 1
	global_load_dwordx4 a[172:175], v2, s[78:79] offset:3072
	ds_read_b128 v[88:91], v2 offset:32768
	s_waitcnt lgkmcnt(3)
	v_mfma_f32_32x32x16_bf16 v[64:79], v[92:95], a[28:31], v[64:79]
	s_lshl_b32 s41, s22, 2
	s_add_u32 s42, s41, s40
	s_sub_u32 s42, s42, 8
	ds_read_b128 v[92:95], v2 offset:35840
	s_waitcnt lgkmcnt(3)
	v_mfma_f32_32x32x16_bf16 v[64:79], v[80:83], a[32:35], v[64:79]
	s_and_b32 s40, s40, 3
	s_add_u32 s41, s41, s40
	s_cmp_lt_i32 s42, 0
	global_load_dwordx4 a[144:147], v3, s[76:77] offset:0
	ds_read_b128 v[80:83], v2 offset:38912
	s_waitcnt lgkmcnt(3)
	v_mfma_f32_32x32x16_bf16 v[64:79], v[84:87], a[36:39], v[64:79]
	s_cselect_b32 s45, s41, s42
	s_lshr_b32 s41, s45, 2
	s_and_b32 s42, s45, 3
	ds_read_b128 v[84:87], v2 offset:41984
	s_waitcnt lgkmcnt(3)
	v_mfma_f32_32x32x16_bf16 v[64:79], v[88:91], a[40:43], v[64:79]
	s_mul_i32 s46, s41, 2359296
	s_lshl_b32 s47, s42, 16
	s_add_u32 s46, s46, s47
	global_load_dwordx4 a[176:179], v3, s[78:79] offset:0
	ds_read_b128 v[88:91], v2 offset:45056
	s_waitcnt lgkmcnt(3)
	v_mfma_f32_32x32x16_bf16 v[64:79], v[92:95], a[44:47], v[64:79]
	s_lshl_b32 s47, s23, 12
	s_add_u32 s46, s46, s47
	s_add_u32 s46, s46, 10551296
	ds_read_b128 v[92:95], v2 offset:48128
	s_waitcnt lgkmcnt(3)
	v_mfma_f32_32x32x16_bf16 v[64:79], v[80:83], a[48:51], v[64:79]
	s_add_u32 s36, s20, s46
	s_addc_u32 s37, s21, 0
	s_lshl_b32 s40, s45, 7
	global_load_dwordx4 a[148:151], v3, s[76:77] offset:1024
	ds_read_b128 v[80:83], v2 offset:51200
	s_waitcnt lgkmcnt(3)
	v_mfma_f32_32x32x16_bf16 v[64:79], v[84:87], a[52:55], v[64:79]
	s_lshl_b32 s41, s44, 7
	v_mov_b32 v22, s40
	v_mov_b32 v23, s41
	ds_read_b128 v[84:87], v2 offset:54272
	s_waitcnt lgkmcnt(3)
	v_mfma_f32_32x32x16_bf16 v[64:79], v[88:91], a[56:59], v[64:79]
	v_cmp_eq_u32 vcc, 0, v0
	s_nop 1
	v_cndmask_b32 v23, v22, v23, vcc
	s_cmp_ge_u32 s22, 2
	global_load_dwordx4 a[180:183], v3, s[78:79] offset:1024
	ds_read_b128 v[88:91], v18 offset:0
	s_waitcnt lgkmcnt(3)
	v_mfma_f32_32x32x16_bf16 v[64:79], v[92:95], a[60:63], v[64:79]
	s_cselect_b32 s40, 0, 0xf149f2ca
	v_mov_b32 v112, s40
	v_mov_b32 v113, s40
	ds_read_b128 v[92:95], v18 offset:3072
	s_waitcnt lgkmcnt(3)
	v_mfma_f32_32x32x16_bf16 v[64:79], v[80:83], a[64:67], v[64:79]
	v_mov_b32 v114, s40
	v_mov_b32 v115, s40
	v_mov_b32 v116, s40
	global_load_dwordx4 a[152:155], v3, s[76:77] offset:2048
	ds_read_b128 v[80:83], v18 offset:6144
	s_waitcnt lgkmcnt(3)
	v_mfma_f32_32x32x16_bf16 v[64:79], v[84:87], a[68:71], v[64:79]
	v_mov_b32 v117, s40
	v_mov_b32 v118, s40
	v_mov_b32 v119, s40
	ds_read_b128 v[84:87], v18 offset:9216
	s_waitcnt lgkmcnt(3)
	v_mfma_f32_32x32x16_bf16 v[64:79], v[88:91], a[72:75], v[64:79]
	v_mov_b32 v120, s40
	v_mov_b32 v121, s40
	v_mov_b32 v122, s40
	global_load_dwordx4 a[184:187], v3, s[78:79] offset:2048
	ds_read_b128 v[88:91], v18 offset:12288
	s_waitcnt lgkmcnt(3)
	v_mfma_f32_32x32x16_bf16 v[64:79], v[92:95], a[76:79], v[64:79]
	v_mov_b32 v123, s40
	v_mov_b32 v124, s40
	v_mov_b32 v125, s40
	ds_read_b128 v[92:95], v18 offset:15360
	s_waitcnt lgkmcnt(3)
	v_mfma_f32_32x32x16_bf16 v[64:79], v[80:83], a[80:83], v[64:79]
	s_waitcnt vmcnt(10)
	v_mov_b32 v28, s51
	s_mov_b32 exec_hi, 0
	global_store_dword v1, v28, s[38:39] sc1
	s_mov_b32 exec_hi, -1
	ds_read_b128 v[80:83], v18 offset:18432
	s_waitcnt lgkmcnt(3)
	v_mfma_f32_32x32x16_bf16 v[64:79], v[84:87], a[84:87], v[64:79]
	v_mov_b32 v126, s40
	v_mov_b32 v127, s40
	ds_read_b128 v[84:87], v18 offset:21504
	s_waitcnt lgkmcnt(3)
	v_mfma_f32_32x32x16_bf16 v[64:79], v[88:91], a[88:91], v[64:79]
	ds_read_b128 v[88:91], v18 offset:24576
	s_waitcnt lgkmcnt(3)
	v_mfma_f32_32x32x16_bf16 v[64:79], v[92:95], a[92:95], v[64:79]
	ds_read_b128 v[92:95], v18 offset:27648
	s_waitcnt lgkmcnt(3)
	v_mfma_f32_32x32x16_bf16 v[64:79], v[80:83], a[96:99], v[64:79]
	ds_read_b128 v[80:83], v18 offset:30720
	s_waitcnt lgkmcnt(3)
	v_mfma_f32_32x32x16_bf16 v[64:79], v[84:87], a[100:103], v[64:79]
	ds_read_b128 v[84:87], v18 offset:33792
	s_waitcnt lgkmcnt(3)
	v_mfma_f32_32x32x16_bf16 v[64:79], v[88:91], a[104:107], v[64:79]
	ds_read_b128 v[88:91], v18 offset:36864
	s_waitcnt lgkmcnt(3)
	v_mfma_f32_32x32x16_bf16 v[64:79], v[92:95], a[108:111], v[64:79]
	ds_read_b128 v[92:95], v18 offset:39936
	s_waitcnt lgkmcnt(3)
	v_mfma_f32_32x32x16_bf16 v[64:79], v[80:83], a[112:115], v[64:79]
	s_waitcnt lgkmcnt(2)
	v_mfma_f32_32x32x16_bf16 v[64:79], v[84:87], a[116:119], v[64:79]
	s_waitcnt lgkmcnt(1)
	v_mfma_f32_32x32x16_bf16 v[64:79], v[88:91], a[120:123], v[64:79]
	s_waitcnt lgkmcnt(0)
	v_mfma_f32_32x32x16_bf16 v[64:79], v[92:95], a[124:127], v[64:79]
	v_mfma_f32_32x32x16_bf16 v[64:79], v[184:187], v[188:191], v[64:79]
	s_lshl_b32 s46, s23, 13
	s_add_u32 s46, s46, 50987008
	s_add_u32 s38, s20, s46
	s_addc_u32 s39, s21, 0
	global_load_dword v108, v23, s[38:39] sc1
	s_nop 6
	v_pk_mul_f32 v[64:65], v[64:65], v[130:131] op_sel_hi:[1,0]
	v_pk_mul_f32 v[66:67], v[66:67], v[130:131] op_sel_hi:[1,0]
	v_pk_mul_f32 v[68:69], v[68:69], v[130:131] op_sel_hi:[1,0]
	v_pk_mul_f32 v[70:71], v[70:71], v[130:131] op_sel_hi:[1,0]
	v_pk_mul_f32 v[72:73], v[72:73], v[130:131] op_sel_hi:[1,0]
	v_pk_mul_f32 v[74:75], v[74:75], v[130:131] op_sel_hi:[1,0]
	v_pk_mul_f32 v[76:77], v[76:77], v[130:131] op_sel_hi:[1,0]
	v_pk_mul_f32 v[78:79], v[78:79], v[130:131] op_sel_hi:[1,0]
	v_cvt_pk_bf16_f32 v164, v64, v65
	v_cvt_pk_bf16_f32 v165, v66, v67
	v_cvt_pk_bf16_f32 v166, v68, v69
	v_cvt_pk_bf16_f32 v167, v70, v71
	v_cvt_pk_bf16_f32 v168, v72, v73
	v_cvt_pk_bf16_f32 v169, v74, v75
	v_cvt_pk_bf16_f32 v170, v76, v77
	v_cvt_pk_bf16_f32 v171, v78, v79
	s_lshl_b32 s40, s24, 11
	s_add_u32 s40, s40, 155648
	v_add_u32 v22, s40, v2
	ds_write_b128 v22, v[164:167] offset:0
	ds_write_b128 v22, v[168:171] offset:1024
	s_lshl_b32 s40, s60, 11
	s_lshl_b32 s41, s63, 10
	s_add_u32 s41, s41, 155648
	s_add_u32 s40, s40, s41
	v_add_u32 v22, s40, v2
	s_lshl_b32 s40, s61, 11
	s_add_u32 s40, s40, s41
	v_add_u32 v28, s40, v2
	s_mov_b32 s62, 0
	s_waitcnt lgkmcnt(0)
	s_barrier
	ds_read_b128 v[164:167], v22
	ds_read_b128 v[168:171], v28
	global_load_dword v109, v23, s[38:39] sc1
	s_cmp_eq_u32 s60, 0
	s_cbranch_scc0 L_alt_60
	ds_read_b128 v[80:83], v104 offset:45056
	ds_read_b128 v[84:87], v104 offset:32768
	s_waitcnt lgkmcnt(1)
	v_mfma_f32_32x32x16_bf16 v[32:47], v[80:83], v[168:171], v[208:223]
	s_waitcnt lgkmcnt(0)
	v_mfma_f32_32x32x16_bf16 v[48:63], v[84:87], v[164:167], v[208:223]
	v_mad_u32_u24 v172, v175, 11, v174
	s_nop 8
	v_exp_f32 v32, v32
	v_exp_f32 v33, v33
	v_exp_f32 v34, v34
	v_exp_f32 v35, v35
	ds_read_b128 v[80:83], v104 offset:40960
	v_exp_f32 v36, v36
	v_exp_f32 v37, v37
	v_exp_f32 v38, v38
	v_exp_f32 v39, v39
	v_exp_f32 v40, v40
	v_exp_f32 v41, v41
	ds_read_b128 v[88:91], v172 offset:0
	ds_read_b128 v[92:95], v172 offset:1024
	v_exp_f32 v42, v42
	v_exp_f32 v43, v43
	v_exp_f32 v44, v44
	v_exp_f32 v45, v45
	v_exp_f32 v46, v46
	v_exp_f32 v47, v47
	v_cvt_pk_bf16_f32 v64, v32, v33
	v_cvt_pk_bf16_f32 v65, v34, v35
	v_cvt_pk_bf16_f32 v66, v36, v37
	v_cvt_pk_bf16_f32 v67, v38, v39
	v_cvt_pk_bf16_f32 v68, v40, v41
	v_cvt_pk_bf16_f32 v69, v42, v43
	v_cvt_pk_bf16_f32 v70, v44, v45
	v_cvt_pk_bf16_f32 v71, v46, v47
	global_load_dword v110, v23, s[38:39] sc1
	s_nop 3
	s_cmp_eq_u32 s62, 1
	s_cbranch_scc1 L_hchk_62
	s_waitcnt vmcnt(2)
	v_cmp_ne_u32 vcc, s51, v108
	s_nop 4
	s_cbranch_vccnz L_hchk_62
	s_lshl_b32 s40, s24, 13
	s_add_u32 m0, s40, 98304
	s_nop 0
	global_load_lds_dwordx4 v2, s[34:35] offset:0
	global_load_lds_dwordx4 v2, s[34:35] offset:1024
	global_load_lds_dwordx4 v2, s[34:35] offset:2048
	global_load_lds_dwordx4 v2, s[34:35] offset:3072
	s_lshl_b32 s40, s24, 13
	s_add_u32 m0, s40, 102400
	s_nop 0
	global_load_lds_dwordx4 v2, s[36:37] offset:0
	global_load_lds_dwordx4 v2, s[36:37] offset:1024
	global_load_lds_dwordx4 v2, s[36:37] offset:2048
	global_load_lds_dwordx4 v2, s[36:37] offset:3072
	s_mov_b32 s62, 1
L_hchk_62:
	s_waitcnt lgkmcnt(2)
	v_mfma_f32_32x32x16_bf16 v[32:47], v[80:83], v[168:171], 0
	v_mad_u32_u24 v173, v175, 8, v174
	v_exp_f32 v48, v48
	v_exp_f32 v49, v49
	v_exp_f32 v50, v50
	v_exp_f32 v51, v51
	s_waitcnt lgkmcnt(1)
	v_mfma_f32_32x32x16_bf16 v[192:207], v[88:91], v[64:67], 0
	ds_read_b128 v[84:87], v104 offset:36864
	v_exp_f32 v52, v52
	v_exp_f32 v53, v53
	v_exp_f32 v54, v54
	v_exp_f32 v55, v55
	v_exp_f32 v56, v56
	v_exp_f32 v57, v57
	ds_read_b128 v[96:99], v173 offset:0
	ds_read_b128 v[100:103], v173 offset:1024
	s_waitcnt lgkmcnt(3)
	v_mfma_f32_32x32x16_bf16 v[192:207], v[92:95], v[68:71], v[192:207]
	v_exp_f32 v58, v58
	v_exp_f32 v59, v59
	v_exp_f32 v60, v60
	v_exp_f32 v61, v61
	v_exp_f32 v62, v62
	v_exp_f32 v63, v63
	v_cvt_pk_bf16_f32 v72, v48, v49
	v_cvt_pk_bf16_f32 v73, v50, v51
	v_cvt_pk_bf16_f32 v74, v52, v53
	v_cvt_pk_bf16_f32 v75, v54, v55
	v_cvt_pk_bf16_f32 v76, v56, v57
	v_cvt_pk_bf16_f32 v77, v58, v59
	v_cvt_pk_bf16_f32 v78, v60, v61
	v_cvt_pk_bf16_f32 v79, v62, v63
	global_load_dword v111, v23, s[38:39] sc1
	s_nop 3
	s_cmp_eq_u32 s62, 1
	s_cbranch_scc1 L_hchk_63
	s_waitcnt vmcnt(2)
	v_cmp_ne_u32 vcc, s51, v109
	s_nop 4
	s_cbranch_vccnz L_hchk_63
	s_lshl_b32 s40, s24, 13
	s_add_u32 m0, s40, 98304
	s_nop 0
	global_load_lds_dwordx4 v2, s[34:35] offset:0
	global_load_lds_dwordx4 v2, s[34:35] offset:1024
	global_load_lds_dwordx4 v2, s[34:35] offset:2048
	global_load_lds_dwordx4 v2, s[34:35] offset:3072
	s_lshl_b32 s40, s24, 13
	s_add_u32 m0, s40, 102400
	s_nop 0
	global_load_lds_dwordx4 v2, s[36:37] offset:0
	global_load_lds_dwordx4 v2, s[36:37] offset:1024
	global_load_lds_dwordx4 v2, s[36:37] offset:2048
	global_load_lds_dwordx4 v2, s[36:37] offset:3072
	s_mov_b32 s62, 1
L_hchk_63:
	s_waitcnt lgkmcnt(2)
	v_mfma_f32_32x32x16_bf16 v[48:63], v[84:87], v[168:171], 0
	v_mad_u32_u24 v172, v175, 10, v174
	v_exp_f32 v32, v32
	v_exp_f32 v33, v33
	v_exp_f32 v34, v34
	v_exp_f32 v35, v35
	s_waitcnt lgkmcnt(1)
	v_mfma_f32_32x32x16_bf16 v[176:191], v[96:99], v[72:75], 0
	ds_read_b128 v[80:83], v104 offset:32768
	v_exp_f32 v36, v36
	v_exp_f32 v37, v37
	v_exp_f32 v38, v38
	v_exp_f32 v39, v39
	v_exp_f32 v40, v40
	v_exp_f32 v41, v41
	ds_read_b128 v[88:91], v172 offset:0
	ds_read_b128 v[92:95], v172 offset:1024
	s_waitcnt lgkmcnt(3)
	v_mfma_f32_32x32x16_bf16 v[176:191], v[100:103], v[76:79], v[176:191]
	v_exp_f32 v42, v42
	v_exp_f32 v43, v43
	v_exp_f32 v44, v44
	v_exp_f32 v45, v45
	v_exp_f32 v46, v46
	v_exp_f32 v47, v47
	v_cvt_pk_bf16_f32 v64, v32, v33
	v_cvt_pk_bf16_f32 v65, v34, v35
	v_cvt_pk_bf16_f32 v66, v36, v37
	v_cvt_pk_bf16_f32 v67, v38, v39
	v_cvt_pk_bf16_f32 v68, v40, v41
	v_cvt_pk_bf16_f32 v69, v42, v43
	v_cvt_pk_bf16_f32 v70, v44, v45
	v_cvt_pk_bf16_f32 v71, v46, v47
	s_nop 4
	s_cmp_eq_u32 s62, 1
	s_cbranch_scc1 L_hchk_64
	s_waitcnt vmcnt(1)
	v_cmp_ne_u32 vcc, s51, v110
	s_nop 4
	s_cbranch_vccnz L_hchk_64
	s_lshl_b32 s40, s24, 13
	s_add_u32 m0, s40, 98304
	s_nop 0
	global_load_lds_dwordx4 v2, s[34:35] offset:0
	global_load_lds_dwordx4 v2, s[34:35] offset:1024
	global_load_lds_dwordx4 v2, s[34:35] offset:2048
	global_load_lds_dwordx4 v2, s[34:35] offset:3072
	s_lshl_b32 s40, s24, 13
	s_add_u32 m0, s40, 102400
	s_nop 0
	global_load_lds_dwordx4 v2, s[36:37] offset:0
	global_load_lds_dwordx4 v2, s[36:37] offset:1024
	global_load_lds_dwordx4 v2, s[36:37] offset:2048
	global_load_lds_dwordx4 v2, s[36:37] offset:3072
	s_mov_b32 s62, 1
L_hchk_64:
	s_waitcnt lgkmcnt(2)
	v_mfma_f32_32x32x16_bf16 v[32:47], v[80:83], v[168:171], 0
	v_mad_u32_u24 v173, v175, 9, v174
	v_exp_f32 v48, v48
	v_exp_f32 v49, v49
	v_exp_f32 v50, v50
	v_exp_f32 v51, v51
	s_waitcnt lgkmcnt(1)
	v_mfma_f32_32x32x16_bf16 v[192:207], v[88:91], v[64:67], v[192:207]
	v_exp_f32 v52, v52
	v_exp_f32 v53, v53
	v_exp_f32 v54, v54
	v_exp_f32 v55, v55
	v_exp_f32 v56, v56
	v_exp_f32 v57, v57
	ds_read_b128 v[96:99], v173 offset:0
	ds_read_b128 v[100:103], v173 offset:1024
	s_waitcnt lgkmcnt(2)
	v_mfma_f32_32x32x16_bf16 v[192:207], v[92:95], v[68:71], v[192:207]
	v_exp_f32 v58, v58
	v_exp_f32 v59, v59
	v_exp_f32 v60, v60
	v_exp_f32 v61, v61
	v_exp_f32 v62, v62
	v_exp_f32 v63, v63
	v_cvt_pk_bf16_f32 v72, v48, v49
	v_cvt_pk_bf16_f32 v73, v50, v51
	v_cvt_pk_bf16_f32 v74, v52, v53
	v_cvt_pk_bf16_f32 v75, v54, v55
	v_cvt_pk_bf16_f32 v76, v56, v57
	v_cvt_pk_bf16_f32 v77, v58, v59
	v_cvt_pk_bf16_f32 v78, v60, v61
	v_cvt_pk_bf16_f32 v79, v62, v63
	s_nop 4
	s_cmp_eq_u32 s62, 1
	s_cbranch_scc1 L_hchk_65
	s_waitcnt vmcnt(0)
	v_cmp_ne_u32 vcc, s51, v111
	s_nop 4
	s_cbranch_vccnz L_hchk_65
	s_lshl_b32 s40, s24, 13
	s_add_u32 m0, s40, 98304
	s_nop 0
	global_load_lds_dwordx4 v2, s[34:35] offset:0
	global_load_lds_dwordx4 v2, s[34:35] offset:1024
	global_load_lds_dwordx4 v2, s[34:35] offset:2048
	global_load_lds_dwordx4 v2, s[34:35] offset:3072
	s_lshl_b32 s40, s24, 13
	s_add_u32 m0, s40, 102400
	s_nop 0
	global_load_lds_dwordx4 v2, s[36:37] offset:0
	global_load_lds_dwordx4 v2, s[36:37] offset:1024
	global_load_lds_dwordx4 v2, s[36:37] offset:2048
	global_load_lds_dwordx4 v2, s[36:37] offset:3072
	s_mov_b32 s62, 1
L_hchk_65:
	v_mad_u32_u24 v172, v175, 8, v174
	v_exp_f32 v32, v32
	v_exp_f32 v33, v33
	v_exp_f32 v34, v34
	v_exp_f32 v35, v35
	s_waitcnt lgkmcnt(1)
	v_mfma_f32_32x32x16_bf16 v[192:207], v[96:99], v[72:75], v[192:207]
	v_exp_f32 v36, v36
	v_exp_f32 v37, v37
	v_exp_f32 v38, v38
	v_exp_f32 v39, v39
	v_exp_f32 v40, v40
	v_exp_f32 v41, v41
	ds_read_b128 v[88:91], v172 offset:0
	ds_read_b128 v[92:95], v172 offset:1024
	s_waitcnt lgkmcnt(2)
	v_mfma_f32_32x32x16_bf16 v[192:207], v[100:103], v[76:79], v[192:207]
	v_exp_f32 v42, v42
	v_exp_f32 v43, v43
	v_exp_f32 v44, v44
	v_exp_f32 v45, v45
	v_exp_f32 v46, v46
	v_exp_f32 v47, v47
	v_cvt_pk_bf16_f32 v64, v32, v33
	v_cvt_pk_bf16_f32 v65, v34, v35
	v_cvt_pk_bf16_f32 v66, v36, v37
	v_cvt_pk_bf16_f32 v67, v38, v39
	v_cvt_pk_bf16_f32 v68, v40, v41
	v_cvt_pk_bf16_f32 v69, v42, v43
	v_cvt_pk_bf16_f32 v70, v44, v45
	v_cvt_pk_bf16_f32 v71, v46, v47
	s_nop 4
	s_cmp_eq_u32 s62, 1
	s_cbranch_scc1 L_hfin_66
	s_mov_b32 s49, 0
	s_nop 1
L_poll_67:
	global_load_dword v28, v23, s[38:39] sc1
	s_waitcnt vmcnt(0)
	v_cmp_ne_u32 vcc, s51, v28
	s_nop 4
	s_cbranch_vccz L_pollout_68
	s_add_u32 s49, s49, 1
	s_cmp_ge_u32 s49, s26
	s_cbranch_scc0 L_poll_67
	s_mov_b32 s26, 1
L_pollout_68:
	s_lshl_b32 s40, s24, 13
	s_add_u32 m0, s40, 98304
	s_nop 0
	global_load_lds_dwordx4 v2, s[34:35] offset:0
	global_load_lds_dwordx4 v2, s[34:35] offset:1024
	global_load_lds_dwordx4 v2, s[34:35] offset:2048
	global_load_lds_dwordx4 v2, s[34:35] offset:3072
	s_lshl_b32 s40, s24, 13
	s_add_u32 m0, s40, 102400
	s_nop 0
	global_load_lds_dwordx4 v2, s[36:37] offset:0
	global_load_lds_dwordx4 v2, s[36:37] offset:1024
	global_load_lds_dwordx4 v2, s[36:37] offset:2048
	global_load_lds_dwordx4 v2, s[36:37] offset:3072
	s_mov_b32 s62, 1
L_hfin_66:
	s_waitcnt vmcnt(0)
	s_barrier
	ds_read_b128 v[84:87], v104 offset:28672
	ds_read_b128 v[80:83], v104 offset:28672
	s_waitcnt lgkmcnt(1)
	v_mfma_f32_32x32x16_bf16 v[48:63], v[84:87], v[164:167], v[224:239]
	v_mfma_f32_32x32x16_bf16 v[192:207], v[88:91], v[64:67], v[192:207]
	v_mfma_f32_32x32x16_bf16 v[192:207], v[92:95], v[68:71], v[192:207]
	s_waitcnt lgkmcnt(0)
	v_mfma_f32_32x32x16_bf16 v[32:47], v[80:83], v[168:171], v[224:239]
	v_mad_u32_u24 v173, v175, 7, v174
	s_nop 6
	v_exp_f32 v48, v48
	v_exp_f32 v49, v49
	global_load_dwordx4 a[156:159], v3, s[76:77] offset:3072
	v_exp_f32 v50, v50
	v_exp_f32 v51, v51
	ds_read_b128 v[84:87], v104 offset:24576
	v_exp_f32 v52, v52
	v_exp_f32 v53, v53
	v_exp_f32 v54, v54
	v_exp_f32 v55, v55
	v_exp_f32 v56, v56
	global_load_dwordx4 a[188:191], v3, s[78:79] offset:3072
	v_exp_f32 v57, v57
	ds_read_b128 v[96:99], v173 offset:0
	ds_read_b128 v[100:103], v173 offset:1024
	v_exp_f32 v58, v58
	v_exp_f32 v59, v59
	v_exp_f32 v60, v60
	v_exp_f32 v61, v61
	v_exp_f32 v62, v62
	s_add_u32 m0, s66, 0
	s_nop 0
	global_load_lds_dwordx4 v2, s[64:65] offset:0
	v_exp_f32 v63, v63
	v_cvt_pk_bf16_f32 v72, v48, v49
	v_cvt_pk_bf16_f32 v73, v50, v51
	v_cvt_pk_bf16_f32 v74, v52, v53
	v_cvt_pk_bf16_f32 v75, v54, v55
	v_cvt_pk_bf16_f32 v76, v56, v57
	v_cvt_pk_bf16_f32 v77, v58, v59
	v_cvt_pk_bf16_f32 v78, v60, v61
	v_cvt_pk_bf16_f32 v79, v62, v63
	s_waitcnt lgkmcnt(2)
	v_mfma_f32_32x32x16_bf16 v[48:63], v[84:87], v[164:167], v[224:239]
	v_mad_u32_u24 v172, v175, 7, v174
	v_exp_f32 v32, v32
	v_exp_f32 v33, v33
	global_load_lds_dwordx4 v2, s[64:65] offset:1024
	v_exp_f32 v34, v34
	v_exp_f32 v35, v35
	s_waitcnt lgkmcnt(1)
	v_mfma_f32_32x32x16_bf16 v[176:191], v[96:99], v[72:75], v[176:191]
	ds_read_b128 v[80:83], v104 offset:24576
	v_exp_f32 v36, v36
	v_exp_f32 v37, v37
	v_exp_f32 v38, v38
	v_exp_f32 v39, v39
	v_exp_f32 v40, v40
	global_load_lds_dwordx4 v2, s[64:65] offset:2048
	v_exp_f32 v41, v41
	ds_read_b128 v[88:91], v172 offset:0
	ds_read_b128 v[92:95], v172 offset:1024
	s_waitcnt lgkmcnt(3)
	v_mfma_f32_32x32x16_bf16 v[176:191], v[100:103], v[76:79], v[176:191]
	v_exp_f32 v42, v42
	v_exp_f32 v43, v43
	v_exp_f32 v44, v44
	v_exp_f32 v45, v45
	v_exp_f32 v46, v46
	global_load_lds_dwordx4 v2, s[64:65] offset:3072
	v_exp_f32 v47, v47
	v_cvt_pk_bf16_f32 v64, v32, v33
	v_cvt_pk_bf16_f32 v65, v34, v35
	v_cvt_pk_bf16_f32 v66, v36, v37
	v_cvt_pk_bf16_f32 v67, v38, v39
	v_cvt_pk_bf16_f32 v68, v40, v41
	v_cvt_pk_bf16_f32 v69, v42, v43
	v_cvt_pk_bf16_f32 v70, v44, v45
	v_cvt_pk_bf16_f32 v71, v46, v47
	s_waitcnt lgkmcnt(2)
	v_mfma_f32_32x32x16_bf16 v[32:47], v[80:83], v[168:171], v[224:239]
	v_mad_u32_u24 v173, v175, 6, v174
	v_exp_f32 v48, v48
	v_exp_f32 v49, v49
	s_add_u32 m0, s66, 4096
	s_nop 0
	global_load_lds_dwordx4 v3, s[64:65] offset:0
	v_exp_f32 v50, v50
	v_exp_f32 v51, v51
	s_waitcnt lgkmcnt(1)
	v_mfma_f32_32x32x16_bf16 v[192:207], v[88:91], v[64:67], v[192:207]
	ds_read_b128 v[84:87], v104 offset:20480
	v_exp_f32 v52, v52
	v_exp_f32 v53, v53
	v_exp_f32 v54, v54
	v_exp_f32 v55, v55
	v_exp_f32 v56, v56
	global_load_lds_dwordx4 v3, s[64:65] offset:1024
	v_exp_f32 v57, v57
	ds_read_b128 v[96:99], v173 offset:0
	ds_read_b128 v[100:103], v173 offset:1024
	s_waitcnt lgkmcnt(3)
	v_mfma_f32_32x32x16_bf16 v[192:207], v[92:95], v[68:71], v[192:207]
	v_exp_f32 v58, v58
	v_exp_f32 v59, v59
	v_exp_f32 v60, v60
	v_exp_f32 v61, v61
	v_exp_f32 v62, v62
	global_load_lds_dwordx4 v3, s[64:65] offset:2048
	s_add_u32 s64, s64, 28672
	s_addc_u32 s65, s65, 0
	v_exp_f32 v63, v63
	v_cvt_pk_bf16_f32 v72, v48, v49
	v_cvt_pk_bf16_f32 v73, v50, v51
	v_cvt_pk_bf16_f32 v74, v52, v53
	v_cvt_pk_bf16_f32 v75, v54, v55
	v_cvt_pk_bf16_f32 v76, v56, v57
	v_cvt_pk_bf16_f32 v77, v58, v59
	v_cvt_pk_bf16_f32 v78, v60, v61
	v_cvt_pk_bf16_f32 v79, v62, v63
	s_waitcnt lgkmcnt(2)
	v_mfma_f32_32x32x16_bf16 v[48:63], v[84:87], v[164:167], v[224:239]
	v_mad_u32_u24 v172, v175, 6, v174
	v_exp_f32 v32, v32
	v_exp_f32 v33, v33
	s_add_u32 m0, s66, 28672
	s_nop 0
	global_load_lds_dwordx4 v2, s[64:65] offset:0
	v_exp_f32 v34, v34
	v_exp_f32 v35, v35
	s_waitcnt lgkmcnt(1)
	v_mfma_f32_32x32x16_bf16 v[176:191], v[96:99], v[72:75], v[176:191]
	ds_read_b128 v[80:83], v104 offset:20480
	v_exp_f32 v36, v36
	v_exp_f32 v37, v37
	v_exp_f32 v38, v38
	v_exp_f32 v39, v39
	v_exp_f32 v40, v40
	global_load_lds_dwordx4 v2, s[64:65] offset:1024
	v_exp_f32 v41, v41
	ds_read_b128 v[88:91], v172 offset:0
	ds_read_b128 v[92:95], v172 offset:1024
	s_waitcnt lgkmcnt(3)
	v_mfma_f32_32x32x16_bf16 v[176:191], v[100:103], v[76:79], v[176:191]
	v_exp_f32 v42, v42
	v_exp_f32 v43, v43
	v_exp_f32 v44, v44
	v_exp_f32 v45, v45
	v_exp_f32 v46, v46
	global_load_lds_dwordx4 v2, s[64:65] offset:2048
	v_exp_f32 v47, v47
	v_cvt_pk_bf16_f32 v64, v32, v33
	v_cvt_pk_bf16_f32 v65, v34, v35
	v_cvt_pk_bf16_f32 v66, v36, v37
	v_cvt_pk_bf16_f32 v67, v38, v39
	v_cvt_pk_bf16_f32 v68, v40, v41
	v_cvt_pk_bf16_f32 v69, v42, v43
	v_cvt_pk_bf16_f32 v70, v44, v45
	v_cvt_pk_bf16_f32 v71, v46, v47
	s_waitcnt lgkmcnt(2)
	v_mfma_f32_32x32x16_bf16 v[32:47], v[80:83], v[168:171], v[224:239]
	v_mad_u32_u24 v173, v175, 5, v174
	v_exp_f32 v48, v48
	v_exp_f32 v49, v49
	global_load_lds_dwordx4 v2, s[64:65] offset:3072
	v_exp_f32 v50, v50
	v_exp_f32 v51, v51
	s_waitcnt lgkmcnt(1)
	v_mfma_f32_32x32x16_bf16 v[192:207], v[88:91], v[64:67], v[192:207]
	ds_read_b128 v[84:87], v104 offset:16384
	v_exp_f32 v52, v52
	v_exp_f32 v53, v53
	v_exp_f32 v54, v54
	v_exp_f32 v55, v55
	v_exp_f32 v56, v56
	s_add_u32 m0, s66, 32768
	s_nop 0
	global_load_lds_dwordx4 v3, s[64:65] offset:0
	v_exp_f32 v57, v57
	ds_read_b128 v[96:99], v173 offset:0
	ds_read_b128 v[100:103], v173 offset:1024
	s_waitcnt lgkmcnt(3)
	v_mfma_f32_32x32x16_bf16 v[192:207], v[92:95], v[68:71], v[192:207]
	v_exp_f32 v58, v58
	v_exp_f32 v59, v59
	v_exp_f32 v60, v60
	v_exp_f32 v61, v61
	v_exp_f32 v62, v62
	global_load_lds_dwordx4 v3, s[64:65] offset:1024
	v_exp_f32 v63, v63
	v_cvt_pk_bf16_f32 v72, v48, v49
	v_cvt_pk_bf16_f32 v73, v50, v51
	v_cvt_pk_bf16_f32 v74, v52, v53
	v_cvt_pk_bf16_f32 v75, v54, v55
	v_cvt_pk_bf16_f32 v76, v56, v57
	v_cvt_pk_bf16_f32 v77, v58, v59
	v_cvt_pk_bf16_f32 v78, v60, v61
	v_cvt_pk_bf16_f32 v79, v62, v63
	s_waitcnt lgkmcnt(2)
	v_mfma_f32_32x32x16_bf16 v[48:63], v[84:87], v[164:167], v[224:239]
	v_mad_u32_u24 v172, v175, 5, v174
	v_exp_f32 v32, v32
	v_exp_f32 v33, v33
	global_load_lds_dwordx4 v3, s[64:65] offset:2048
	s_add_u32 s64, s64, 28672
	s_addc_u32 s65, s65, 0
	v_exp_f32 v34, v34
	v_exp_f32 v35, v35
	s_waitcnt lgkmcnt(1)
	v_mfma_f32_32x32x16_bf16 v[176:191], v[96:99], v[72:75], v[176:191]
	ds_read_b128 v[80:83], v104 offset:16384
	v_exp_f32 v36, v36
	v_exp_f32 v37, v37
	v_exp_f32 v38, v38
	v_exp_f32 v39, v39
	v_exp_f32 v40, v40
	s_add_u32 m0, s66, 57344
	s_nop 0
	global_load_lds_dwordx4 v2, s[64:65] offset:0
	v_exp_f32 v41, v41
	ds_read_b128 v[88:91], v172 offset:0
	ds_read_b128 v[92:95], v172 offset:1024
	s_waitcnt lgkmcnt(3)
	v_mfma_f32_32x32x16_bf16 v[176:191], v[100:103], v[76:79], v[176:191]
	v_exp_f32 v42, v42
	v_exp_f32 v43, v43
	v_exp_f32 v44, v44
	v_exp_f32 v45, v45
	v_exp_f32 v46, v46
	global_load_lds_dwordx4 v2, s[64:65] offset:1024
	v_exp_f32 v47, v47
	v_cvt_pk_bf16_f32 v64, v32, v33
	v_cvt_pk_bf16_f32 v65, v34, v35
	v_cvt_pk_bf16_f32 v66, v36, v37
	v_cvt_pk_bf16_f32 v67, v38, v39
	v_cvt_pk_bf16_f32 v68, v40, v41
	v_cvt_pk_bf16_f32 v69, v42, v43
	v_cvt_pk_bf16_f32 v70, v44, v45
	v_cvt_pk_bf16_f32 v71, v46, v47
	s_waitcnt lgkmcnt(2)
	v_mfma_f32_32x32x16_bf16 v[32:47], v[80:83], v[168:171], v[224:239]
	v_mad_u32_u24 v173, v175, 4, v174
	v_exp_f32 v48, v48
	v_exp_f32 v49, v49
	global_load_lds_dwordx4 v2, s[64:65] offset:2048
	v_exp_f32 v50, v50
	v_exp_f32 v51, v51
	s_waitcnt lgkmcnt(1)
	v_mfma_f32_32x32x16_bf16 v[192:207], v[88:91], v[64:67], v[192:207]
	ds_read_b128 v[84:87], v104 offset:12288
	v_exp_f32 v52, v52
	v_exp_f32 v53, v53
	v_exp_f32 v54, v54
	v_exp_f32 v55, v55
	v_exp_f32 v56, v56
	global_load_lds_dwordx4 v2, s[64:65] offset:3072
	v_exp_f32 v57, v57
	ds_read_b128 v[96:99], v173 offset:0
	ds_read_b128 v[100:103], v173 offset:1024
	s_waitcnt lgkmcnt(3)
	v_mfma_f32_32x32x16_bf16 v[192:207], v[92:95], v[68:71], v[192:207]
	v_exp_f32 v58, v58
	v_exp_f32 v59, v59
	v_exp_f32 v60, v60
	v_exp_f32 v61, v61
	v_exp_f32 v62, v62
	s_add_u32 m0, s66, 61440
	s_nop 0
	global_load_lds_dwordx4 v3, s[64:65] offset:0
	v_exp_f32 v63, v63
	v_cvt_pk_bf16_f32 v72, v48, v49
	v_cvt_pk_bf16_f32 v73, v50, v51
	v_cvt_pk_bf16_f32 v74, v52, v53
	v_cvt_pk_bf16_f32 v75, v54, v55
	v_cvt_pk_bf16_f32 v76, v56, v57
	v_cvt_pk_bf16_f32 v77, v58, v59
	v_cvt_pk_bf16_f32 v78, v60, v61
	v_cvt_pk_bf16_f32 v79, v62, v63
	s_waitcnt lgkmcnt(2)
	v_mfma_f32_32x32x16_bf16 v[48:63], v[84:87], v[164:167], v[112:127]
	v_mad_u32_u24 v172, v175, 4, v174
	v_exp_f32 v32, v32
	v_exp_f32 v33, v33
	global_load_lds_dwordx4 v3, s[64:65] offset:1024
	v_exp_f32 v34, v34
	v_exp_f32 v35, v35
	s_waitcnt lgkmcnt(1)
	v_mfma_f32_32x32x16_bf16 v[176:191], v[96:99], v[72:75], v[176:191]
	ds_read_b128 v[80:83], v104 offset:12288
	v_exp_f32 v36, v36
	v_exp_f32 v37, v37
	v_exp_f32 v38, v38
	v_exp_f32 v39, v39
	v_exp_f32 v40, v40
	global_load_lds_dwordx4 v3, s[64:65] offset:2048
	s_add_u32 s64, s64, 28672
	s_addc_u32 s65, s65, 0
	v_exp_f32 v41, v41
	ds_read_b128 v[88:91], v172 offset:0
	ds_read_b128 v[92:95], v172 offset:1024
	s_waitcnt lgkmcnt(3)
	v_mfma_f32_32x32x16_bf16 v[176:191], v[100:103], v[76:79], v[176:191]
	v_exp_f32 v42, v42
	v_exp_f32 v43, v43
	v_exp_f32 v44, v44
	v_exp_f32 v45, v45
	v_exp_f32 v46, v46
	global_load_dwordx4 a[0:3], v2, s[72:73] offset:0
	v_exp_f32 v47, v47
	v_cvt_pk_bf16_f32 v64, v32, v33
	v_cvt_pk_bf16_f32 v65, v34, v35
	v_cvt_pk_bf16_f32 v66, v36, v37
	v_cvt_pk_bf16_f32 v67, v38, v39
	v_cvt_pk_bf16_f32 v68, v40, v41
	v_cvt_pk_bf16_f32 v69, v42, v43
	v_cvt_pk_bf16_f32 v70, v44, v45
	v_cvt_pk_bf16_f32 v71, v46, v47
	s_waitcnt lgkmcnt(2)
	v_mfma_f32_32x32x16_bf16 v[32:47], v[80:83], v[168:171], v[240:255]
	v_mad_u32_u24 v173, v175, 3, v174
	v_exp_f32 v48, v48
	v_exp_f32 v49, v49
	global_load_dwordx4 a[4:7], v2, s[74:75] offset:0
	v_exp_f32 v50, v50
	v_exp_f32 v51, v51
	s_waitcnt lgkmcnt(1)
	v_mfma_f32_32x32x16_bf16 v[192:207], v[88:91], v[64:67], v[192:207]
	ds_read_b128 v[84:87], v104 offset:8192
	v_exp_f32 v52, v52
	v_exp_f32 v53, v53
	v_exp_f32 v54, v54
	v_exp_f32 v55, v55
	v_exp_f32 v56, v56
	global_load_dwordx4 a[8:11], v2, s[72:73] offset:1024
	v_exp_f32 v57, v57
	ds_read_b128 v[96:99], v173 offset:0
	ds_read_b128 v[100:103], v173 offset:1024
	s_waitcnt lgkmcnt(3)
	v_mfma_f32_32x32x16_bf16 v[192:207], v[92:95], v[68:71], v[192:207]
	v_exp_f32 v58, v58
	v_exp_f32 v59, v59
	v_exp_f32 v60, v60
	v_exp_f32 v61, v61
	v_exp_f32 v62, v62
	global_load_dwordx4 a[12:15], v2, s[74:75] offset:1024
	v_exp_f32 v63, v63
	v_cvt_pk_bf16_f32 v72, v48, v49
	v_cvt_pk_bf16_f32 v73, v50, v51
	v_cvt_pk_bf16_f32 v74, v52, v53
	v_cvt_pk_bf16_f32 v75, v54, v55
	v_cvt_pk_bf16_f32 v76, v56, v57
	v_cvt_pk_bf16_f32 v77, v58, v59
	v_cvt_pk_bf16_f32 v78, v60, v61
	v_cvt_pk_bf16_f32 v79, v62, v63
	s_waitcnt lgkmcnt(2)
	v_mfma_f32_32x32x16_bf16 v[48:63], v[84:87], v[164:167], v[112:127]
	v_mad_u32_u24 v172, v175, 3, v174
	v_exp_f32 v32, v32
	v_exp_f32 v33, v33
	global_load_dwordx4 a[16:19], v2, s[72:73] offset:2048
	v_exp_f32 v34, v34
	v_exp_f32 v35, v35
	s_waitcnt lgkmcnt(1)
	v_mfma_f32_32x32x16_bf16 v[176:191], v[96:99], v[72:75], v[176:191]
	ds_read_b128 v[80:83], v104 offset:4096
	v_exp_f32 v36, v36
	v_exp_f32 v37, v37
	v_exp_f32 v38, v38
	v_exp_f32 v39, v39
	v_exp_f32 v40, v40
	global_load_dwordx4 a[20:23], v2, s[74:75] offset:2048
	v_exp_f32 v41, v41
	ds_read_b128 v[88:91], v172 offset:0
	ds_read_b128 v[92:95], v172 offset:1024
	s_waitcnt lgkmcnt(3)
	v_mfma_f32_32x32x16_bf16 v[176:191], v[100:103], v[76:79], v[176:191]
	v_exp_f32 v42, v42
	v_exp_f32 v43, v43
	v_exp_f32 v44, v44
	v_exp_f32 v45, v45
	v_exp_f32 v46, v46
	global_load_dwordx4 a[24:27], v2, s[72:73] offset:3072
	v_exp_f32 v47, v47
	v_cvt_pk_bf16_f32 v64, v32, v33
	v_cvt_pk_bf16_f32 v65, v34, v35
	v_cvt_pk_bf16_f32 v66, v36, v37
	v_cvt_pk_bf16_f32 v67, v38, v39
	v_cvt_pk_bf16_f32 v68, v40, v41
	v_cvt_pk_bf16_f32 v69, v42, v43
	v_cvt_pk_bf16_f32 v70, v44, v45
	v_cvt_pk_bf16_f32 v71, v46, v47
	s_waitcnt lgkmcnt(2)
	v_mfma_f32_32x32x16_bf16 v[32:47], v[80:83], v[164:167], v[112:127]
	v_mad_u32_u24 v173, v175, 2, v174
	v_exp_f32 v48, v48
	v_exp_f32 v49, v49
	global_load_dwordx4 a[28:31], v2, s[74:75] offset:3072
	v_exp_f32 v50, v50
	v_exp_f32 v51, v51
	s_waitcnt lgkmcnt(1)
	v_mfma_f32_32x32x16_bf16 v[192:207], v[88:91], v[64:67], v[192:207]
	ds_read_b128 v[84:87], v104 offset:0
	v_exp_f32 v52, v52
	v_exp_f32 v53, v53
	v_exp_f32 v54, v54
	v_exp_f32 v55, v55
	v_exp_f32 v56, v56
	global_load_dwordx4 a[32:35], v3, s[72:73] offset:0
	v_exp_f32 v57, v57
	ds_read_b128 v[96:99], v173 offset:0
	ds_read_b128 v[100:103], v173 offset:1024
	s_waitcnt lgkmcnt(3)
	v_mfma_f32_32x32x16_bf16 v[192:207], v[92:95], v[68:71], v[192:207]
	v_exp_f32 v58, v58
	v_exp_f32 v59, v59
	v_exp_f32 v60, v60
	v_exp_f32 v61, v61
	v_exp_f32 v62, v62
	global_load_dwordx4 a[36:39], v3, s[74:75] offset:0
	v_exp_f32 v63, v63
	v_cvt_pk_bf16_f32 v72, v48, v49
	v_cvt_pk_bf16_f32 v73, v50, v51
	v_cvt_pk_bf16_f32 v74, v52, v53
	v_cvt_pk_bf16_f32 v75, v54, v55
	v_cvt_pk_bf16_f32 v76, v56, v57
	v_cvt_pk_bf16_f32 v77, v58, v59
	v_cvt_pk_bf16_f32 v78, v60, v61
	v_cvt_pk_bf16_f32 v79, v62, v63
	s_waitcnt lgkmcnt(2)
	v_mfma_f32_32x32x16_bf16 v[48:63], v[84:87], v[164:167], v[240:255]
	v_mad_u32_u24 v172, v175, 1, v174
	v_exp_f32 v32, v32
	v_exp_f32 v33, v33
	global_load_dwordx4 a[40:43], v3, s[72:73] offset:1024
	v_exp_f32 v34, v34
	v_exp_f32 v35, v35
	s_waitcnt lgkmcnt(1)
	v_mfma_f32_32x32x16_bf16 v[176:191], v[96:99], v[72:75], v[176:191]
	v_exp_f32 v36, v36
	v_exp_f32 v37, v37
	v_exp_f32 v38, v38
	v_exp_f32 v39, v39
	v_exp_f32 v40, v40
	global_load_dwordx4 a[44:47], v3, s[74:75] offset:1024
	v_exp_f32 v41, v41
	ds_read_b128 v[88:91], v172 offset:0
	ds_read_b128 v[92:95], v172 offset:1024
	s_waitcnt lgkmcnt(2)
	v_mfma_f32_32x32x16_bf16 v[176:191], v[100:103], v[76:79], v[176:191]
	v_exp_f32 v42, v42
	v_exp_f32 v43, v43
	v_exp_f32 v44, v44
	v_exp_f32 v45, v45
	v_exp_f32 v46, v46
	global_load_dwordx4 a[48:51], v3, s[72:73] offset:2048
	v_exp_f32 v47, v47
	v_cvt_pk_bf16_f32 v64, v32, v33
	v_cvt_pk_bf16_f32 v65, v34, v35
	v_cvt_pk_bf16_f32 v66, v36, v37
	v_cvt_pk_bf16_f32 v67, v38, v39
	v_cvt_pk_bf16_f32 v68, v40, v41
	v_cvt_pk_bf16_f32 v69, v42, v43
	v_cvt_pk_bf16_f32 v70, v44, v45
	v_cvt_pk_bf16_f32 v71, v46, v47
	v_mad_u32_u24 v173, v175, 0, v174
	v_exp_f32 v48, v48
	v_exp_f32 v49, v49
	global_load_dwordx4 a[52:55], v3, s[74:75] offset:2048
	v_exp_f32 v50, v50
	v_exp_f32 v51, v51
	s_waitcnt lgkmcnt(1)
	v_mfma_f32_32x32x16_bf16 v[176:191], v[88:91], v[64:67], v[176:191]
	v_exp_f32 v52, v52
	v_exp_f32 v53, v53
	v_exp_f32 v54, v54
	v_exp_f32 v55, v55
	v_exp_f32 v56, v56
	global_load_dwordx4 a[56:59], v3, s[72:73] offset:3072
	v_exp_f32 v57, v57
	ds_read_b128 v[96:99], v173 offset:0
	ds_read_b128 v[100:103], v173 offset:1024
	s_waitcnt lgkmcnt(2)
	v_mfma_f32_32x32x16_bf16 v[176:191], v[92:95], v[68:71], v[176:191]
	v_exp_f32 v58, v58
	v_exp_f32 v59, v59
	v_exp_f32 v60, v60
	v_exp_f32 v61, v61
	v_exp_f32 v62, v62
	global_load_dwordx4 a[60:63], v3, s[74:75] offset:3072
	v_exp_f32 v63, v63
	v_cvt_pk_bf16_f32 v72, v48, v49
	v_cvt_pk_bf16_f32 v73, v50, v51
	v_cvt_pk_bf16_f32 v74, v52, v53
	v_cvt_pk_bf16_f32 v75, v54, v55
	v_cvt_pk_bf16_f32 v76, v56, v57
	v_cvt_pk_bf16_f32 v77, v58, v59
	v_cvt_pk_bf16_f32 v78, v60, v61
	v_cvt_pk_bf16_f32 v79, v62, v63
	s_waitcnt lgkmcnt(1)
	v_mfma_f32_32x32x16_bf16 v[176:191], v[96:99], v[72:75], v[176:191]
	s_waitcnt lgkmcnt(0)
	v_mfma_f32_32x32x16_bf16 v[176:191], v[100:103], v[76:79], v[176:191]
	s_branch L_join_61
L_alt_60:
	ds_read_b128 v[80:83], v104 offset:40960
	ds_read_b128 v[84:87], v104 offset:36864
	s_waitcnt lgkmcnt(1)
	v_mfma_f32_32x32x16_bf16 v[32:47], v[80:83], v[168:171], v[208:223]
	s_waitcnt lgkmcnt(0)
	v_mfma_f32_32x32x16_bf16 v[48:63], v[84:87], v[164:167], v[208:223]
	v_mad_u32_u24 v172, v175, 10, v174
	s_nop 8
	v_exp_f32 v32, v32
	v_exp_f32 v33, v33
	v_exp_f32 v34, v34
	v_exp_f32 v35, v35
	ds_read_b128 v[80:83], v104 offset:36864
	v_exp_f32 v36, v36
	v_exp_f32 v37, v37
	v_exp_f32 v38, v38
	v_exp_f32 v39, v39
	v_exp_f32 v40, v40
	v_exp_f32 v41, v41
	ds_read_b128 v[88:91], v172 offset:0
	ds_read_b128 v[92:95], v172 offset:1024
	v_exp_f32 v42, v42
	v_exp_f32 v43, v43
	v_exp_f32 v44, v44
	v_exp_f32 v45, v45
	v_exp_f32 v46, v46
	v_exp_f32 v47, v47
	v_cvt_pk_bf16_f32 v64, v32, v33
	v_cvt_pk_bf16_f32 v65, v34, v35
	v_cvt_pk_bf16_f32 v66, v36, v37
	v_cvt_pk_bf16_f32 v67, v38, v39
	v_cvt_pk_bf16_f32 v68, v40, v41
	v_cvt_pk_bf16_f32 v69, v42, v43
	v_cvt_pk_bf16_f32 v70, v44, v45
	v_cvt_pk_bf16_f32 v71, v46, v47
	global_load_dword v110, v23, s[38:39] sc1
	s_nop 3
	s_cmp_eq_u32 s62, 1
	s_cbranch_scc1 L_hchk_69
	s_waitcnt vmcnt(2)
	v_cmp_ne_u32 vcc, s51, v108
	s_nop 4
	s_cbranch_vccnz L_hchk_69
	s_lshl_b32 s40, s24, 13
	s_add_u32 m0, s40, 98304
	s_nop 0
	global_load_lds_dwordx4 v2, s[34:35] offset:0
	global_load_lds_dwordx4 v2, s[34:35] offset:1024
	global_load_lds_dwordx4 v2, s[34:35] offset:2048
	global_load_lds_dwordx4 v2, s[34:35] offset:3072
	s_lshl_b32 s40, s24, 13
	s_add_u32 m0, s40, 102400
	s_nop 0
	global_load_lds_dwordx4 v2, s[36:37] offset:0
	global_load_lds_dwordx4 v2, s[36:37] offset:1024
	global_load_lds_dwordx4 v2, s[36:37] offset:2048
	global_load_lds_dwordx4 v2, s[36:37] offset:3072
	s_mov_b32 s62, 1
L_hchk_69:
	s_waitcnt lgkmcnt(2)
	v_mfma_f32_32x32x16_bf16 v[32:47], v[80:83], v[168:171], 0
	v_mad_u32_u24 v173, v175, 9, v174
	v_exp_f32 v48, v48
	v_exp_f32 v49, v49
	v_exp_f32 v50, v50
	v_exp_f32 v51, v51
	s_waitcnt lgkmcnt(1)
	v_mfma_f32_32x32x16_bf16 v[192:207], v[88:91], v[64:67], 0
	ds_read_b128 v[84:87], v104 offset:32768
	v_exp_f32 v52, v52
	v_exp_f32 v53, v53
	v_exp_f32 v54, v54
	v_exp_f32 v55, v55
	v_exp_f32 v56, v56
	v_exp_f32 v57, v57
	ds_read_b128 v[96:99], v173 offset:0
	ds_read_b128 v[100:103], v173 offset:1024
	s_waitcnt lgkmcnt(3)
	v_mfma_f32_32x32x16_bf16 v[192:207], v[92:95], v[68:71], v[192:207]
	v_exp_f32 v58, v58
	v_exp_f32 v59, v59
	v_exp_f32 v60, v60
	v_exp_f32 v61, v61
	v_exp_f32 v62, v62
	v_exp_f32 v63, v63
	v_cvt_pk_bf16_f32 v72, v48, v49
	v_cvt_pk_bf16_f32 v73, v50, v51
	v_cvt_pk_bf16_f32 v74, v52, v53
	v_cvt_pk_bf16_f32 v75, v54, v55
	v_cvt_pk_bf16_f32 v76, v56, v57
	v_cvt_pk_bf16_f32 v77, v58, v59
	v_cvt_pk_bf16_f32 v78, v60, v61
	v_cvt_pk_bf16_f32 v79, v62, v63
	global_load_dword v111, v23, s[38:39] sc1
	s_nop 3
	s_cmp_eq_u32 s62, 1
	s_cbranch_scc1 L_hchk_70
	s_waitcnt vmcnt(2)
	v_cmp_ne_u32 vcc, s51, v109
	s_nop 4
	s_cbranch_vccnz L_hchk_70
	s_lshl_b32 s40, s24, 13
	s_add_u32 m0, s40, 98304
	s_nop 0
	global_load_lds_dwordx4 v2, s[34:35] offset:0
	global_load_lds_dwordx4 v2, s[34:35] offset:1024
	global_load_lds_dwordx4 v2, s[34:35] offset:2048
	global_load_lds_dwordx4 v2, s[34:35] offset:3072
	s_lshl_b32 s40, s24, 13
	s_add_u32 m0, s40, 102400
	s_nop 0
	global_load_lds_dwordx4 v2, s[36:37] offset:0
	global_load_lds_dwordx4 v2, s[36:37] offset:1024
	global_load_lds_dwordx4 v2, s[36:37] offset:2048
	global_load_lds_dwordx4 v2, s[36:37] offset:3072
	s_mov_b32 s62, 1
L_hchk_70:
	s_waitcnt lgkmcnt(2)
	v_mfma_f32_32x32x16_bf16 v[48:63], v[84:87], v[164:167], 0
	v_mad_u32_u24 v172, v175, 9, v174
	v_exp_f32 v32, v32
	v_exp_f32 v33, v33
	v_exp_f32 v34, v34
	v_exp_f32 v35, v35
	s_waitcnt lgkmcnt(1)
	v_mfma_f32_32x32x16_bf16 v[176:191], v[96:99], v[72:75], 0
	ds_read_b128 v[80:83], v104 offset:32768
	v_exp_f32 v36, v36
	v_exp_f32 v37, v37
	v_exp_f32 v38, v38
	v_exp_f32 v39, v39
	v_exp_f32 v40, v40
	v_exp_f32 v41, v41
	ds_read_b128 v[88:91], v172 offset:0
	ds_read_b128 v[92:95], v172 offset:1024
	s_waitcnt lgkmcnt(3)
	v_mfma_f32_32x32x16_bf16 v[176:191], v[100:103], v[76:79], v[176:191]
	v_exp_f32 v42, v42
	v_exp_f32 v43, v43
	v_exp_f32 v44, v44
	v_exp_f32 v45, v45
	v_exp_f32 v46, v46
	v_exp_f32 v47, v47
	v_cvt_pk_bf16_f32 v64, v32, v33
	v_cvt_pk_bf16_f32 v65, v34, v35
	v_cvt_pk_bf16_f32 v66, v36, v37
	v_cvt_pk_bf16_f32 v67, v38, v39
	v_cvt_pk_bf16_f32 v68, v40, v41
	v_cvt_pk_bf16_f32 v69, v42, v43
	v_cvt_pk_bf16_f32 v70, v44, v45
	v_cvt_pk_bf16_f32 v71, v46, v47
	s_nop 4
	s_cmp_eq_u32 s62, 1
	s_cbranch_scc1 L_hchk_71
	s_waitcnt vmcnt(1)
	v_cmp_ne_u32 vcc, s51, v110
	s_nop 4
	s_cbranch_vccnz L_hchk_71
	s_lshl_b32 s40, s24, 13
	s_add_u32 m0, s40, 98304
	s_nop 0
	global_load_lds_dwordx4 v2, s[34:35] offset:0
	global_load_lds_dwordx4 v2, s[34:35] offset:1024
	global_load_lds_dwordx4 v2, s[34:35] offset:2048
	global_load_lds_dwordx4 v2, s[34:35] offset:3072
	s_lshl_b32 s40, s24, 13
	s_add_u32 m0, s40, 102400
	s_nop 0
	global_load_lds_dwordx4 v2, s[36:37] offset:0
	global_load_lds_dwordx4 v2, s[36:37] offset:1024
	global_load_lds_dwordx4 v2, s[36:37] offset:2048
	global_load_lds_dwordx4 v2, s[36:37] offset:3072
	s_mov_b32 s62, 1
L_hchk_71:
	s_waitcnt lgkmcnt(2)
	v_mfma_f32_32x32x16_bf16 v[32:47], v[80:83], v[168:171], 0
	v_mad_u32_u24 v173, v175, 8, v174
	v_exp_f32 v48, v48
	v_exp_f32 v49, v49
	v_exp_f32 v50, v50
	v_exp_f32 v51, v51
	s_waitcnt lgkmcnt(1)
	v_mfma_f32_32x32x16_bf16 v[192:207], v[88:91], v[64:67], v[192:207]
	v_exp_f32 v52, v52
	v_exp_f32 v53, v53
	v_exp_f32 v54, v54
	v_exp_f32 v55, v55
	v_exp_f32 v56, v56
	v_exp_f32 v57, v57
	ds_read_b128 v[96:99], v173 offset:0
	ds_read_b128 v[100:103], v173 offset:1024
	s_waitcnt lgkmcnt(2)
	v_mfma_f32_32x32x16_bf16 v[192:207], v[92:95], v[68:71], v[192:207]
	v_exp_f32 v58, v58
	v_exp_f32 v59, v59
	v_exp_f32 v60, v60
	v_exp_f32 v61, v61
	v_exp_f32 v62, v62
	v_exp_f32 v63, v63
	v_cvt_pk_bf16_f32 v72, v48, v49
	v_cvt_pk_bf16_f32 v73, v50, v51
	v_cvt_pk_bf16_f32 v74, v52, v53
	v_cvt_pk_bf16_f32 v75, v54, v55
	v_cvt_pk_bf16_f32 v76, v56, v57
	v_cvt_pk_bf16_f32 v77, v58, v59
	v_cvt_pk_bf16_f32 v78, v60, v61
	v_cvt_pk_bf16_f32 v79, v62, v63
	s_nop 4
	s_cmp_eq_u32 s62, 1
	s_cbranch_scc1 L_hchk_72
	s_waitcnt vmcnt(0)
	v_cmp_ne_u32 vcc, s51, v111
	s_nop 4
	s_cbranch_vccnz L_hchk_72
	s_lshl_b32 s40, s24, 13
	s_add_u32 m0, s40, 98304
	s_nop 0
	global_load_lds_dwordx4 v2, s[34:35] offset:0
	global_load_lds_dwordx4 v2, s[34:35] offset:1024
	global_load_lds_dwordx4 v2, s[34:35] offset:2048
	global_load_lds_dwordx4 v2, s[34:35] offset:3072
	s_lshl_b32 s40, s24, 13
	s_add_u32 m0, s40, 102400
	s_nop 0
	global_load_lds_dwordx4 v2, s[36:37] offset:0
	global_load_lds_dwordx4 v2, s[36:37] offset:1024
	global_load_lds_dwordx4 v2, s[36:37] offset:2048
	global_load_lds_dwordx4 v2, s[36:37] offset:3072
	s_mov_b32 s62, 1
L_hchk_72:
	v_mad_u32_u24 v172, v175, 8, v174
	v_exp_f32 v32, v32
	v_exp_f32 v33, v33
	v_exp_f32 v34, v34
	v_exp_f32 v35, v35
	s_waitcnt lgkmcnt(1)
	v_mfma_f32_32x32x16_bf16 v[176:191], v[96:99], v[72:75], v[176:191]
	v_exp_f32 v36, v36
	v_exp_f32 v37, v37
	v_exp_f32 v38, v38
	v_exp_f32 v39, v39
	v_exp_f32 v40, v40
	v_exp_f32 v41, v41
	ds_read_b128 v[88:91], v172 offset:0
	ds_read_b128 v[92:95], v172 offset:1024
	s_waitcnt lgkmcnt(2)
	v_mfma_f32_32x32x16_bf16 v[176:191], v[100:103], v[76:79], v[176:191]
	v_exp_f32 v42, v42
	v_exp_f32 v43, v43
	v_exp_f32 v44, v44
	v_exp_f32 v45, v45
	v_exp_f32 v46, v46
	v_exp_f32 v47, v47
	v_cvt_pk_bf16_f32 v64, v32, v33
	v_cvt_pk_bf16_f32 v65, v34, v35
	v_cvt_pk_bf16_f32 v66, v36, v37
	v_cvt_pk_bf16_f32 v67, v38, v39
	v_cvt_pk_bf16_f32 v68, v40, v41
	v_cvt_pk_bf16_f32 v69, v42, v43
	v_cvt_pk_bf16_f32 v70, v44, v45
	v_cvt_pk_bf16_f32 v71, v46, v47
	s_nop 4
	s_cmp_eq_u32 s62, 1
	s_cbranch_scc1 L_hfin_73
	s_mov_b32 s49, 0
	s_nop 1
L_poll_74:
	global_load_dword v28, v23, s[38:39] sc1
	s_waitcnt vmcnt(0)
	v_cmp_ne_u32 vcc, s51, v28
	s_nop 4
	s_cbranch_vccz L_pollout_75
	s_add_u32 s49, s49, 1
	s_cmp_ge_u32 s49, s26
	s_cbranch_scc0 L_poll_74
	s_mov_b32 s26, 1
L_pollout_75:
	s_lshl_b32 s40, s24, 13
	s_add_u32 m0, s40, 98304
	s_nop 0
	global_load_lds_dwordx4 v2, s[34:35] offset:0
	global_load_lds_dwordx4 v2, s[34:35] offset:1024
	global_load_lds_dwordx4 v2, s[34:35] offset:2048
	global_load_lds_dwordx4 v2, s[34:35] offset:3072
	s_lshl_b32 s40, s24, 13
	s_add_u32 m0, s40, 102400
	s_nop 0
	global_load_lds_dwordx4 v2, s[36:37] offset:0
	global_load_lds_dwordx4 v2, s[36:37] offset:1024
	global_load_lds_dwordx4 v2, s[36:37] offset:2048
	global_load_lds_dwordx4 v2, s[36:37] offset:3072
	s_mov_b32 s62, 1
L_hfin_73:
	s_waitcnt vmcnt(0)
	s_barrier
	ds_read_b128 v[84:87], v104 offset:28672
	ds_read_b128 v[80:83], v104 offset:28672
	s_waitcnt lgkmcnt(1)
	v_mfma_f32_32x32x16_bf16 v[48:63], v[84:87], v[164:167], v[224:239]
	v_mfma_f32_32x32x16_bf16 v[192:207], v[88:91], v[64:67], v[192:207]
	v_mfma_f32_32x32x16_bf16 v[192:207], v[92:95], v[68:71], v[192:207]
	s_waitcnt lgkmcnt(0)
	v_mfma_f32_32x32x16_bf16 v[32:47], v[80:83], v[168:171], v[224:239]
	v_mad_u32_u24 v173, v175, 7, v174
	s_nop 6
	v_exp_f32 v48, v48
	v_exp_f32 v49, v49
	global_load_dwordx4 a[156:159], v3, s[76:77] offset:3072
	v_exp_f32 v50, v50
	v_exp_f32 v51, v51
	ds_read_b128 v[84:87], v104 offset:24576
	v_exp_f32 v52, v52
	v_exp_f32 v53, v53
	v_exp_f32 v54, v54
	v_exp_f32 v55, v55
	v_exp_f32 v56, v56
	global_load_dwordx4 a[188:191], v3, s[78:79] offset:3072
	v_exp_f32 v57, v57
	ds_read_b128 v[96:99], v173 offset:0
	ds_read_b128 v[100:103], v173 offset:1024
	v_exp_f32 v58, v58
	v_exp_f32 v59, v59
	v_exp_f32 v60, v60
	v_exp_f32 v61, v61
	v_exp_f32 v62, v62
	s_add_u32 m0, s66, 0
	s_nop 0
	global_load_lds_dwordx4 v2, s[64:65] offset:0
	v_exp_f32 v63, v63
	v_cvt_pk_bf16_f32 v72, v48, v49
	v_cvt_pk_bf16_f32 v73, v50, v51
	v_cvt_pk_bf16_f32 v74, v52, v53
	v_cvt_pk_bf16_f32 v75, v54, v55
	v_cvt_pk_bf16_f32 v76, v56, v57
	v_cvt_pk_bf16_f32 v77, v58, v59
	v_cvt_pk_bf16_f32 v78, v60, v61
	v_cvt_pk_bf16_f32 v79, v62, v63
	s_waitcnt lgkmcnt(2)
	v_mfma_f32_32x32x16_bf16 v[48:63], v[84:87], v[164:167], v[224:239]
	v_mad_u32_u24 v172, v175, 7, v174
	v_exp_f32 v32, v32
	v_exp_f32 v33, v33
	global_load_lds_dwordx4 v2, s[64:65] offset:1024
	v_exp_f32 v34, v34
	v_exp_f32 v35, v35
	s_waitcnt lgkmcnt(1)
	v_mfma_f32_32x32x16_bf16 v[176:191], v[96:99], v[72:75], v[176:191]
	ds_read_b128 v[80:83], v104 offset:24576
	v_exp_f32 v36, v36
	v_exp_f32 v37, v37
	v_exp_f32 v38, v38
	v_exp_f32 v39, v39
	v_exp_f32 v40, v40
	global_load_lds_dwordx4 v2, s[64:65] offset:2048
	v_exp_f32 v41, v41
	ds_read_b128 v[88:91], v172 offset:0
	ds_read_b128 v[92:95], v172 offset:1024
	s_waitcnt lgkmcnt(3)
	v_mfma_f32_32x32x16_bf16 v[176:191], v[100:103], v[76:79], v[176:191]
	v_exp_f32 v42, v42
	v_exp_f32 v43, v43
	v_exp_f32 v44, v44
	v_exp_f32 v45, v45
	v_exp_f32 v46, v46
	global_load_lds_dwordx4 v2, s[64:65] offset:3072
	v_exp_f32 v47, v47
	v_cvt_pk_bf16_f32 v64, v32, v33
	v_cvt_pk_bf16_f32 v65, v34, v35
	v_cvt_pk_bf16_f32 v66, v36, v37
	v_cvt_pk_bf16_f32 v67, v38, v39
	v_cvt_pk_bf16_f32 v68, v40, v41
	v_cvt_pk_bf16_f32 v69, v42, v43
	v_cvt_pk_bf16_f32 v70, v44, v45
	v_cvt_pk_bf16_f32 v71, v46, v47
	s_waitcnt lgkmcnt(2)
	v_mfma_f32_32x32x16_bf16 v[32:47], v[80:83], v[168:171], v[224:239]
	v_mad_u32_u24 v173, v175, 6, v174
	v_exp_f32 v48, v48
	v_exp_f32 v49, v49
	s_add_u32 m0, s66, 4096
	s_nop 0
	global_load_lds_dwordx4 v3, s[64:65] offset:0
	v_exp_f32 v50, v50
	v_exp_f32 v51, v51
	s_waitcnt lgkmcnt(1)
	v_mfma_f32_32x32x16_bf16 v[192:207], v[88:91], v[64:67], v[192:207]
	ds_read_b128 v[84:87], v104 offset:20480
	v_exp_f32 v52, v52
	v_exp_f32 v53, v53
	v_exp_f32 v54, v54
	v_exp_f32 v55, v55
	v_exp_f32 v56, v56
	global_load_lds_dwordx4 v3, s[64:65] offset:1024
	v_exp_f32 v57, v57
	ds_read_b128 v[96:99], v173 offset:0
	ds_read_b128 v[100:103], v173 offset:1024
	s_waitcnt lgkmcnt(3)
	v_mfma_f32_32x32x16_bf16 v[192:207], v[92:95], v[68:71], v[192:207]
	v_exp_f32 v58, v58
	v_exp_f32 v59, v59
	v_exp_f32 v60, v60
	v_exp_f32 v61, v61
	v_exp_f32 v62, v62
	global_load_lds_dwordx4 v3, s[64:65] offset:2048
	s_add_u32 s64, s64, 28672
	s_addc_u32 s65, s65, 0
	v_exp_f32 v63, v63
	v_cvt_pk_bf16_f32 v72, v48, v49
	v_cvt_pk_bf16_f32 v73, v50, v51
	v_cvt_pk_bf16_f32 v74, v52, v53
	v_cvt_pk_bf16_f32 v75, v54, v55
	v_cvt_pk_bf16_f32 v76, v56, v57
	v_cvt_pk_bf16_f32 v77, v58, v59
	v_cvt_pk_bf16_f32 v78, v60, v61
	v_cvt_pk_bf16_f32 v79, v62, v63
	s_waitcnt lgkmcnt(2)
	v_mfma_f32_32x32x16_bf16 v[48:63], v[84:87], v[164:167], v[224:239]
	v_mad_u32_u24 v172, v175, 6, v174
	v_exp_f32 v32, v32
	v_exp_f32 v33, v33
	s_add_u32 m0, s66, 28672
	s_nop 0
	global_load_lds_dwordx4 v2, s[64:65] offset:0
	v_exp_f32 v34, v34
	v_exp_f32 v35, v35
	s_waitcnt lgkmcnt(1)
	v_mfma_f32_32x32x16_bf16 v[176:191], v[96:99], v[72:75], v[176:191]
	ds_read_b128 v[80:83], v104 offset:20480
	v_exp_f32 v36, v36
	v_exp_f32 v37, v37
	v_exp_f32 v38, v38
	v_exp_f32 v39, v39
	v_exp_f32 v40, v40
	global_load_lds_dwordx4 v2, s[64:65] offset:1024
	v_exp_f32 v41, v41
	ds_read_b128 v[88:91], v172 offset:0
	ds_read_b128 v[92:95], v172 offset:1024
	s_waitcnt lgkmcnt(3)
	v_mfma_f32_32x32x16_bf16 v[176:191], v[100:103], v[76:79], v[176:191]
	v_exp_f32 v42, v42
	v_exp_f32 v43, v43
	v_exp_f32 v44, v44
	v_exp_f32 v45, v45
	v_exp_f32 v46, v46
	global_load_lds_dwordx4 v2, s[64:65] offset:2048
	v_exp_f32 v47, v47
	v_cvt_pk_bf16_f32 v64, v32, v33
	v_cvt_pk_bf16_f32 v65, v34, v35
	v_cvt_pk_bf16_f32 v66, v36, v37
	v_cvt_pk_bf16_f32 v67, v38, v39
	v_cvt_pk_bf16_f32 v68, v40, v41
	v_cvt_pk_bf16_f32 v69, v42, v43
	v_cvt_pk_bf16_f32 v70, v44, v45
	v_cvt_pk_bf16_f32 v71, v46, v47
	s_waitcnt lgkmcnt(2)
	v_mfma_f32_32x32x16_bf16 v[32:47], v[80:83], v[168:171], v[224:239]
	v_mad_u32_u24 v173, v175, 5, v174
	v_exp_f32 v48, v48
	v_exp_f32 v49, v49
	global_load_lds_dwordx4 v2, s[64:65] offset:3072
	v_exp_f32 v50, v50
	v_exp_f32 v51, v51
	s_waitcnt lgkmcnt(1)
	v_mfma_f32_32x32x16_bf16 v[192:207], v[88:91], v[64:67], v[192:207]
	ds_read_b128 v[84:87], v104 offset:16384
	v_exp_f32 v52, v52
	v_exp_f32 v53, v53
	v_exp_f32 v54, v54
	v_exp_f32 v55, v55
	v_exp_f32 v56, v56
	s_add_u32 m0, s66, 32768
	s_nop 0
	global_load_lds_dwordx4 v3, s[64:65] offset:0
	v_exp_f32 v57, v57
	ds_read_b128 v[96:99], v173 offset:0
	ds_read_b128 v[100:103], v173 offset:1024
	s_waitcnt lgkmcnt(3)
	v_mfma_f32_32x32x16_bf16 v[192:207], v[92:95], v[68:71], v[192:207]
	v_exp_f32 v58, v58
	v_exp_f32 v59, v59
	v_exp_f32 v60, v60
	v_exp_f32 v61, v61
	v_exp_f32 v62, v62
	global_load_lds_dwordx4 v3, s[64:65] offset:1024
	v_exp_f32 v63, v63
	v_cvt_pk_bf16_f32 v72, v48, v49
	v_cvt_pk_bf16_f32 v73, v50, v51
	v_cvt_pk_bf16_f32 v74, v52, v53
	v_cvt_pk_bf16_f32 v75, v54, v55
	v_cvt_pk_bf16_f32 v76, v56, v57
	v_cvt_pk_bf16_f32 v77, v58, v59
	v_cvt_pk_bf16_f32 v78, v60, v61
	v_cvt_pk_bf16_f32 v79, v62, v63
	s_waitcnt lgkmcnt(2)
	v_mfma_f32_32x32x16_bf16 v[48:63], v[84:87], v[164:167], v[224:239]
	v_mad_u32_u24 v172, v175, 5, v174
	v_exp_f32 v32, v32
	v_exp_f32 v33, v33
	global_load_lds_dwordx4 v3, s[64:65] offset:2048
	s_add_u32 s64, s64, 28672
	s_addc_u32 s65, s65, 0
	v_exp_f32 v34, v34
	v_exp_f32 v35, v35
	s_waitcnt lgkmcnt(1)
	v_mfma_f32_32x32x16_bf16 v[176:191], v[96:99], v[72:75], v[176:191]
	ds_read_b128 v[80:83], v104 offset:16384
	v_exp_f32 v36, v36
	v_exp_f32 v37, v37
	v_exp_f32 v38, v38
	v_exp_f32 v39, v39
	v_exp_f32 v40, v40
	s_add_u32 m0, s66, 57344
	s_nop 0
	global_load_lds_dwordx4 v2, s[64:65] offset:0
	v_exp_f32 v41, v41
	ds_read_b128 v[88:91], v172 offset:0
	ds_read_b128 v[92:95], v172 offset:1024
	s_waitcnt lgkmcnt(3)
	v_mfma_f32_32x32x16_bf16 v[176:191], v[100:103], v[76:79], v[176:191]
	v_exp_f32 v42, v42
	v_exp_f32 v43, v43
	v_exp_f32 v44, v44
	v_exp_f32 v45, v45
	v_exp_f32 v46, v46
	global_load_lds_dwordx4 v2, s[64:65] offset:1024
	v_exp_f32 v47, v47
	v_cvt_pk_bf16_f32 v64, v32, v33
	v_cvt_pk_bf16_f32 v65, v34, v35
	v_cvt_pk_bf16_f32 v66, v36, v37
	v_cvt_pk_bf16_f32 v67, v38, v39
	v_cvt_pk_bf16_f32 v68, v40, v41
	v_cvt_pk_bf16_f32 v69, v42, v43
	v_cvt_pk_bf16_f32 v70, v44, v45
	v_cvt_pk_bf16_f32 v71, v46, v47
	s_waitcnt lgkmcnt(2)
	v_mfma_f32_32x32x16_bf16 v[32:47], v[80:83], v[168:171], v[224:239]
	v_mad_u32_u24 v173, v175, 4, v174
	v_exp_f32 v48, v48
	v_exp_f32 v49, v49
	global_load_lds_dwordx4 v2, s[64:65] offset:2048
	v_exp_f32 v50, v50
	v_exp_f32 v51, v51
	s_waitcnt lgkmcnt(1)
	v_mfma_f32_32x32x16_bf16 v[192:207], v[88:91], v[64:67], v[192:207]
	ds_read_b128 v[84:87], v104 offset:12288
	v_exp_f32 v52, v52
	v_exp_f32 v53, v53
	v_exp_f32 v54, v54
	v_exp_f32 v55, v55
	v_exp_f32 v56, v56
	global_load_lds_dwordx4 v2, s[64:65] offset:3072
	v_exp_f32 v57, v57
	ds_read_b128 v[96:99], v173 offset:0
	ds_read_b128 v[100:103], v173 offset:1024
	s_waitcnt lgkmcnt(3)
	v_mfma_f32_32x32x16_bf16 v[192:207], v[92:95], v[68:71], v[192:207]
	v_exp_f32 v58, v58
	v_exp_f32 v59, v59
	v_exp_f32 v60, v60
	v_exp_f32 v61, v61
	v_exp_f32 v62, v62
	s_add_u32 m0, s66, 61440
	s_nop 0
	global_load_lds_dwordx4 v3, s[64:65] offset:0
	v_exp_f32 v63, v63
	v_cvt_pk_bf16_f32 v72, v48, v49
	v_cvt_pk_bf16_f32 v73, v50, v51
	v_cvt_pk_bf16_f32 v74, v52, v53
	v_cvt_pk_bf16_f32 v75, v54, v55
	v_cvt_pk_bf16_f32 v76, v56, v57
	v_cvt_pk_bf16_f32 v77, v58, v59
	v_cvt_pk_bf16_f32 v78, v60, v61
	v_cvt_pk_bf16_f32 v79, v62, v63
	s_waitcnt lgkmcnt(2)
	v_mfma_f32_32x32x16_bf16 v[48:63], v[84:87], v[164:167], v[112:127]
	v_mad_u32_u24 v172, v175, 4, v174
	v_exp_f32 v32, v32
	v_exp_f32 v33, v33
	global_load_lds_dwordx4 v3, s[64:65] offset:1024
	v_exp_f32 v34, v34
	v_exp_f32 v35, v35
	s_waitcnt lgkmcnt(1)
	v_mfma_f32_32x32x16_bf16 v[176:191], v[96:99], v[72:75], v[176:191]
	ds_read_b128 v[80:83], v104 offset:12288
	v_exp_f32 v36, v36
	v_exp_f32 v37, v37
	v_exp_f32 v38, v38
	v_exp_f32 v39, v39
	v_exp_f32 v40, v40
	global_load_lds_dwordx4 v3, s[64:65] offset:2048
	s_add_u32 s64, s64, 28672
	s_addc_u32 s65, s65, 0
	v_exp_f32 v41, v41
	ds_read_b128 v[88:91], v172 offset:0
	ds_read_b128 v[92:95], v172 offset:1024
	s_waitcnt lgkmcnt(3)
	v_mfma_f32_32x32x16_bf16 v[176:191], v[100:103], v[76:79], v[176:191]
	v_exp_f32 v42, v42
	v_exp_f32 v43, v43
	v_exp_f32 v44, v44
	v_exp_f32 v45, v45
	v_exp_f32 v46, v46
	global_load_dwordx4 a[0:3], v2, s[72:73] offset:0
	v_exp_f32 v47, v47
	v_cvt_pk_bf16_f32 v64, v32, v33
	v_cvt_pk_bf16_f32 v65, v34, v35
	v_cvt_pk_bf16_f32 v66, v36, v37
	v_cvt_pk_bf16_f32 v67, v38, v39
	v_cvt_pk_bf16_f32 v68, v40, v41
	v_cvt_pk_bf16_f32 v69, v42, v43
	v_cvt_pk_bf16_f32 v70, v44, v45
	v_cvt_pk_bf16_f32 v71, v46, v47
	s_waitcnt lgkmcnt(2)
	v_mfma_f32_32x32x16_bf16 v[32:47], v[80:83], v[168:171], v[112:127]
	v_mad_u32_u24 v173, v175, 3, v174
	v_exp_f32 v48, v48
	v_exp_f32 v49, v49
	global_load_dwordx4 a[4:7], v2, s[74:75] offset:0
	v_exp_f32 v50, v50
	v_exp_f32 v51, v51
	s_waitcnt lgkmcnt(1)
	v_mfma_f32_32x32x16_bf16 v[192:207], v[88:91], v[64:67], v[192:207]
	ds_read_b128 v[84:87], v104 offset:8192
	v_exp_f32 v52, v52
	v_exp_f32 v53, v53
	v_exp_f32 v54, v54
	v_exp_f32 v55, v55
	v_exp_f32 v56, v56
	global_load_dwordx4 a[8:11], v2, s[72:73] offset:1024
	v_exp_f32 v57, v57
	ds_read_b128 v[96:99], v173 offset:0
	ds_read_b128 v[100:103], v173 offset:1024
	s_waitcnt lgkmcnt(3)
	v_mfma_f32_32x32x16_bf16 v[192:207], v[92:95], v[68:71], v[192:207]
	v_exp_f32 v58, v58
	v_exp_f32 v59, v59
	v_exp_f32 v60, v60
	v_exp_f32 v61, v61
	v_exp_f32 v62, v62
	global_load_dwordx4 a[12:15], v2, s[74:75] offset:1024
	v_exp_f32 v63, v63
	v_cvt_pk_bf16_f32 v72, v48, v49
	v_cvt_pk_bf16_f32 v73, v50, v51
	v_cvt_pk_bf16_f32 v74, v52, v53
	v_cvt_pk_bf16_f32 v75, v54, v55
	v_cvt_pk_bf16_f32 v76, v56, v57
	v_cvt_pk_bf16_f32 v77, v58, v59
	v_cvt_pk_bf16_f32 v78, v60, v61
	v_cvt_pk_bf16_f32 v79, v62, v63
	s_waitcnt lgkmcnt(2)
	v_mfma_f32_32x32x16_bf16 v[48:63], v[84:87], v[164:167], v[112:127]
	v_mad_u32_u24 v172, v175, 3, v174
	v_exp_f32 v32, v32
	v_exp_f32 v33, v33
	global_load_dwordx4 a[16:19], v2, s[72:73] offset:2048
	v_exp_f32 v34, v34
	v_exp_f32 v35, v35
	s_waitcnt lgkmcnt(1)
	v_mfma_f32_32x32x16_bf16 v[176:191], v[96:99], v[72:75], v[176:191]
	ds_read_b128 v[80:83], v104 offset:8192
	v_exp_f32 v36, v36
	v_exp_f32 v37, v37
	v_exp_f32 v38, v38
	v_exp_f32 v39, v39
	v_exp_f32 v40, v40
	global_load_dwordx4 a[20:23], v2, s[74:75] offset:2048
	v_exp_f32 v41, v41
	ds_read_b128 v[88:91], v172 offset:0
	ds_read_b128 v[92:95], v172 offset:1024
	s_waitcnt lgkmcnt(3)
	v_mfma_f32_32x32x16_bf16 v[176:191], v[100:103], v[76:79], v[176:191]
	v_exp_f32 v42, v42
	v_exp_f32 v43, v43
	v_exp_f32 v44, v44
	v_exp_f32 v45, v45
	v_exp_f32 v46, v46
	global_load_dwordx4 a[24:27], v2, s[72:73] offset:3072
	v_exp_f32 v47, v47
	v_cvt_pk_bf16_f32 v64, v32, v33
	v_cvt_pk_bf16_f32 v65, v34, v35
	v_cvt_pk_bf16_f32 v66, v36, v37
	v_cvt_pk_bf16_f32 v67, v38, v39
	v_cvt_pk_bf16_f32 v68, v40, v41
	v_cvt_pk_bf16_f32 v69, v42, v43
	v_cvt_pk_bf16_f32 v70, v44, v45
	v_cvt_pk_bf16_f32 v71, v46, v47
	s_waitcnt lgkmcnt(2)
	v_mfma_f32_32x32x16_bf16 v[32:47], v[80:83], v[168:171], v[240:255]
	v_mad_u32_u24 v173, v175, 2, v174
	v_exp_f32 v48, v48
	v_exp_f32 v49, v49
	global_load_dwordx4 a[28:31], v2, s[74:75] offset:3072
	v_exp_f32 v50, v50
	v_exp_f32 v51, v51
	s_waitcnt lgkmcnt(1)
	v_mfma_f32_32x32x16_bf16 v[192:207], v[88:91], v[64:67], v[192:207]
	ds_read_b128 v[84:87], v104 offset:4096
	v_exp_f32 v52, v52
	v_exp_f32 v53, v53
	v_exp_f32 v54, v54
	v_exp_f32 v55, v55
	v_exp_f32 v56, v56
	global_load_dwordx4 a[32:35], v3, s[72:73] offset:0
	v_exp_f32 v57, v57
	ds_read_b128 v[96:99], v173 offset:0
	ds_read_b128 v[100:103], v173 offset:1024
	s_waitcnt lgkmcnt(3)
	v_mfma_f32_32x32x16_bf16 v[192:207], v[92:95], v[68:71], v[192:207]
	v_exp_f32 v58, v58
	v_exp_f32 v59, v59
	v_exp_f32 v60, v60
	v_exp_f32 v61, v61
	v_exp_f32 v62, v62
	global_load_dwordx4 a[36:39], v3, s[74:75] offset:0
	v_exp_f32 v63, v63
	v_cvt_pk_bf16_f32 v72, v48, v49
	v_cvt_pk_bf16_f32 v73, v50, v51
	v_cvt_pk_bf16_f32 v74, v52, v53
	v_cvt_pk_bf16_f32 v75, v54, v55
	v_cvt_pk_bf16_f32 v76, v56, v57
	v_cvt_pk_bf16_f32 v77, v58, v59
	v_cvt_pk_bf16_f32 v78, v60, v61
	v_cvt_pk_bf16_f32 v79, v62, v63
	s_waitcnt lgkmcnt(2)
	v_mfma_f32_32x32x16_bf16 v[48:63], v[84:87], v[164:167], v[240:255]
	v_mad_u32_u24 v172, v175, 2, v174
	v_exp_f32 v32, v32
	v_exp_f32 v33, v33
	global_load_dwordx4 a[40:43], v3, s[72:73] offset:1024
	v_exp_f32 v34, v34
	v_exp_f32 v35, v35
	s_waitcnt lgkmcnt(1)
	v_mfma_f32_32x32x16_bf16 v[176:191], v[96:99], v[72:75], v[176:191]
	v_exp_f32 v36, v36
	v_exp_f32 v37, v37
	v_exp_f32 v38, v38
	v_exp_f32 v39, v39
	v_exp_f32 v40, v40
	global_load_dwordx4 a[44:47], v3, s[74:75] offset:1024
	v_exp_f32 v41, v41
	ds_read_b128 v[88:91], v172 offset:0
	ds_read_b128 v[92:95], v172 offset:1024
	s_waitcnt lgkmcnt(2)
	v_mfma_f32_32x32x16_bf16 v[176:191], v[100:103], v[76:79], v[176:191]
	v_exp_f32 v42, v42
	v_exp_f32 v43, v43
	v_exp_f32 v44, v44
	v_exp_f32 v45, v45
	v_exp_f32 v46, v46
	global_load_dwordx4 a[48:51], v3, s[72:73] offset:2048
	v_exp_f32 v47, v47
	v_cvt_pk_bf16_f32 v64, v32, v33
	v_cvt_pk_bf16_f32 v65, v34, v35
	v_cvt_pk_bf16_f32 v66, v36, v37
	v_cvt_pk_bf16_f32 v67, v38, v39
	v_cvt_pk_bf16_f32 v68, v40, v41
	v_cvt_pk_bf16_f32 v69, v42, v43
	v_cvt_pk_bf16_f32 v70, v44, v45
	v_cvt_pk_bf16_f32 v71, v46, v47
	v_mad_u32_u24 v173, v175, 1, v174
	v_exp_f32 v48, v48
	v_exp_f32 v49, v49
	global_load_dwordx4 a[52:55], v3, s[74:75] offset:2048
	v_exp_f32 v50, v50
	v_exp_f32 v51, v51
	s_waitcnt lgkmcnt(1)
	v_mfma_f32_32x32x16_bf16 v[192:207], v[88:91], v[64:67], v[192:207]
	v_exp_f32 v52, v52
	v_exp_f32 v53, v53
	v_exp_f32 v54, v54
	v_exp_f32 v55, v55
	v_exp_f32 v56, v56
	global_load_dwordx4 a[56:59], v3, s[72:73] offset:3072
	v_exp_f32 v57, v57
	ds_read_b128 v[96:99], v173 offset:0
	ds_read_b128 v[100:103], v173 offset:1024
	s_waitcnt lgkmcnt(2)
	v_mfma_f32_32x32x16_bf16 v[192:207], v[92:95], v[68:71], v[192:207]
	v_exp_f32 v58, v58
	v_exp_f32 v59, v59
	v_exp_f32 v60, v60
	v_exp_f32 v61, v61
	v_exp_f32 v62, v62
	global_load_dwordx4 a[60:63], v3, s[74:75] offset:3072
	v_exp_f32 v63, v63
	v_cvt_pk_bf16_f32 v72, v48, v49
	v_cvt_pk_bf16_f32 v73, v50, v51
	v_cvt_pk_bf16_f32 v74, v52, v53
	v_cvt_pk_bf16_f32 v75, v54, v55
	v_cvt_pk_bf16_f32 v76, v56, v57
	v_cvt_pk_bf16_f32 v77, v58, v59
	v_cvt_pk_bf16_f32 v78, v60, v61
	v_cvt_pk_bf16_f32 v79, v62, v63
	s_waitcnt lgkmcnt(1)
	v_mfma_f32_32x32x16_bf16 v[176:191], v[96:99], v[72:75], v[176:191]
	s_waitcnt lgkmcnt(0)
	v_mfma_f32_32x32x16_bf16 v[176:191], v[100:103], v[76:79], v[176:191]
L_join_61:
	s_nop 11
	v_min_f32 v23, v184, v200
	v_max_f32 v24, v184, v200
	v_cmp_o_f32 vcc, v184, v200
	s_mov_b64 s[52:53], vcc
	v_cmp_le_f32 vcc, 0x21800000, v23
	s_and_b64 s[52:53], s[52:53], vcc
	v_cmp_ge_f32 vcc, 0x5d800000, v24
	s_and_b64 s[52:53], s[52:53], vcc
	s_cmp_eq_u64 s[52:53], exec
	s_cbranch_scc0 L_fallback_1
	s_nop 1
L_norm_1:
	s_mul_i32 s46, s22, 2359296
	s_lshl_b32 s47, s60, 15
	s_add_u32 s46, s46, s47
	s_lshl_b32 s47, s23, 11
	s_add_u32 s46, s46, s47
	s_lshl_b32 s47, s63, 10
	s_add_u32 s46, s46, s47
	s_add_u32 s46, s46, 10158080
	s_add_u32 s34, s20, s46
	s_addc_u32 s35, s21, 0
	s_mul_i32 s46, s22, 2359296
	s_lshl_b32 s47, s61, 15
	s_add_u32 s46, s46, s47
	s_lshl_b32 s47, s23, 11
	s_add_u32 s46, s46, s47
	s_lshl_b32 s47, s63, 10
	s_add_u32 s46, s46, s47
	s_add_u32 s46, s46, 10158080
	s_add_u32 s36, s20, s46
	s_addc_u32 s37, s21, 0
	v_rcp_f32 v24, v184
	s_nop 0
	v_pk_mul_f32 v[176:177], v[176:177], v[24:25] op_sel_hi:[1,0]
	v_pk_mul_f32 v[178:179], v[178:179], v[24:25] op_sel_hi:[1,0]
	v_pk_mul_f32 v[180:181], v[180:181], v[24:25] op_sel_hi:[1,0]
	v_pk_mul_f32 v[182:183], v[182:183], v[24:25] op_sel_hi:[1,0]
	v_cvt_pk_bf16_f32 v148, v176, v177
	v_cvt_pk_bf16_f32 v149, v178, v179
	v_cvt_pk_bf16_f32 v150, v180, v181
	v_cvt_pk_bf16_f32 v151, v182, v183
	global_store_dwordx4 v2, v[148:151], s[34:35] sc1
	v_rcp_f32 v24, v200
	s_nop 0
	v_pk_mul_f32 v[192:193], v[192:193], v[24:25] op_sel_hi:[1,0]
	v_pk_mul_f32 v[194:195], v[194:195], v[24:25] op_sel_hi:[1,0]
	v_pk_mul_f32 v[196:197], v[196:197], v[24:25] op_sel_hi:[1,0]
	v_pk_mul_f32 v[198:199], v[198:199], v[24:25] op_sel_hi:[1,0]
	v_cvt_pk_bf16_f32 v152, v192, v193
	v_cvt_pk_bf16_f32 v153, v194, v195
	v_cvt_pk_bf16_f32 v154, v196, v197
	v_cvt_pk_bf16_f32 v155, v198, v199
	global_store_dwordx4 v2, v[152:155], s[36:37] sc1
	s_lshl_b32 s46, s22, 8
	s_lshl_b32 s47, s23, 4
	s_add_u32 s46, s46, s47
	s_lshl_b32 s47, s24, 2
	s_add_u32 s46, s46, s47
	s_add_u32 s46, s46, 28672
	s_add_u32 s38, s20, s46
	s_addc_u32 s39, s21, 0
	s_waitcnt vmcnt(0) lgkmcnt(0)
	v_mov_b32 v28, s51
	v_mov_b32 v29, 0
	s_mov_b64 exec, 1
	s_cmp_eq_u32 s25, 1
	s_cbranch_scc1 L_alt_76
	global_store_dword v29, v28, s[38:39] sc1
	s_branch L_join_77
L_alt_76:
	global_store_dword v29, v28, s[38:39]
L_join_77:
	s_mov_b64 exec, -1
	global_load_dwordx4 a[64:67], v4, s[72:73] offset:0
	global_load_dwordx4 a[68:71], v4, s[74:75] offset:0
	global_load_dwordx4 a[72:75], v4, s[72:73] offset:1024
	global_load_dwordx4 a[76:79], v4, s[74:75] offset:1024
	global_load_dwordx4 a[80:83], v4, s[72:73] offset:2048
	global_load_dwordx4 a[84:87], v4, s[74:75] offset:2048
	global_load_dwordx4 a[88:91], v4, s[72:73] offset:3072
	v_lshlrev_b32 v32, 16, v10
	v_and_b32 v33, 0xffff0000, v10
	v_lshlrev_b32 v34, 16, v11
	v_and_b32 v35, 0xffff0000, v11
	v_lshlrev_b32 v36, 16, v12
	v_and_b32 v37, 0xffff0000, v12
	v_lshlrev_b32 v38, 16, v13
	v_and_b32 v39, 0xffff0000, v13
	v_lshlrev_b32 v40, 16, v14
	v_and_b32 v41, 0xffff0000, v14
	v_lshlrev_b32 v42, 16, v15
	v_and_b32 v43, 0xffff0000, v15
	v_lshlrev_b32 v44, 16, v16
	v_and_b32 v45, 0xffff0000, v16
	v_lshlrev_b32 v46, 16, v17
	v_and_b32 v47, 0xffff0000, v17
	s_xor_b32 s40, s70, 0
	s_mul_i32 s46, s22, 2359296
	s_lshl_b32 s47, s40, 15
	s_add_u32 s46, s46, s47
	s_lshl_b32 s47, s24, 13
	s_add_u32 s46, s46, s47
	s_add_u32 s46, s46, 10158080
	s_add_u32 s30, s20, s46
	s_addc_u32 s31, s21, 0
	s_xor_b32 s40, s70, 1
	s_mul_i32 s46, s22, 2359296
	s_lshl_b32 s47, s40, 15
	s_add_u32 s46, s46, s47
	s_lshl_b32 s47, s24, 13
	s_add_u32 s46, s46, s47
	s_add_u32 s46, s46, 10158080
	s_add_u32 s32, s20, s46
	s_addc_u32 s33, s21, 0
	s_lshl_b32 s46, s22, 8
	s_add_u32 s46, s46, 28672
	s_add_u32 s38, s20, s46
	s_addc_u32 s39, s21, 0
	s_mov_b32 s49, 0
	s_nop 1
L_poll_78:
	global_load_dword v28, v1, s[38:39] sc1
	s_waitcnt vmcnt(0)
	v_cmp_ne_u32 vcc, s51, v28
	s_nop 4
	s_cbranch_vccz L_pollout_79
	s_add_u32 s49, s49, 1
	s_cmp_ge_u32 s49, s26
	s_cbranch_scc0 L_poll_78
	s_mov_b32 s26, 1
L_pollout_79:
	global_load_dwordx4 a[192:195], v2, s[30:31] offset:0
	global_load_dwordx4 a[224:227], v2, s[32:33] offset:0
	global_load_dwordx4 a[196:199], v2, s[30:31] offset:1024
	global_load_dwordx4 a[228:231], v2, s[32:33] offset:1024
	global_load_dwordx4 a[200:203], v2, s[30:31] offset:2048
	global_load_dwordx4 a[232:235], v2, s[32:33] offset:2048
	global_load_dwordx4 a[204:207], v2, s[30:31] offset:3072
	global_load_dwordx4 a[236:239], v2, s[32:33] offset:3072
	s_waitcnt vmcnt(7)
	v_mfma_f32_32x32x16_bf16 v[32:47], a[128:131], a[192:195], v[32:47]
	global_load_dwordx4 a[208:211], v3, s[30:31] offset:0
	global_load_dwordx4 a[240:243], v3, s[32:33] offset:0
	s_waitcnt vmcnt(8)
	v_mfma_f32_32x32x16_bf16 v[48:63], a[128:131], a[224:227], 0
	v_mfma_f32_32x32x16_bf16 v[64:79], a[160:163], a[192:195], 0
	v_mfma_f32_32x32x16_bf16 v[80:95], a[160:163], a[224:227], 0
	s_waitcnt vmcnt(7)
	v_mfma_f32_32x32x16_bf16 v[32:47], a[132:135], a[196:199], v[32:47]
	global_load_dwordx4 a[212:215], v3, s[30:31] offset:1024
	global_load_dwordx4 a[244:247], v3, s[32:33] offset:1024
	s_waitcnt vmcnt(8)
	v_mfma_f32_32x32x16_bf16 v[48:63], a[132:135], a[228:231], v[48:63]
	v_mfma_f32_32x32x16_bf16 v[64:79], a[164:167], a[196:199], v[64:79]
	v_mfma_f32_32x32x16_bf16 v[80:95], a[164:167], a[228:231], v[80:95]
	s_waitcnt vmcnt(7)
	v_mfma_f32_32x32x16_bf16 v[32:47], a[136:139], a[200:203], v[32:47]
	global_load_dwordx4 a[216:219], v3, s[30:31] offset:2048
	global_load_dwordx4 a[248:251], v3, s[32:33] offset:2048
	s_waitcnt vmcnt(8)
	v_mfma_f32_32x32x16_bf16 v[48:63], a[136:139], a[232:235], v[48:63]
	v_mfma_f32_32x32x16_bf16 v[64:79], a[168:171], a[200:203], v[64:79]
	v_mfma_f32_32x32x16_bf16 v[80:95], a[168:171], a[232:235], v[80:95]
	s_waitcnt vmcnt(7)
	v_mfma_f32_32x32x16_bf16 v[32:47], a[140:143], a[204:207], v[32:47]
	global_load_dwordx4 a[220:223], v3, s[30:31] offset:3072
	global_load_dwordx4 a[252:255], v3, s[32:33] offset:3072
	s_waitcnt vmcnt(8)
	v_mfma_f32_32x32x16_bf16 v[48:63], a[140:143], a[236:239], v[48:63]
	v_mfma_f32_32x32x16_bf16 v[64:79], a[172:175], a[204:207], v[64:79]
	v_mfma_f32_32x32x16_bf16 v[80:95], a[172:175], a[236:239], v[80:95]
	s_waitcnt vmcnt(7)
	v_mfma_f32_32x32x16_bf16 v[32:47], a[144:147], a[208:211], v[32:47]
	s_add_u32 m0, s66, 86016
	s_nop 0
	global_load_lds_dwordx4 v2, s[64:65] offset:0
	s_waitcnt vmcnt(7)
	v_mfma_f32_32x32x16_bf16 v[48:63], a[144:147], a[240:243], v[48:63]
	global_load_lds_dwordx4 v2, s[64:65] offset:1024
	v_mfma_f32_32x32x16_bf16 v[64:79], a[176:179], a[208:211], v[64:79]
	global_load_lds_dwordx4 v2, s[64:65] offset:2048
	v_mfma_f32_32x32x16_bf16 v[80:95], a[176:179], a[240:243], v[80:95]
	global_load_lds_dwordx4 v2, s[64:65] offset:3072
	s_waitcnt vmcnt(9)
	v_mfma_f32_32x32x16_bf16 v[32:47], a[148:151], a[212:215], v[32:47]
	s_add_u32 m0, s66, 90112
	s_nop 0
	global_load_lds_dwordx4 v3, s[64:65] offset:0
	s_waitcnt vmcnt(9)
	v_mfma_f32_32x32x16_bf16 v[48:63], a[148:151], a[244:247], v[48:63]
	global_load_lds_dwordx4 v3, s[64:65] offset:1024
	v_mfma_f32_32x32x16_bf16 v[64:79], a[180:183], a[212:215], v[64:79]
	global_load_lds_dwordx4 v3, s[64:65] offset:2048
	s_add_u32 s64, s64, 28672
	s_addc_u32 s65, s65, 0
	v_mfma_f32_32x32x16_bf16 v[80:95], a[180:183], a[244:247], v[80:95]
	global_load_dwordx4 a[92:95], v4, s[74:75] offset:3072
	s_waitcnt vmcnt(11)
	v_mfma_f32_32x32x16_bf16 v[32:47], a[152:155], a[216:219], v[32:47]
	global_load_dwordx4 a[96:99], v5, s[72:73] offset:0
	s_waitcnt vmcnt(11)
	v_mfma_f32_32x32x16_bf16 v[48:63], a[152:155], a[248:251], v[48:63]
	global_load_dwordx4 a[100:103], v5, s[74:75] offset:0
	v_mfma_f32_32x32x16_bf16 v[64:79], a[184:187], a[216:219], v[64:79]
	global_load_dwordx4 a[104:107], v5, s[72:73] offset:1024
	v_mfma_f32_32x32x16_bf16 v[80:95], a[184:187], a[248:251], v[80:95]
	global_load_dwordx4 a[108:111], v5, s[74:75] offset:1024
	s_waitcnt vmcnt(13)
	v_mfma_f32_32x32x16_bf16 v[32:47], a[156:159], a[220:223], v[32:47]
	global_load_dwordx4 a[112:115], v5, s[72:73] offset:2048
	s_waitcnt vmcnt(13)
	v_mfma_f32_32x32x16_bf16 v[48:63], a[156:159], a[252:255], v[48:63]
	global_load_dwordx4 a[116:119], v5, s[74:75] offset:2048
	v_mfma_f32_32x32x16_bf16 v[64:79], a[188:191], a[220:223], v[64:79]
	v_mfma_f32_32x32x16_bf16 v[80:95], a[188:191], a[252:255], v[80:95]
	s_xor_b32 s40, s24, 1
	s_mul_i32 s40, s40, 12288
	s_add_u32 s40, s40, 114688
	v_add_u32 v21, s40, v2
	s_xor_b32 s40, s24, 2
	s_mul_i32 s40, s40, 12288
	s_add_u32 s40, s40, 118784
	v_add_u32 v22, s40, v2
	s_xor_b32 s40, s24, 3
	s_mul_i32 s40, s40, 12288
	s_add_u32 s40, s40, 122880
	v_add_u32 v23, s40, v2
	ds_write_b128 v21, v[48:51] offset:0
	ds_write_b128 v21, v[52:55] offset:1024
	ds_write_b128 v21, v[56:59] offset:2048
	ds_write_b128 v21, v[60:63] offset:3072
	ds_write_b128 v22, v[64:67] offset:0
	ds_write_b128 v22, v[68:71] offset:1024
	ds_write_b128 v22, v[72:75] offset:2048
	ds_write_b128 v22, v[76:79] offset:3072
	ds_write_b128 v23, v[80:83] offset:0
	ds_write_b128 v23, v[84:87] offset:1024
	ds_write_b128 v23, v[88:91] offset:2048
	ds_write_b128 v23, v[92:95] offset:3072
	s_mul_i32 s40, s24, 12288
	s_add_u32 s40, s40, 114688
	v_add_u32 v20, s40, v2
	s_waitcnt lgkmcnt(0)
	s_barrier
	ds_read_b128 v[96:99], v20 offset:0
	ds_read_b128 v[100:103], v20 offset:1024
	ds_read_b128 v[104:107], v20 offset:2048
	ds_read_b128 v[108:111], v20 offset:3072
	ds_read_b128 v[112:115], v20 offset:4096
	ds_read_b128 v[116:119], v20 offset:5120
	ds_read_b128 v[120:123], v20 offset:6144
	ds_read_b128 v[124:127], v20 offset:7168
	ds_read_b128 v[128:131], v20 offset:8192
	ds_read_b128 v[132:135], v20 offset:9216
	ds_read_b128 v[136:139], v20 offset:10240
	ds_read_b128 v[140:143], v20 offset:11264
	s_waitcnt lgkmcnt(11)
	v_pk_add_f32 v[32:33], v[32:33], v[96:97]
	v_pk_add_f32 v[34:35], v[34:35], v[98:99]
	s_waitcnt lgkmcnt(10)
	v_pk_add_f32 v[36:37], v[36:37], v[100:101]
	v_pk_add_f32 v[38:39], v[38:39], v[102:103]
	s_waitcnt lgkmcnt(9)
	v_pk_add_f32 v[40:41], v[40:41], v[104:105]
	v_pk_add_f32 v[42:43], v[42:43], v[106:107]
	s_waitcnt lgkmcnt(8)
	v_pk_add_f32 v[44:45], v[44:45], v[108:109]
	v_pk_add_f32 v[46:47], v[46:47], v[110:111]
	s_waitcnt lgkmcnt(7)
	v_pk_add_f32 v[32:33], v[32:33], v[112:113]
	v_pk_add_f32 v[34:35], v[34:35], v[114:115]
	s_waitcnt lgkmcnt(6)
	v_pk_add_f32 v[36:37], v[36:37], v[116:117]
	v_pk_add_f32 v[38:39], v[38:39], v[118:119]
	s_waitcnt lgkmcnt(5)
	v_pk_add_f32 v[40:41], v[40:41], v[120:121]
	v_pk_add_f32 v[42:43], v[42:43], v[122:123]
	s_waitcnt lgkmcnt(4)
	v_pk_add_f32 v[44:45], v[44:45], v[124:125]
	v_pk_add_f32 v[46:47], v[46:47], v[126:127]
	s_waitcnt lgkmcnt(3)
	v_pk_add_f32 v[32:33], v[32:33], v[128:129]
	v_pk_add_f32 v[34:35], v[34:35], v[130:131]
	s_waitcnt lgkmcnt(2)
	v_pk_add_f32 v[36:37], v[36:37], v[132:133]
	v_pk_add_f32 v[38:39], v[38:39], v[134:135]
	s_waitcnt lgkmcnt(1)
	v_pk_add_f32 v[40:41], v[40:41], v[136:137]
	v_pk_add_f32 v[42:43], v[42:43], v[138:139]
	s_waitcnt lgkmcnt(0)
	v_pk_add_f32 v[44:45], v[44:45], v[140:141]
	v_pk_add_f32 v[46:47], v[46:47], v[142:143]
	v_cvt_pk_bf16_f32 v10, v32, v33
	v_cvt_pk_bf16_f32 v11, v34, v35
	v_cvt_pk_bf16_f32 v12, v36, v37
	v_cvt_pk_bf16_f32 v13, v38, v39
	v_cvt_pk_bf16_f32 v14, v40, v41
	v_cvt_pk_bf16_f32 v15, v42, v43
	v_cvt_pk_bf16_f32 v16, v44, v45
	v_cvt_pk_bf16_f32 v17, v46, v47
	s_mul_i32 s46, s22, 2359296
	s_lshl_b32 s47, s70, 15
	s_add_u32 s46, s46, s47
	s_lshl_b32 s47, s29, 11
	s_add_u32 s46, s46, s47
	s_add_u32 s46, s46, 9830400
	s_add_u32 s34, s20, s46
	s_addc_u32 s35, s21, 0
	global_store_dwordx4 v2, v[10:13], s[34:35] offset:0 sc1
	global_store_dwordx4 v2, v[14:17], s[34:35] offset:1024 sc1
	s_mul_i32 s46, s22, 2359296
	s_lshl_b32 s47, s70, 12
	s_add_u32 s46, s46, s47
	s_lshl_b32 s47, s29, 8
	s_add_u32 s46, s46, s47
	s_add_u32 s46, s46, 10010624
	s_add_u32 s36, s20, s46
	s_addc_u32 s37, s21, 0
	v_pk_add_f32 v[96:97], v[32:33], v[34:35]
	v_pk_mul_f32 v[98:99], v[32:33], v[32:33]
	v_pk_fma_f32 v[98:99], v[34:35], v[34:35], v[98:99]
	v_pk_add_f32 v[96:97], v[96:97], v[36:37]
	v_pk_fma_f32 v[98:99], v[36:37], v[36:37], v[98:99]
	v_pk_add_f32 v[96:97], v[96:97], v[38:39]
	v_pk_fma_f32 v[98:99], v[38:39], v[38:39], v[98:99]
	v_pk_add_f32 v[96:97], v[96:97], v[40:41]
	v_pk_fma_f32 v[98:99], v[40:41], v[40:41], v[98:99]
	v_pk_add_f32 v[96:97], v[96:97], v[42:43]
	v_pk_fma_f32 v[98:99], v[42:43], v[42:43], v[98:99]
	v_pk_add_f32 v[96:97], v[96:97], v[44:45]
	v_pk_fma_f32 v[98:99], v[44:45], v[44:45], v[98:99]
	v_pk_add_f32 v[96:97], v[96:97], v[46:47]
	v_pk_fma_f32 v[98:99], v[46:47], v[46:47], v[98:99]
	v_add_f32 v96, v96, v97
	v_add_f32 v98, v98, v99
	s_nop 1
	v_permlane32_swap_b32 v96, v98
	v_add_f32 v96, v96, v98
	global_store_dword v1, v96, s[36:37] sc1
	s_lshl_b32 s46, s22, 8
	s_lshl_b32 s47, s23, 4
	s_add_u32 s46, s46, s47
	s_lshl_b32 s47, s24, 2
	s_add_u32 s46, s46, s47
	s_add_u32 s46, s46, 32768
	s_add_u32 s38, s20, s46
	s_addc_u32 s39, s21, 0
	s_waitcnt vmcnt(0) lgkmcnt(0)
	v_mov_b32 v28, s51
	v_mov_b32 v29, 0
	s_mov_b64 exec, 1
	s_cmp_eq_u32 s25, 1
	s_cbranch_scc1 L_alt_80
	global_store_dword v29, v28, s[38:39] sc1
	s_branch L_join_81
L_alt_80:
	global_store_dword v29, v28, s[38:39]
L_join_81:
	s_mov_b64 exec, -1
	global_load_dwordx4 a[120:123], v5, s[72:73] offset:3072
	global_load_dwordx4 a[124:127], v5, s[74:75] offset:3072
	s_mul_i32 s46, s22, 2359296
	s_lshl_b32 s47, s24, 15
	s_add_u32 s46, s46, s47
	s_add_u32 s46, s46, 9830400
	s_add_u32 s30, s20, s46
	s_addc_u32 s31, s21, 0
	s_mul_i32 s46, s23, 7168
	s_add_u32 s46, s46, 720896
	s_add_u32 s34, s20, s46
	s_addc_u32 s35, s21, 0
	v_and_b32 v24, 15, v0
	v_bfe_u32 v25, v0, 4, 1
	v_lshlrev_b32 v24, 4, v24
	v_lshrrev_b32 v22, 5, v0
	v_lshl_add_u32 v24, v25, 9, v24
	v_mul_u32_u24 v23, 7168, v22
	v_lshl_add_u32 v20, v22, 10, v24
	v_add_u32 v21, v23, v24
	v_lshl_add_u32 v24, v22, 8, v24
	v_add_u32 v22, 57344, v21
	v_add_u32 v23, 114688, v21
	v_add_u32 v25, 4096, v24
	s_lshl_b32 s46, s22, 8
	s_add_u32 s46, s46, 32768
	s_add_u32 s38, s20, s46
	s_addc_u32 s39, s21, 0
	s_mov_b32 s49, 0
	s_nop 1
L_poll_82:
	global_load_dword v28, v1, s[38:39] sc1
	s_waitcnt vmcnt(0)
	v_cmp_ne_u32 vcc, s51, v28
	s_nop 4
	s_cbranch_vccz L_pollout_83
	s_add_u32 s49, s49, 1
	s_cmp_ge_u32 s49, s26
	s_cbranch_scc0 L_poll_82
	s_mov_b32 s26, 1
L_pollout_83:
	global_load_dwordx4 a[128:131], v20, s[30:31] offset:0
	global_load_dwordx4 a[132:135], v20, s[30:31] offset:256
	global_load_dwordx4 a[136:139], v20, s[30:31] offset:2048
	global_load_dwordx4 a[140:143], v20, s[30:31] offset:2304
	s_add_u32 s30, s30, 4096
	s_addc_u32 s31, s31, 0
	s_mul_i32 s46, s22, 2359296
	s_lshl_b32 s47, s24, 12
	s_add_u32 s46, s46, s47
	s_add_u32 s46, s46, 10010624
	s_add_u32 s32, s20, s46
	s_addc_u32 s33, s21, 0
	global_load_dword v200, v1, s[32:33] offset:0
	global_load_dword v201, v1, s[32:33] offset:256
	global_load_dword v202, v1, s[32:33] offset:512
	global_load_dword v203, v1, s[32:33] offset:768
	global_load_dword v204, v1, s[32:33] offset:1024
	global_load_dword v205, v1, s[32:33] offset:1280
	global_load_dword v206, v1, s[32:33] offset:1536
	global_load_dword v207, v1, s[32:33] offset:1792
	global_load_dword v208, v1, s[32:33] offset:2048
	global_load_dword v209, v1, s[32:33] offset:2304
	global_load_dword v210, v1, s[32:33] offset:2560
	global_load_dword v211, v1, s[32:33] offset:2816
	global_load_dword v212, v1, s[32:33] offset:3072
	global_load_dword v213, v1, s[32:33] offset:3328
	global_load_dword v214, v1, s[32:33] offset:3584
	global_load_dword v215, v1, s[32:33] offset:3840
	global_load_dwordx4 a[144:147], v20, s[30:31] offset:0
	global_load_dwordx4 a[148:151], v20, s[30:31] offset:256
	ds_read_b128 v[144:147], v21 offset:0
	ds_read_b128 v[148:151], v21 offset:256
	ds_read_b128 v[152:155], v21 offset:1024
	ds_read_b128 v[156:159], v21 offset:1280
	ds_read_b128 v[160:163], v21 offset:2048
	ds_read_b128 v[164:167], v21 offset:2304
	ds_read_b128 v[168:171], v21 offset:3072
	s_waitcnt vmcnt(21) lgkmcnt(6)
	v_mfma_f32_16x16x32_bf16 v[32:35], v[144:147], a[128:131], 0
	ds_read_b128 v[172:175], v21 offset:3328
	s_waitcnt vmcnt(20)
	v_mfma_f32_16x16x32_bf16 v[36:39], v[144:147], a[132:135], 0
	global_load_dwordx4 a[152:155], v20, s[30:31] offset:2048
	s_waitcnt lgkmcnt(6)
	v_mfma_f32_16x16x32_bf16 v[40:43], v[148:151], a[128:131], 0
	ds_read_b128 v[176:179], v21 offset:4096
	v_mfma_f32_16x16x32_bf16 v[44:47], v[148:151], a[132:135], 0
	s_waitcnt lgkmcnt(6)
	v_mfma_f32_16x16x32_bf16 v[48:51], v[152:155], a[128:131], 0
	ds_read_b128 v[180:183], v21 offset:4352
	v_mfma_f32_16x16x32_bf16 v[52:55], v[152:155], a[132:135], 0
	s_add_u32 m0, s66, 114688
	s_nop 0
	global_load_lds_dwordx4 v2, s[64:65] offset:0
	s_waitcnt lgkmcnt(6)
	v_mfma_f32_16x16x32_bf16 v[56:59], v[156:159], a[128:131], 0
	ds_read_b128 v[184:187], v21 offset:5120
	v_mfma_f32_16x16x32_bf16 v[60:63], v[156:159], a[132:135], 0
	s_waitcnt lgkmcnt(6)
	v_mfma_f32_16x16x32_bf16 v[64:67], v[160:163], a[128:131], 0
	ds_read_b128 v[188:191], v21 offset:5376
	v_mfma_f32_16x16x32_bf16 v[68:71], v[160:163], a[132:135], 0
	global_load_lds_dwordx4 v2, s[64:65] offset:1024
	s_waitcnt lgkmcnt(6)
	v_mfma_f32_16x16x32_bf16 v[72:75], v[164:167], a[128:131], 0
	ds_read_b128 v[192:195], v21 offset:6144
	v_mfma_f32_16x16x32_bf16 v[76:79], v[164:167], a[132:135], 0
	s_waitcnt lgkmcnt(6)
	v_mfma_f32_16x16x32_bf16 v[80:83], v[168:171], a[128:131], 0
	ds_read_b128 v[196:199], v21 offset:6400
	v_mfma_f32_16x16x32_bf16 v[84:87], v[168:171], a[132:135], 0
	s_waitcnt lgkmcnt(6)
	v_mfma_f32_16x16x32_bf16 v[88:91], v[172:175], a[128:131], 0
	ds_read_b128 v[144:147], v21 offset:14336
	v_mfma_f32_16x16x32_bf16 v[92:95], v[172:175], a[132:135], 0
	global_load_dwordx4 a[156:159], v20, s[30:31] offset:2304
	s_add_u32 s30, s30, 4096
	s_addc_u32 s31, s31, 0
	s_waitcnt lgkmcnt(6)
	v_mfma_f32_16x16x32_bf16 v[96:99], v[176:179], a[128:131], 0
	ds_read_b128 v[148:151], v21 offset:14592
	v_mfma_f32_16x16x32_bf16 v[100:103], v[176:179], a[132:135], 0
	s_waitcnt lgkmcnt(6)
	v_mfma_f32_16x16x32_bf16 v[104:107], v[180:183], a[128:131], 0
	ds_read_b128 v[152:155], v21 offset:15360
	v_mfma_f32_16x16x32_bf16 v[108:111], v[180:183], a[132:135], 0
	global_load_lds_dwordx4 v2, s[64:65] offset:2048
	s_waitcnt lgkmcnt(6)
	v_mfma_f32_16x16x32_bf16 v[112:115], v[184:187], a[128:131], 0
	ds_read_b128 v[156:159], v21 offset:15616
	v_mfma_f32_16x16x32_bf16 v[116:119], v[184:187], a[132:135], 0
	s_waitcnt lgkmcnt(6)
	v_mfma_f32_16x16x32_bf16 v[120:123], v[188:191], a[128:131], 0
	ds_read_b128 v[160:163], v21 offset:16384
	v_mfma_f32_16x16x32_bf16 v[124:127], v[188:191], a[132:135], 0
	global_load_lds_dwordx4 v2, s[64:65] offset:3072
	s_waitcnt lgkmcnt(6)
	v_mfma_f32_16x16x32_bf16 v[128:131], v[192:195], a[128:131], 0
	ds_read_b128 v[164:167], v21 offset:16640
	v_mfma_f32_16x16x32_bf16 v[132:135], v[192:195], a[132:135], 0
	s_waitcnt lgkmcnt(6)
	v_mfma_f32_16x16x32_bf16 v[136:139], v[196:199], a[128:131], 0
	ds_read_b128 v[168:171], v21 offset:17408
	v_mfma_f32_16x16x32_bf16 v[140:143], v[196:199], a[132:135], 0
	s_waitcnt vmcnt(25) lgkmcnt(6)
	v_mfma_f32_16x16x32_bf16 v[32:35], v[144:147], a[136:139], v[32:35]
	ds_read_b128 v[172:175], v21 offset:17664
	s_waitcnt vmcnt(24)
	v_mfma_f32_16x16x32_bf16 v[36:39], v[144:147], a[140:143], v[36:39]
	global_load_dwordx4 a[160:163], v20, s[30:31] offset:0
	s_waitcnt lgkmcnt(6)
	v_mfma_f32_16x16x32_bf16 v[40:43], v[148:151], a[136:139], v[40:43]
	ds_read_b128 v[176:179], v21 offset:18432
	v_mfma_f32_16x16x32_bf16 v[44:47], v[148:151], a[140:143], v[44:47]
	s_waitcnt lgkmcnt(6)
	v_mfma_f32_16x16x32_bf16 v[48:51], v[152:155], a[136:139], v[48:51]
	ds_read_b128 v[180:183], v21 offset:18688
	v_mfma_f32_16x16x32_bf16 v[52:55], v[152:155], a[140:143], v[52:55]
	s_add_u32 m0, s66, 118784
	s_nop 0
	global_load_lds_dwordx4 v3, s[64:65] offset:0
	s_waitcnt lgkmcnt(6)
	v_mfma_f32_16x16x32_bf16 v[56:59], v[156:159], a[136:139], v[56:59]
	ds_read_b128 v[184:187], v21 offset:19456
	v_mfma_f32_16x16x32_bf16 v[60:63], v[156:159], a[140:143], v[60:63]
	s_waitcnt lgkmcnt(6)
	v_mfma_f32_16x16x32_bf16 v[64:67], v[160:163], a[136:139], v[64:67]
	ds_read_b128 v[188:191], v21 offset:19712
	v_mfma_f32_16x16x32_bf16 v[68:71], v[160:163], a[140:143], v[68:71]
	global_load_lds_dwordx4 v3, s[64:65] offset:1024
	s_waitcnt lgkmcnt(6)
	v_mfma_f32_16x16x32_bf16 v[72:75], v[164:167], a[136:139], v[72:75]
	ds_read_b128 v[192:195], v21 offset:20480
	v_mfma_f32_16x16x32_bf16 v[76:79], v[164:167], a[140:143], v[76:79]
	s_waitcnt lgkmcnt(6)
	v_mfma_f32_16x16x32_bf16 v[80:83], v[168:171], a[136:139], v[80:83]
	ds_read_b128 v[196:199], v21 offset:20736
	v_mfma_f32_16x16x32_bf16 v[84:87], v[168:171], a[140:143], v[84:87]
	s_waitcnt lgkmcnt(6)
	v_mfma_f32_16x16x32_bf16 v[88:91], v[172:175], a[136:139], v[88:91]
	ds_read_b128 v[144:147], v21 offset:28672
	v_mfma_f32_16x16x32_bf16 v[92:95], v[172:175], a[140:143], v[92:95]
	global_load_dwordx4 a[164:167], v20, s[30:31] offset:256
	s_waitcnt lgkmcnt(6)
	v_mfma_f32_16x16x32_bf16 v[96:99], v[176:179], a[136:139], v[96:99]
	ds_read_b128 v[148:151], v21 offset:28928
	v_mfma_f32_16x16x32_bf16 v[100:103], v[176:179], a[140:143], v[100:103]
	s_waitcnt lgkmcnt(6)
	v_mfma_f32_16x16x32_bf16 v[104:107], v[180:183], a[136:139], v[104:107]
	ds_read_b128 v[152:155], v21 offset:29696
	v_mfma_f32_16x16x32_bf16 v[108:111], v[180:183], a[140:143], v[108:111]
	global_load_lds_dwordx4 v3, s[64:65] offset:2048
	s_add_u32 s64, s64, 28672
	s_addc_u32 s65, s65, 0
	s_waitcnt lgkmcnt(6)
	v_mfma_f32_16x16x32_bf16 v[112:115], v[184:187], a[136:139], v[112:115]
	ds_read_b128 v[156:159], v21 offset:29952
	v_mfma_f32_16x16x32_bf16 v[116:119], v[184:187], a[140:143], v[116:119]
	s_waitcnt lgkmcnt(6)
	v_mfma_f32_16x16x32_bf16 v[120:123], v[188:191], a[136:139], v[120:123]
	ds_read_b128 v[160:163], v21 offset:30720
	v_mfma_f32_16x16x32_bf16 v[124:127], v[188:191], a[140:143], v[124:127]
	global_load_dwordx4 a[128:131], v6, s[72:73] offset:0
	s_waitcnt lgkmcnt(6)
	v_mfma_f32_16x16x32_bf16 v[128:131], v[192:195], a[136:139], v[128:131]
	ds_read_b128 v[164:167], v21 offset:30976
	v_mfma_f32_16x16x32_bf16 v[132:135], v[192:195], a[140:143], v[132:135]
	s_waitcnt lgkmcnt(6)
	v_mfma_f32_16x16x32_bf16 v[136:139], v[196:199], a[136:139], v[136:139]
	ds_read_b128 v[168:171], v21 offset:31744
	v_mfma_f32_16x16x32_bf16 v[140:143], v[196:199], a[140:143], v[140:143]
	s_waitcnt vmcnt(13) lgkmcnt(6)
	v_mfma_f32_16x16x32_bf16 v[32:35], v[144:147], a[144:147], v[32:35]
	ds_read_b128 v[172:175], v21 offset:32000
	s_waitcnt vmcnt(12)
	v_mfma_f32_16x16x32_bf16 v[36:39], v[144:147], a[148:151], v[36:39]
	global_load_dwordx4 a[168:171], v20, s[30:31] offset:2048
	s_waitcnt lgkmcnt(6)
	v_mfma_f32_16x16x32_bf16 v[40:43], v[148:151], a[144:147], v[40:43]
	ds_read_b128 v[176:179], v21 offset:32768
	v_mfma_f32_16x16x32_bf16 v[44:47], v[148:151], a[148:151], v[44:47]
	v_pk_add_f32 v[200:201], v[200:201], v[208:209]
	s_waitcnt lgkmcnt(6)
	v_mfma_f32_16x16x32_bf16 v[48:51], v[152:155], a[144:147], v[48:51]
	ds_read_b128 v[180:183], v21 offset:33024
	v_mfma_f32_16x16x32_bf16 v[52:55], v[152:155], a[148:151], v[52:55]
	global_load_dwordx4 a[132:135], v6, s[74:75] offset:0
	s_waitcnt lgkmcnt(6)
	v_mfma_f32_16x16x32_bf16 v[56:59], v[156:159], a[144:147], v[56:59]
	ds_read_b128 v[184:187], v21 offset:33792
	v_mfma_f32_16x16x32_bf16 v[60:63], v[156:159], a[148:151], v[60:63]
	v_pk_add_f32 v[202:203], v[202:203], v[210:211]
	s_waitcnt lgkmcnt(6)
	v_mfma_f32_16x16x32_bf16 v[64:67], v[160:163], a[144:147], v[64:67]
	ds_read_b128 v[188:191], v21 offset:34048
	v_mfma_f32_16x16x32_bf16 v[68:71], v[160:163], a[148:151], v[68:71]
	global_load_dwordx4 a[136:139], v6, s[72:73] offset:1024
	s_waitcnt lgkmcnt(6)
	v_mfma_f32_16x16x32_bf16 v[72:75], v[164:167], a[144:147], v[72:75]
	ds_read_b128 v[192:195], v21 offset:34816
	v_mfma_f32_16x16x32_bf16 v[76:79], v[164:167], a[148:151], v[76:79]
	v_pk_add_f32 v[204:205], v[204:205], v[212:213]
	s_waitcnt lgkmcnt(6)
	v_mfma_f32_16x16x32_bf16 v[80:83], v[168:171], a[144:147], v[80:83]
	ds_read_b128 v[196:199], v21 offset:35072
	v_mfma_f32_16x16x32_bf16 v[84:87], v[168:171], a[148:151], v[84:87]
	s_waitcnt lgkmcnt(6)
	v_mfma_f32_16x16x32_bf16 v[88:91], v[172:175], a[144:147], v[88:91]
	ds_read_b128 v[144:147], v21 offset:43008
	v_mfma_f32_16x16x32_bf16 v[92:95], v[172:175], a[148:151], v[92:95]
	global_load_dwordx4 a[172:175], v20, s[30:31] offset:2304
	s_add_u32 s30, s30, 4096
	s_addc_u32 s31, s31, 0
	s_waitcnt lgkmcnt(6)
	v_mfma_f32_16x16x32_bf16 v[96:99], v[176:179], a[144:147], v[96:99]
	ds_read_b128 v[148:151], v21 offset:43264
	v_mfma_f32_16x16x32_bf16 v[100:103], v[176:179], a[148:151], v[100:103]
	v_pk_add_f32 v[206:207], v[206:207], v[214:215]
	s_waitcnt lgkmcnt(6)
	v_mfma_f32_16x16x32_bf16 v[104:107], v[180:183], a[144:147], v[104:107]
	ds_read_b128 v[152:155], v21 offset:44032
	v_mfma_f32_16x16x32_bf16 v[108:111], v[180:183], a[148:151], v[108:111]
	global_load_dwordx4 a[140:143], v6, s[74:75] offset:1024
	s_waitcnt lgkmcnt(6)
	v_mfma_f32_16x16x32_bf16 v[112:115], v[184:187], a[144:147], v[112:115]
	ds_read_b128 v[156:159], v21 offset:44288
	v_mfma_f32_16x16x32_bf16 v[116:119], v[184:187], a[148:151], v[116:119]
	v_pk_add_f32 v[200:201], v[200:201], v[204:205]
	s_waitcnt lgkmcnt(6)
	v_mfma_f32_16x16x32_bf16 v[120:123], v[188:191], a[144:147], v[120:123]
	ds_read_b128 v[160:163], v21 offset:45056
	v_mfma_f32_16x16x32_bf16 v[124:127], v[188:191], a[148:151], v[124:127]
	s_waitcnt lgkmcnt(6)
	v_mfma_f32_16x16x32_bf16 v[128:131], v[192:195], a[144:147], v[128:131]
	ds_read_b128 v[164:167], v21 offset:45312
	v_mfma_f32_16x16x32_bf16 v[132:135], v[192:195], a[148:151], v[132:135]
	v_pk_add_f32 v[202:203], v[202:203], v[206:207]
	s_waitcnt lgkmcnt(6)
	v_mfma_f32_16x16x32_bf16 v[136:139], v[196:199], a[144:147], v[136:139]
	ds_read_b128 v[168:171], v21 offset:46080
	v_mfma_f32_16x16x32_bf16 v[140:143], v[196:199], a[148:151], v[140:143]
	s_waitcnt vmcnt(16) lgkmcnt(6)
	v_mfma_f32_16x16x32_bf16 v[32:35], v[144:147], a[152:155], v[32:35]
	ds_read_b128 v[172:175], v21 offset:46336
	s_waitcnt vmcnt(13)
	v_mfma_f32_16x16x32_bf16 v[36:39], v[144:147], a[156:159], v[36:39]
	global_load_dwordx4 a[176:179], v20, s[30:31] offset:0
	s_waitcnt lgkmcnt(6)
	v_mfma_f32_16x16x32_bf16 v[40:43], v[148:151], a[152:155], v[40:43]
	ds_read_b128 v[176:179], v21 offset:47104
	v_mfma_f32_16x16x32_bf16 v[44:47], v[148:151], a[156:159], v[44:47]
	v_pk_add_f32 v[200:201], v[200:201], v[202:203]
	s_waitcnt lgkmcnt(6)
	v_mfma_f32_16x16x32_bf16 v[48:51], v[152:155], a[152:155], v[48:51]
	ds_read_b128 v[180:183], v21 offset:47360
	v_mfma_f32_16x16x32_bf16 v[52:55], v[152:155], a[156:159], v[52:55]
	global_load_dwordx4 a[144:147], v6, s[72:73] offset:2048
	s_waitcnt lgkmcnt(6)
	v_mfma_f32_16x16x32_bf16 v[56:59], v[156:159], a[152:155], v[56:59]
	ds_read_b128 v[184:187], v21 offset:48128
	v_mfma_f32_16x16x32_bf16 v[60:63], v[156:159], a[156:159], v[60:63]
	v_add_f32 v200, v200, v201
	s_waitcnt lgkmcnt(6)
	v_mfma_f32_16x16x32_bf16 v[64:67], v[160:163], a[152:155], v[64:67]
	ds_read_b128 v[188:191], v21 offset:48384
	v_mfma_f32_16x16x32_bf16 v[68:71], v[160:163], a[156:159], v[68:71]
	global_load_dwordx4 a[148:151], v6, s[74:75] offset:2048
	s_waitcnt lgkmcnt(6)
	v_mfma_f32_16x16x32_bf16 v[72:75], v[164:167], a[152:155], v[72:75]
	ds_read_b128 v[192:195], v21 offset:49152
	v_mfma_f32_16x16x32_bf16 v[76:79], v[164:167], a[156:159], v[76:79]
	v_mov_b32 v201, v200
	s_waitcnt lgkmcnt(6)
	v_mfma_f32_16x16x32_bf16 v[80:83], v[168:171], a[152:155], v[80:83]
	ds_read_b128 v[196:199], v21 offset:49408
	v_mfma_f32_16x16x32_bf16 v[84:87], v[168:171], a[156:159], v[84:87]
	s_barrier
	s_waitcnt lgkmcnt(6)
	v_mfma_f32_16x16x32_bf16 v[88:91], v[172:175], a[152:155], v[88:91]
	ds_read_b128 v[144:147], v22 offset:0
	v_mfma_f32_16x16x32_bf16 v[92:95], v[172:175], a[156:159], v[92:95]
	global_load_dwordx4 a[180:183], v20, s[30:31] offset:256
	s_waitcnt lgkmcnt(6)
	v_mfma_f32_16x16x32_bf16 v[96:99], v[176:179], a[152:155], v[96:99]
	ds_read_b128 v[148:151], v22 offset:256
	v_mfma_f32_16x16x32_bf16 v[100:103], v[176:179], a[156:159], v[100:103]
	v_permlane32_swap_b32 v200, v201
	s_waitcnt lgkmcnt(6)
	v_mfma_f32_16x16x32_bf16 v[104:107], v[180:183], a[152:155], v[104:107]
	ds_read_b128 v[152:155], v22 offset:1024
	v_mfma_f32_16x16x32_bf16 v[108:111], v[180:183], a[156:159], v[108:111]
	s_add_u32 m0, s66, 0
	s_nop 0
	global_load_lds_dwordx4 v2, s[64:65] offset:0
	s_waitcnt lgkmcnt(6)
	v_mfma_f32_16x16x32_bf16 v[112:115], v[184:187], a[152:155], v[112:115]
	ds_read_b128 v[156:159], v22 offset:1280
	v_mfma_f32_16x16x32_bf16 v[116:119], v[184:187], a[156:159], v[116:119]
	v_mul_f32 v200, 0xbb000000, v200
	s_waitcnt lgkmcnt(6)
	v_mfma_f32_16x16x32_bf16 v[120:123], v[188:191], a[152:155], v[120:123]
	ds_read_b128 v[160:163], v22 offset:2048
	v_mfma_f32_16x16x32_bf16 v[124:127], v[188:191], a[156:159], v[124:127]
	global_load_lds_dwordx4 v2, s[64:65] offset:1024
	s_waitcnt lgkmcnt(6)
	v_mfma_f32_16x16x32_bf16 v[128:131], v[192:195], a[152:155], v[128:131]
	ds_read_b128 v[164:167], v22 offset:2304
	v_mfma_f32_16x16x32_bf16 v[132:135], v[192:195], a[156:159], v[132:135]
	v_mul_f32 v201, 0x3b000000, v201
	s_waitcnt lgkmcnt(6)
	v_mfma_f32_16x16x32_bf16 v[136:139], v[196:199], a[152:155], v[136:139]
	ds_read_b128 v[168:171], v22 offset:3072
	v_mfma_f32_16x16x32_bf16 v[140:143], v[196:199], a[156:159], v[140:143]
	s_waitcnt vmcnt(16) lgkmcnt(6)
	v_mfma_f32_16x16x32_bf16 v[32:35], v[144:147], a[160:163], v[32:35]
	ds_read_b128 v[172:175], v22 offset:3328
	s_waitcnt vmcnt(13)
	v_mfma_f32_16x16x32_bf16 v[36:39], v[144:147], a[164:167], v[36:39]
	global_load_dwordx4 a[184:187], v20, s[30:31] offset:2048
	s_waitcnt lgkmcnt(6)
	v_mfma_f32_16x16x32_bf16 v[40:43], v[148:151], a[160:163], v[40:43]
	ds_read_b128 v[176:179], v22 offset:4096
	v_mfma_f32_16x16x32_bf16 v[44:47], v[148:151], a[164:167], v[44:47]
	v_cvt_pk_bf16_f32 v202, v200, v200
	s_waitcnt lgkmcnt(6)
	v_mfma_f32_16x16x32_bf16 v[48:51], v[152:155], a[160:163], v[48:51]
	ds_read_b128 v[180:183], v22 offset:4352
	v_mfma_f32_16x16x32_bf16 v[52:55], v[152:155], a[164:167], v[52:55]
	global_load_lds_dwordx4 v2, s[64:65] offset:2048
	s_waitcnt lgkmcnt(6)
	v_mfma_f32_16x16x32_bf16 v[56:59], v[156:159], a[160:163], v[56:59]
	ds_read_b128 v[184:187], v22 offset:5120
	v_mfma_f32_16x16x32_bf16 v[60:63], v[156:159], a[164:167], v[60:63]
	v_fma_f32 v201, -v200, v200, v201
	s_waitcnt lgkmcnt(6)
	v_mfma_f32_16x16x32_bf16 v[64:67], v[160:163], a[160:163], v[64:67]
	ds_read_b128 v[188:191], v22 offset:5376
	v_mfma_f32_16x16x32_bf16 v[68:71], v[160:163], a[164:167], v[68:71]
	global_load_lds_dwordx4 v2, s[64:65] offset:3072
	s_waitcnt lgkmcnt(6)
	v_mfma_f32_16x16x32_bf16 v[72:75], v[164:167], a[160:163], v[72:75]
	ds_read_b128 v[192:195], v22 offset:6144
	v_mfma_f32_16x16x32_bf16 v[76:79], v[164:167], a[164:167], v[76:79]
	v_lshlrev_b32 v202, 16, v202
	s_waitcnt lgkmcnt(6)
	v_mfma_f32_16x16x32_bf16 v[80:83], v[168:171], a[160:163], v[80:83]
	ds_read_b128 v[196:199], v22 offset:6400
	v_mfma_f32_16x16x32_bf16 v[84:87], v[168:171], a[164:167], v[84:87]
	s_waitcnt lgkmcnt(6)
	v_mfma_f32_16x16x32_bf16 v[88:91], v[172:175], a[160:163], v[88:91]
	ds_read_b128 v[144:147], v22 offset:14336
	v_mfma_f32_16x16x32_bf16 v[92:95], v[172:175], a[164:167], v[92:95]
	global_load_dwordx4 a[188:191], v20, s[30:31] offset:2304
	s_add_u32 s30, s30, 4096
	s_addc_u32 s31, s31, 0
	s_waitcnt lgkmcnt(6)
	v_mfma_f32_16x16x32_bf16 v[96:99], v[176:179], a[160:163], v[96:99]
	ds_read_b128 v[148:151], v22 offset:14592
	v_mfma_f32_16x16x32_bf16 v[100:103], v[176:179], a[164:167], v[100:103]
	v_max_f32 v201, 0, v201
	s_waitcnt lgkmcnt(6)
	v_mfma_f32_16x16x32_bf16 v[104:107], v[180:183], a[160:163], v[104:107]
	ds_read_b128 v[152:155], v22 offset:15360
	v_mfma_f32_16x16x32_bf16 v[108:111], v[180:183], a[164:167], v[108:111]
	s_add_u32 m0, s66, 4096
	s_nop 0
	global_load_lds_dwordx4 v3, s[64:65] offset:0
	s_waitcnt lgkmcnt(6)
	v_mfma_f32_16x16x32_bf16 v[112:115], v[184:187], a[160:163], v[112:115]
	ds_read_b128 v[156:159], v22 offset:15616
	v_mfma_f32_16x16x32_bf16 v[116:119], v[184:187], a[164:167], v[116:119]
	v_sub_f32 v202, v200, v202
	s_waitcnt lgkmcnt(6)
	v_mfma_f32_16x16x32_bf16 v[120:123], v[188:191], a[160:163], v[120:123]
	ds_read_b128 v[160:163], v22 offset:16384
	v_mfma_f32_16x16x32_bf16 v[124:127], v[188:191], a[164:167], v[124:127]
	global_load_lds_dwordx4 v3, s[64:65] offset:1024
	s_waitcnt lgkmcnt(6)
	v_mfma_f32_16x16x32_bf16 v[128:131], v[192:195], a[160:163], v[128:131]
	ds_read_b128 v[164:167], v22 offset:16640
	v_mfma_f32_16x16x32_bf16 v[132:135], v[192:195], a[164:167], v[132:135]
	v_add_f32 v201, 0x3727c5ac, v201
	s_waitcnt lgkmcnt(6)
	v_mfma_f32_16x16x32_bf16 v[136:139], v[196:199], a[160:163], v[136:139]
	ds_read_b128 v[168:171], v22 offset:17408
	v_mfma_f32_16x16x32_bf16 v[140:143], v[196:199], a[164:167], v[140:143]
	s_waitcnt vmcnt(16) lgkmcnt(6)
	v_mfma_f32_16x16x32_bf16 v[32:35], v[144:147], a[168:171], v[32:35]
	ds_read_b128 v[172:175], v22 offset:17664
	s_waitcnt vmcnt(13)
	v_mfma_f32_16x16x32_bf16 v[36:39], v[144:147], a[172:175], v[36:39]
	global_load_dwordx4 a[192:195], v20, s[30:31] offset:0
	s_waitcnt lgkmcnt(6)
	v_mfma_f32_16x16x32_bf16 v[40:43], v[148:151], a[168:171], v[40:43]
	ds_read_b128 v[176:179], v22 offset:18432
	v_mfma_f32_16x16x32_bf16 v[44:47], v[148:151], a[172:175], v[44:47]
	v_cvt_pk_bf16_f32 v203, v200, v202
	s_waitcnt lgkmcnt(6)
	v_mfma_f32_16x16x32_bf16 v[48:51], v[152:155], a[168:171], v[48:51]
	ds_read_b128 v[180:183], v22 offset:18688
	v_mfma_f32_16x16x32_bf16 v[52:55], v[152:155], a[172:175], v[52:55]
	global_load_lds_dwordx4 v3, s[64:65] offset:2048
	s_add_u32 s64, s64, 28672
	s_addc_u32 s65, s65, 0
	s_waitcnt lgkmcnt(6)
	v_mfma_f32_16x16x32_bf16 v[56:59], v[156:159], a[168:171], v[56:59]
	ds_read_b128 v[184:187], v22 offset:19456
	v_mfma_f32_16x16x32_bf16 v[60:63], v[156:159], a[172:175], v[60:63]
	v_rsq_f32 v216, v201
	s_waitcnt lgkmcnt(6)
	v_mfma_f32_16x16x32_bf16 v[64:67], v[160:163], a[168:171], v[64:67]
	ds_read_b128 v[188:191], v22 offset:19712
	v_mfma_f32_16x16x32_bf16 v[68:71], v[160:163], a[172:175], v[68:71]
	global_load_dwordx4 a[152:155], v6, s[72:73] offset:3072
	s_waitcnt lgkmcnt(6)
	v_mfma_f32_16x16x32_bf16 v[72:75], v[164:167], a[168:171], v[72:75]
	ds_read_b128 v[192:195], v22 offset:20480
	v_mfma_f32_16x16x32_bf16 v[76:79], v[164:167], a[172:175], v[76:79]
	v_mul_f32 v216, v216, v216
	s_waitcnt lgkmcnt(6)
	v_mfma_f32_16x16x32_bf16 v[80:83], v[168:171], a[168:171], v[80:83]
	ds_read_b128 v[196:199], v22 offset:20736
	v_mfma_f32_16x16x32_bf16 v[84:87], v[168:171], a[172:175], v[84:87]
	s_barrier
	s_waitcnt lgkmcnt(6)
	v_mfma_f32_16x16x32_bf16 v[88:91], v[172:175], a[168:171], v[88:91]
	ds_read_b128 v[144:147], v22 offset:28672
	v_mfma_f32_16x16x32_bf16 v[92:95], v[172:175], a[172:175], v[92:95]
	global_load_dwordx4 a[196:199], v20, s[30:31] offset:256
	s_waitcnt lgkmcnt(6)
	v_mfma_f32_16x16x32_bf16 v[96:99], v[176:179], a[168:171], v[96:99]
	ds_read_b128 v[148:151], v22 offset:28928
	v_mfma_f32_16x16x32_bf16 v[100:103], v[176:179], a[172:175], v[100:103]
	v_mov_b32 v204, v203
	s_waitcnt lgkmcnt(6)
	v_mfma_f32_16x16x32_bf16 v[104:107], v[180:183], a[168:171], v[104:107]
	ds_read_b128 v[152:155], v22 offset:29696
	v_mfma_f32_16x16x32_bf16 v[108:111], v[180:183], a[172:175], v[108:111]
	s_add_u32 m0, s66, 28672
	s_nop 0
	global_load_lds_dwordx4 v2, s[64:65] offset:0
	s_waitcnt lgkmcnt(6)
	v_mfma_f32_16x16x32_bf16 v[112:115], v[184:187], a[168:171], v[112:115]
	ds_read_b128 v[156:159], v22 offset:29952
	v_mfma_f32_16x16x32_bf16 v[116:119], v[184:187], a[172:175], v[116:119]
	v_mov_b32 v208, v203
	s_waitcnt lgkmcnt(6)
	v_mfma_f32_16x16x32_bf16 v[120:123], v[188:191], a[168:171], v[120:123]
	ds_read_b128 v[160:163], v22 offset:30720
	v_mfma_f32_16x16x32_bf16 v[124:127], v[188:191], a[172:175], v[124:127]
	global_load_lds_dwordx4 v2, s[64:65] offset:1024
	s_waitcnt lgkmcnt(6)
	v_mfma_f32_16x16x32_bf16 v[128:131], v[192:195], a[168:171], v[128:131]
	ds_read_b128 v[164:167], v22 offset:30976
	v_mfma_f32_16x16x32_bf16 v[132:135], v[192:195], a[172:175], v[132:135]
	v_mov_b32 v246, v216
	s_waitcnt lgkmcnt(6)
	v_mfma_f32_16x16x32_bf16 v[136:139], v[196:199], a[168:171], v[136:139]
	ds_read_b128 v[168:171], v22 offset:31744
	v_mfma_f32_16x16x32_bf16 v[140:143], v[196:199], a[172:175], v[140:143]
	s_waitcnt vmcnt(17) lgkmcnt(6)
	v_mfma_f32_16x16x32_bf16 v[32:35], v[144:147], a[176:179], v[32:35]
	ds_read_b128 v[172:175], v22 offset:32000
	s_waitcnt vmcnt(14)
	v_mfma_f32_16x16x32_bf16 v[36:39], v[144:147], a[180:183], v[36:39]
	global_load_dwordx4 a[200:203], v20, s[30:31] offset:2048
	s_waitcnt lgkmcnt(6)
	v_mfma_f32_16x16x32_bf16 v[40:43], v[148:151], a[176:179], v[40:43]
	ds_read_b128 v[176:179], v22 offset:32768
	v_mfma_f32_16x16x32_bf16 v[44:47], v[148:151], a[180:183], v[44:47]
	v_permlane16_swap_b32 v204, v208
	s_waitcnt lgkmcnt(6)
	v_mfma_f32_16x16x32_bf16 v[48:51], v[152:155], a[176:179], v[48:51]
	ds_read_b128 v[180:183], v22 offset:33024
	v_mfma_f32_16x16x32_bf16 v[52:55], v[152:155], a[180:183], v[52:55]
	global_load_lds_dwordx4 v2, s[64:65] offset:2048
	s_waitcnt lgkmcnt(6)
	v_mfma_f32_16x16x32_bf16 v[56:59], v[156:159], a[176:179], v[56:59]
	ds_read_b128 v[184:187], v22 offset:33792
	v_mfma_f32_16x16x32_bf16 v[60:63], v[156:159], a[180:183], v[60:63]
	v_permlane16_swap_b32 v216, v246
	s_waitcnt lgkmcnt(6)
	v_mfma_f32_16x16x32_bf16 v[64:67], v[160:163], a[176:179], v[64:67]
	ds_read_b128 v[188:191], v22 offset:34048
	v_mfma_f32_16x16x32_bf16 v[68:71], v[160:163], a[180:183], v[68:71]
	global_load_lds_dwordx4 v2, s[64:65] offset:3072
	s_waitcnt lgkmcnt(6)
	v_mfma_f32_16x16x32_bf16 v[72:75], v[164:167], a[176:179], v[72:75]
	ds_read_b128 v[192:195], v22 offset:34816
	v_mfma_f32_16x16x32_bf16 v[76:79], v[164:167], a[180:183], v[76:79]
	v_mov_b32 v206, 0
	s_waitcnt lgkmcnt(6)
	v_mfma_f32_16x16x32_bf16 v[80:83], v[168:171], a[176:179], v[80:83]
	ds_read_b128 v[196:199], v22 offset:35072
	v_mfma_f32_16x16x32_bf16 v[84:87], v[168:171], a[180:183], v[84:87]
	s_waitcnt lgkmcnt(6)
	v_mfma_f32_16x16x32_bf16 v[88:91], v[172:175], a[176:179], v[88:91]
	ds_read_b128 v[144:147], v22 offset:43008
	v_mfma_f32_16x16x32_bf16 v[92:95], v[172:175], a[180:183], v[92:95]
	global_load_dwordx4 a[204:207], v20, s[30:31] offset:2304
	s_add_u32 s30, s30, 4096
	s_addc_u32 s31, s31, 0
	s_waitcnt lgkmcnt(6)
	v_mfma_f32_16x16x32_bf16 v[96:99], v[176:179], a[176:179], v[96:99]
	ds_read_b128 v[148:151], v22 offset:43264
	v_mfma_f32_16x16x32_bf16 v[100:103], v[176:179], a[180:183], v[100:103]
	v_mov_b32 v207, 0
	s_waitcnt lgkmcnt(6)
	v_mfma_f32_16x16x32_bf16 v[104:107], v[180:183], a[176:179], v[104:107]
	ds_read_b128 v[152:155], v22 offset:44032
	v_mfma_f32_16x16x32_bf16 v[108:111], v[180:183], a[180:183], v[108:111]
	s_add_u32 m0, s66, 32768
	s_nop 0
	global_load_lds_dwordx4 v3, s[64:65] offset:0
	s_waitcnt lgkmcnt(6)
	v_mfma_f32_16x16x32_bf16 v[112:115], v[184:187], a[176:179], v[112:115]
	ds_read_b128 v[156:159], v22 offset:44288
	v_mfma_f32_16x16x32_bf16 v[116:119], v[184:187], a[180:183], v[116:119]
	v_mov_b32 v210, 0
	s_waitcnt lgkmcnt(6)
	v_mfma_f32_16x16x32_bf16 v[120:123], v[188:191], a[176:179], v[120:123]
	ds_read_b128 v[160:163], v22 offset:45056
	v_mfma_f32_16x16x32_bf16 v[124:127], v[188:191], a[180:183], v[124:127]
	global_load_lds_dwordx4 v3, s[64:65] offset:1024
	s_waitcnt lgkmcnt(6)
	v_mfma_f32_16x16x32_bf16 v[128:131], v[192:195], a[176:179], v[128:131]
	ds_read_b128 v[164:167], v22 offset:45312
	v_mfma_f32_16x16x32_bf16 v[132:135], v[192:195], a[180:183], v[132:135]
	v_mov_b32 v211, 0
	s_waitcnt lgkmcnt(6)
	v_mfma_f32_16x16x32_bf16 v[136:139], v[196:199], a[176:179], v[136:139]
	ds_read_b128 v[168:171], v22 offset:46080
	v_mfma_f32_16x16x32_bf16 v[140:143], v[196:199], a[180:183], v[140:143]
	s_waitcnt vmcnt(17) lgkmcnt(6)
	v_mfma_f32_16x16x32_bf16 v[32:35], v[144:147], a[184:187], v[32:35]
	ds_read_b128 v[172:175], v22 offset:46336
	s_waitcnt vmcnt(14)
	v_mfma_f32_16x16x32_bf16 v[36:39], v[144:147], a[188:191], v[36:39]
	global_load_dwordx4 a[208:211], v20, s[30:31] offset:0
	s_waitcnt lgkmcnt(6)
	v_mfma_f32_16x16x32_bf16 v[40:43], v[148:151], a[184:187], v[40:43]
	ds_read_b128 v[176:179], v22 offset:47104
	v_mfma_f32_16x16x32_bf16 v[44:47], v[148:151], a[188:191], v[44:47]
	v_mov_b32 v205, v204
	s_waitcnt lgkmcnt(6)
	v_mfma_f32_16x16x32_bf16 v[48:51], v[152:155], a[184:187], v[48:51]
	ds_read_b128 v[180:183], v22 offset:47360
	v_mfma_f32_16x16x32_bf16 v[52:55], v[152:155], a[188:191], v[52:55]
	global_load_lds_dwordx4 v3, s[64:65] offset:2048
	s_add_u32 s64, s64, 28672
	s_addc_u32 s65, s65, 0
	s_waitcnt lgkmcnt(6)
	v_mfma_f32_16x16x32_bf16 v[56:59], v[156:159], a[184:187], v[56:59]
	ds_read_b128 v[184:187], v22 offset:48128
	v_mfma_f32_16x16x32_bf16 v[60:63], v[156:159], a[188:191], v[60:63]
	v_mov_b32 v209, v208
	s_waitcnt lgkmcnt(6)
	v_mfma_f32_16x16x32_bf16 v[64:67], v[160:163], a[184:187], v[64:67]
	ds_read_b128 v[188:191], v22 offset:48384
	v_mfma_f32_16x16x32_bf16 v[68:71], v[160:163], a[188:191], v[68:71]
	global_load_dwordx4 a[156:159], v6, s[74:75] offset:3072
	s_waitcnt lgkmcnt(6)
	v_mfma_f32_16x16x32_bf16 v[72:75], v[164:167], a[184:187], v[72:75]
	ds_read_b128 v[192:195], v22 offset:49152
	v_mfma_f32_16x16x32_bf16 v[76:79], v[164:167], a[188:191], v[76:79]
	v_mov_b32 v212, v204
	s_waitcnt lgkmcnt(6)
	v_mfma_f32_16x16x32_bf16 v[80:83], v[168:171], a[184:187], v[80:83]
	ds_read_b128 v[196:199], v22 offset:49408
	v_mfma_f32_16x16x32_bf16 v[84:87], v[168:171], a[188:191], v[84:87]
	s_barrier
	s_waitcnt lgkmcnt(6)
	v_mfma_f32_16x16x32_bf16 v[88:91], v[172:175], a[184:187], v[88:91]
	ds_read_b128 v[144:147], v23 offset:0
	v_mfma_f32_16x16x32_bf16 v[92:95], v[172:175], a[188:191], v[92:95]
	global_load_dwordx4 a[212:215], v20, s[30:31] offset:256
	s_waitcnt lgkmcnt(6)
	v_mfma_f32_16x16x32_bf16 v[96:99], v[176:179], a[184:187], v[96:99]
	ds_read_b128 v[148:151], v23 offset:256
	v_mfma_f32_16x16x32_bf16 v[100:103], v[176:179], a[188:191], v[100:103]
	v_mov_b32 v213, v204
	s_waitcnt lgkmcnt(6)
	v_mfma_f32_16x16x32_bf16 v[104:107], v[180:183], a[184:187], v[104:107]
	ds_read_b128 v[152:155], v23 offset:1024
	v_mfma_f32_16x16x32_bf16 v[108:111], v[180:183], a[188:191], v[108:111]
	s_add_u32 m0, s66, 57344
	s_nop 0
	global_load_lds_dwordx4 v2, s[64:65] offset:0
	s_waitcnt lgkmcnt(6)
	v_mfma_f32_16x16x32_bf16 v[112:115], v[184:187], a[184:187], v[112:115]
	ds_read_b128 v[156:159], v23 offset:1280
	v_mfma_f32_16x16x32_bf16 v[116:119], v[184:187], a[188:191], v[116:119]
	s_waitcnt lgkmcnt(6)
	v_mfma_f32_16x16x32_bf16 v[120:123], v[188:191], a[184:187], v[120:123]
	ds_read_b128 v[160:163], v23 offset:2048
	v_mfma_f32_16x16x32_bf16 v[124:127], v[188:191], a[188:191], v[124:127]
	global_load_lds_dwordx4 v2, s[64:65] offset:1024
	s_waitcnt lgkmcnt(6)
	v_mfma_f32_16x16x32_bf16 v[128:131], v[192:195], a[184:187], v[128:131]
	ds_read_b128 v[164:167], v23 offset:2304
	v_mfma_f32_16x16x32_bf16 v[132:135], v[192:195], a[188:191], v[132:135]
	s_waitcnt lgkmcnt(6)
	v_mfma_f32_16x16x32_bf16 v[136:139], v[196:199], a[184:187], v[136:139]
	ds_read_b128 v[168:171], v23 offset:3072
	v_mfma_f32_16x16x32_bf16 v[140:143], v[196:199], a[188:191], v[140:143]
	s_waitcnt vmcnt(17) lgkmcnt(6)
	v_mfma_f32_16x16x32_bf16 v[32:35], v[144:147], a[192:195], v[32:35]
	ds_read_b128 v[172:175], v23 offset:3328
	s_waitcnt vmcnt(14)
	v_mfma_f32_16x16x32_bf16 v[36:39], v[144:147], a[196:199], v[36:39]
	global_load_dwordx4 a[216:219], v20, s[30:31] offset:2048
	s_waitcnt lgkmcnt(6)
	v_mfma_f32_16x16x32_bf16 v[40:43], v[148:151], a[192:195], v[40:43]
	ds_read_b128 v[176:179], v23 offset:4096
	v_mfma_f32_16x16x32_bf16 v[44:47], v[148:151], a[196:199], v[44:47]
	s_waitcnt lgkmcnt(6)
	v_mfma_f32_16x16x32_bf16 v[48:51], v[152:155], a[192:195], v[48:51]
	ds_read_b128 v[180:183], v23 offset:4352
	v_mfma_f32_16x16x32_bf16 v[52:55], v[152:155], a[196:199], v[52:55]
	global_load_lds_dwordx4 v2, s[64:65] offset:2048
	s_waitcnt lgkmcnt(6)
	v_mfma_f32_16x16x32_bf16 v[56:59], v[156:159], a[192:195], v[56:59]
	ds_read_b128 v[184:187], v23 offset:5120
	v_mfma_f32_16x16x32_bf16 v[60:63], v[156:159], a[196:199], v[60:63]
	s_waitcnt lgkmcnt(6)
	v_mfma_f32_16x16x32_bf16 v[64:67], v[160:163], a[192:195], v[64:67]
	ds_read_b128 v[188:191], v23 offset:5376
	v_mfma_f32_16x16x32_bf16 v[68:71], v[160:163], a[196:199], v[68:71]
	global_load_lds_dwordx4 v2, s[64:65] offset:3072
	s_waitcnt lgkmcnt(6)
	v_mfma_f32_16x16x32_bf16 v[72:75], v[164:167], a[192:195], v[72:75]
	ds_read_b128 v[192:195], v23 offset:6144
	v_mfma_f32_16x16x32_bf16 v[76:79], v[164:167], a[196:199], v[76:79]
	s_waitcnt lgkmcnt(6)
	v_mfma_f32_16x16x32_bf16 v[80:83], v[168:171], a[192:195], v[80:83]
	ds_read_b128 v[196:199], v23 offset:6400
	v_mfma_f32_16x16x32_bf16 v[84:87], v[168:171], a[196:199], v[84:87]
	s_waitcnt lgkmcnt(6)
	v_mfma_f32_16x16x32_bf16 v[88:91], v[172:175], a[192:195], v[88:91]
	ds_read_b128 v[144:147], v23 offset:14336
	v_mfma_f32_16x16x32_bf16 v[92:95], v[172:175], a[196:199], v[92:95]
	global_load_dwordx4 a[220:223], v20, s[30:31] offset:2304
	s_add_u32 s30, s30, 4096
	s_addc_u32 s31, s31, 0
	s_waitcnt lgkmcnt(6)
	v_mfma_f32_16x16x32_bf16 v[96:99], v[176:179], a[192:195], v[96:99]
	ds_read_b128 v[148:151], v23 offset:14592
	v_mfma_f32_16x16x32_bf16 v[100:103], v[176:179], a[196:199], v[100:103]
	s_waitcnt lgkmcnt(6)
	v_mfma_f32_16x16x32_bf16 v[104:107], v[180:183], a[192:195], v[104:107]
	ds_read_b128 v[152:155], v23 offset:15360
	v_mfma_f32_16x16x32_bf16 v[108:111], v[180:183], a[196:199], v[108:111]
	s_add_u32 m0, s66, 61440
	s_nop 0
	global_load_lds_dwordx4 v3, s[64:65] offset:0
	s_waitcnt lgkmcnt(6)
	v_mfma_f32_16x16x32_bf16 v[112:115], v[184:187], a[192:195], v[112:115]
	ds_read_b128 v[156:159], v23 offset:15616
	v_mfma_f32_16x16x32_bf16 v[116:119], v[184:187], a[196:199], v[116:119]
	s_waitcnt lgkmcnt(6)
	v_mfma_f32_16x16x32_bf16 v[120:123], v[188:191], a[192:195], v[120:123]
	ds_read_b128 v[160:163], v23 offset:16384
	v_mfma_f32_16x16x32_bf16 v[124:127], v[188:191], a[196:199], v[124:127]
	global_load_lds_dwordx4 v3, s[64:65] offset:1024
	s_waitcnt lgkmcnt(6)
	v_mfma_f32_16x16x32_bf16 v[128:131], v[192:195], a[192:195], v[128:131]
	ds_read_b128 v[164:167], v23 offset:16640
	v_mfma_f32_16x16x32_bf16 v[132:135], v[192:195], a[196:199], v[132:135]
	s_waitcnt lgkmcnt(6)
	v_mfma_f32_16x16x32_bf16 v[136:139], v[196:199], a[192:195], v[136:139]
	ds_read_b128 v[168:171], v23 offset:17408
	v_mfma_f32_16x16x32_bf16 v[140:143], v[196:199], a[196:199], v[140:143]
	s_waitcnt vmcnt(17) lgkmcnt(6)
	v_mfma_f32_16x16x32_bf16 v[32:35], v[144:147], a[200:203], v[32:35]
	ds_read_b128 v[172:175], v23 offset:17664
	s_waitcnt vmcnt(14)
	v_mfma_f32_16x16x32_bf16 v[36:39], v[144:147], a[204:207], v[36:39]
	global_load_dwordx4 a[224:227], v20, s[30:31] offset:0
	s_waitcnt lgkmcnt(6)
	v_mfma_f32_16x16x32_bf16 v[40:43], v[148:151], a[200:203], v[40:43]
	ds_read_b128 v[176:179], v23 offset:18432
	v_mfma_f32_16x16x32_bf16 v[44:47], v[148:151], a[204:207], v[44:47]
	s_waitcnt lgkmcnt(6)
	v_mfma_f32_16x16x32_bf16 v[48:51], v[152:155], a[200:203], v[48:51]
	ds_read_b128 v[180:183], v23 offset:18688
	v_mfma_f32_16x16x32_bf16 v[52:55], v[152:155], a[204:207], v[52:55]
	global_load_lds_dwordx4 v3, s[64:65] offset:2048
	s_add_u32 s64, s64, 28672
	s_addc_u32 s65, s65, 0
	s_waitcnt lgkmcnt(6)
	v_mfma_f32_16x16x32_bf16 v[56:59], v[156:159], a[200:203], v[56:59]
	ds_read_b128 v[184:187], v23 offset:19456
	v_mfma_f32_16x16x32_bf16 v[60:63], v[156:159], a[204:207], v[60:63]
	s_waitcnt lgkmcnt(6)
	v_mfma_f32_16x16x32_bf16 v[64:67], v[160:163], a[200:203], v[64:67]
	ds_read_b128 v[188:191], v23 offset:19712
	v_mfma_f32_16x16x32_bf16 v[68:71], v[160:163], a[204:207], v[68:71]
	global_load_dwordx4 a[160:163], v7, s[72:73] offset:0
	s_waitcnt lgkmcnt(6)
	v_mfma_f32_16x16x32_bf16 v[72:75], v[164:167], a[200:203], v[72:75]
	ds_read_b128 v[192:195], v23 offset:20480
	v_mfma_f32_16x16x32_bf16 v[76:79], v[164:167], a[204:207], v[76:79]
	s_waitcnt lgkmcnt(6)
	v_mfma_f32_16x16x32_bf16 v[80:83], v[168:171], a[200:203], v[80:83]
	ds_read_b128 v[196:199], v23 offset:20736
	v_mfma_f32_16x16x32_bf16 v[84:87], v[168:171], a[204:207], v[84:87]
	s_barrier
	s_waitcnt lgkmcnt(6)
	v_mfma_f32_16x16x32_bf16 v[88:91], v[172:175], a[200:203], v[88:91]
	ds_read_b128 v[144:147], v21 offset:0
	v_mfma_f32_16x16x32_bf16 v[92:95], v[172:175], a[204:207], v[92:95]
	global_load_dwordx4 a[228:231], v20, s[30:31] offset:256
	s_waitcnt lgkmcnt(6)
	v_mfma_f32_16x16x32_bf16 v[96:99], v[176:179], a[200:203], v[96:99]
	ds_read_b128 v[148:151], v21 offset:256
	v_mfma_f32_16x16x32_bf16 v[100:103], v[176:179], a[204:207], v[100:103]
	s_waitcnt lgkmcnt(6)
	v_mfma_f32_16x16x32_bf16 v[104:107], v[180:183], a[200:203], v[104:107]
	ds_read_b128 v[152:155], v21 offset:1024
	v_mfma_f32_16x16x32_bf16 v[108:111], v[180:183], a[204:207], v[108:111]
	global_load_dwordx4 v[218:221], v2, s[34:35] offset:0
	s_waitcnt lgkmcnt(6)
	v_mfma_f32_16x16x32_bf16 v[112:115], v[184:187], a[200:203], v[112:115]
	ds_read_b128 v[156:159], v21 offset:1280
	v_mfma_f32_16x16x32_bf16 v[116:119], v[184:187], a[204:207], v[116:119]
	s_waitcnt lgkmcnt(6)
	v_mfma_f32_16x16x32_bf16 v[120:123], v[188:191], a[200:203], v[120:123]
	ds_read_b128 v[160:163], v21 offset:2048
	v_mfma_f32_16x16x32_bf16 v[124:127], v[188:191], a[204:207], v[124:127]
	global_load_dwordx4 v[222:225], v2, s[34:35] offset:1024
	s_waitcnt lgkmcnt(6)
	v_mfma_f32_16x16x32_bf16 v[128:131], v[192:195], a[200:203], v[128:131]
	ds_read_b128 v[164:167], v21 offset:2304
	v_mfma_f32_16x16x32_bf16 v[132:135], v[192:195], a[204:207], v[132:135]
	s_waitcnt lgkmcnt(6)
	v_mfma_f32_16x16x32_bf16 v[136:139], v[196:199], a[200:203], v[136:139]
	ds_read_b128 v[168:171], v21 offset:3072
	v_mfma_f32_16x16x32_bf16 v[140:143], v[196:199], a[204:207], v[140:143]
	s_waitcnt vmcnt(17) lgkmcnt(6)
	v_mfma_f32_16x16x32_bf16 v[32:35], v[144:147], a[208:211], v[32:35]
	ds_read_b128 v[172:175], v21 offset:3328
	s_waitcnt vmcnt(14)
	v_mfma_f32_16x16x32_bf16 v[36:39], v[144:147], a[212:215], v[36:39]
	global_load_dwordx4 a[232:235], v20, s[30:31] offset:2048
	s_waitcnt lgkmcnt(6)
	v_mfma_f32_16x16x32_bf16 v[40:43], v[148:151], a[208:211], v[40:43]
	ds_read_b128 v[176:179], v21 offset:4096
	v_mfma_f32_16x16x32_bf16 v[44:47], v[148:151], a[212:215], v[44:47]
	s_waitcnt lgkmcnt(6)
	v_mfma_f32_16x16x32_bf16 v[48:51], v[152:155], a[208:211], v[48:51]
	ds_read_b128 v[180:183], v21 offset:4352
	v_mfma_f32_16x16x32_bf16 v[52:55], v[152:155], a[212:215], v[52:55]
	global_load_dwordx4 v[226:229], v2, s[34:35] offset:2048
	s_waitcnt lgkmcnt(6)
	v_mfma_f32_16x16x32_bf16 v[56:59], v[156:159], a[208:211], v[56:59]
	ds_read_b128 v[184:187], v21 offset:5120
	v_mfma_f32_16x16x32_bf16 v[60:63], v[156:159], a[212:215], v[60:63]
	s_waitcnt lgkmcnt(6)
	v_mfma_f32_16x16x32_bf16 v[64:67], v[160:163], a[208:211], v[64:67]
	ds_read_b128 v[188:191], v21 offset:5376
	v_mfma_f32_16x16x32_bf16 v[68:71], v[160:163], a[212:215], v[68:71]
	global_load_dwordx4 v[230:233], v2, s[34:35] offset:3072
	s_waitcnt lgkmcnt(6)
	v_mfma_f32_16x16x32_bf16 v[72:75], v[164:167], a[208:211], v[72:75]
	ds_read_b128 v[192:195], v21 offset:6144
	v_mfma_f32_16x16x32_bf16 v[76:79], v[164:167], a[212:215], v[76:79]
	s_waitcnt lgkmcnt(6)
	v_mfma_f32_16x16x32_bf16 v[80:83], v[168:171], a[208:211], v[80:83]
	ds_read_b128 v[196:199], v21 offset:6400
	v_mfma_f32_16x16x32_bf16 v[84:87], v[168:171], a[212:215], v[84:87]
	s_waitcnt lgkmcnt(6)
	v_mfma_f32_16x16x32_bf16 v[88:91], v[172:175], a[208:211], v[88:91]
	ds_read_b128 v[144:147], v21 offset:14336
	v_mfma_f32_16x16x32_bf16 v[92:95], v[172:175], a[212:215], v[92:95]
	global_load_dwordx4 a[236:239], v20, s[30:31] offset:2304
	s_add_u32 s30, s30, 4096
	s_addc_u32 s31, s31, 0
	s_waitcnt lgkmcnt(6)
	v_mfma_f32_16x16x32_bf16 v[96:99], v[176:179], a[208:211], v[96:99]
	ds_read_b128 v[148:151], v21 offset:14592
	v_mfma_f32_16x16x32_bf16 v[100:103], v[176:179], a[212:215], v[100:103]
	s_waitcnt lgkmcnt(6)
	v_mfma_f32_16x16x32_bf16 v[104:107], v[180:183], a[208:211], v[104:107]
	ds_read_b128 v[152:155], v21 offset:15360
	v_mfma_f32_16x16x32_bf16 v[108:111], v[180:183], a[212:215], v[108:111]
	global_load_dwordx4 v[234:237], v3, s[34:35] offset:0
	s_waitcnt lgkmcnt(6)
	v_mfma_f32_16x16x32_bf16 v[112:115], v[184:187], a[208:211], v[112:115]
	ds_read_b128 v[156:159], v21 offset:15616
	v_mfma_f32_16x16x32_bf16 v[116:119], v[184:187], a[212:215], v[116:119]
	s_waitcnt lgkmcnt(6)
	v_mfma_f32_16x16x32_bf16 v[120:123], v[188:191], a[208:211], v[120:123]
	ds_read_b128 v[160:163], v21 offset:16384
	v_mfma_f32_16x16x32_bf16 v[124:127], v[188:191], a[212:215], v[124:127]
	global_load_dwordx4 v[238:241], v3, s[34:35] offset:1024
	s_waitcnt lgkmcnt(6)
	v_mfma_f32_16x16x32_bf16 v[128:131], v[192:195], a[208:211], v[128:131]
	ds_read_b128 v[164:167], v21 offset:16640
	v_mfma_f32_16x16x32_bf16 v[132:135], v[192:195], a[212:215], v[132:135]
	s_waitcnt lgkmcnt(6)
	v_mfma_f32_16x16x32_bf16 v[136:139], v[196:199], a[208:211], v[136:139]
	ds_read_b128 v[168:171], v21 offset:17408
	v_mfma_f32_16x16x32_bf16 v[140:143], v[196:199], a[212:215], v[140:143]
	s_waitcnt vmcnt(17) lgkmcnt(6)
	v_mfma_f32_16x16x32_bf16 v[32:35], v[144:147], a[216:219], v[32:35]
	ds_read_b128 v[172:175], v21 offset:17664
	s_waitcnt vmcnt(14)
	v_mfma_f32_16x16x32_bf16 v[36:39], v[144:147], a[220:223], v[36:39]
	global_load_dwordx4 a[240:243], v20, s[30:31] offset:0
	s_waitcnt lgkmcnt(6)
	v_mfma_f32_16x16x32_bf16 v[40:43], v[148:151], a[216:219], v[40:43]
	ds_read_b128 v[176:179], v21 offset:18432
	v_mfma_f32_16x16x32_bf16 v[44:47], v[148:151], a[220:223], v[44:47]
	s_waitcnt lgkmcnt(6)
	v_mfma_f32_16x16x32_bf16 v[48:51], v[152:155], a[216:219], v[48:51]
	ds_read_b128 v[180:183], v21 offset:18688
	v_mfma_f32_16x16x32_bf16 v[52:55], v[152:155], a[220:223], v[52:55]
	global_load_dwordx4 v[242:245], v3, s[34:35] offset:2048
	s_waitcnt lgkmcnt(6)
	v_mfma_f32_16x16x32_bf16 v[56:59], v[156:159], a[216:219], v[56:59]
	ds_read_b128 v[184:187], v21 offset:19456
	v_mfma_f32_16x16x32_bf16 v[60:63], v[156:159], a[220:223], v[60:63]
	s_waitcnt lgkmcnt(6)
	v_mfma_f32_16x16x32_bf16 v[64:67], v[160:163], a[216:219], v[64:67]
	ds_read_b128 v[188:191], v21 offset:19712
	v_mfma_f32_16x16x32_bf16 v[68:71], v[160:163], a[220:223], v[68:71]
	global_load_dwordx4 a[164:167], v7, s[74:75] offset:0
	s_waitcnt lgkmcnt(6)
	v_mfma_f32_16x16x32_bf16 v[72:75], v[164:167], a[216:219], v[72:75]
	ds_read_b128 v[192:195], v21 offset:20480
	v_mfma_f32_16x16x32_bf16 v[76:79], v[164:167], a[220:223], v[76:79]
	s_waitcnt lgkmcnt(6)
	v_mfma_f32_16x16x32_bf16 v[80:83], v[168:171], a[216:219], v[80:83]
	ds_read_b128 v[196:199], v21 offset:20736
	v_mfma_f32_16x16x32_bf16 v[84:87], v[168:171], a[220:223], v[84:87]
	s_barrier
	s_waitcnt lgkmcnt(6)
	v_mfma_f32_16x16x32_bf16 v[88:91], v[172:175], a[216:219], v[88:91]
	ds_read_b128 v[144:147], v21 offset:28672
	v_mfma_f32_16x16x32_bf16 v[92:95], v[172:175], a[220:223], v[92:95]
	global_load_dwordx4 a[244:247], v20, s[30:31] offset:256
	s_waitcnt lgkmcnt(6)
	v_mfma_f32_16x16x32_bf16 v[96:99], v[176:179], a[216:219], v[96:99]
	ds_read_b128 v[148:151], v21 offset:28928
	v_mfma_f32_16x16x32_bf16 v[100:103], v[176:179], a[220:223], v[100:103]
	s_waitcnt lgkmcnt(6)
	v_mfma_f32_16x16x32_bf16 v[104:107], v[180:183], a[216:219], v[104:107]
	ds_read_b128 v[152:155], v21 offset:29696
	v_mfma_f32_16x16x32_bf16 v[108:111], v[180:183], a[220:223], v[108:111]
	global_load_dwordx4 a[168:171], v7, s[72:73] offset:1024
	s_waitcnt lgkmcnt(6)
	v_mfma_f32_16x16x32_bf16 v[112:115], v[184:187], a[216:219], v[112:115]
	ds_read_b128 v[156:159], v21 offset:29952
	v_mfma_f32_16x16x32_bf16 v[116:119], v[184:187], a[220:223], v[116:119]
	s_waitcnt lgkmcnt(6)
	v_mfma_f32_16x16x32_bf16 v[120:123], v[188:191], a[216:219], v[120:123]
	ds_read_b128 v[160:163], v21 offset:30720
	v_mfma_f32_16x16x32_bf16 v[124:127], v[188:191], a[220:223], v[124:127]
	global_load_dwordx4 a[172:175], v7, s[74:75] offset:1024
	s_waitcnt lgkmcnt(6)
	v_mfma_f32_16x16x32_bf16 v[128:131], v[192:195], a[216:219], v[128:131]
	ds_read_b128 v[164:167], v21 offset:30976
	v_mfma_f32_16x16x32_bf16 v[132:135], v[192:195], a[220:223], v[132:135]
	s_waitcnt lgkmcnt(6)
	v_mfma_f32_16x16x32_bf16 v[136:139], v[196:199], a[216:219], v[136:139]
	ds_read_b128 v[168:171], v21 offset:31744
	v_mfma_f32_16x16x32_bf16 v[140:143], v[196:199], a[220:223], v[140:143]
	s_waitcnt vmcnt(17) lgkmcnt(6)
	v_mfma_f32_16x16x32_bf16 v[32:35], v[144:147], a[224:227], v[32:35]
	ds_read_b128 v[172:175], v21 offset:32000
	s_waitcnt vmcnt(14)
	v_mfma_f32_16x16x32_bf16 v[36:39], v[144:147], a[228:231], v[36:39]
	global_load_dwordx4 a[248:251], v20, s[30:31] offset:2048
	s_waitcnt lgkmcnt(6)
	v_mfma_f32_16x16x32_bf16 v[40:43], v[148:151], a[224:227], v[40:43]
	ds_read_b128 v[176:179], v21 offset:32768
	v_mfma_f32_16x16x32_bf16 v[44:47], v[148:151], a[228:231], v[44:47]
	s_waitcnt lgkmcnt(6)
	v_mfma_f32_16x16x32_bf16 v[48:51], v[152:155], a[224:227], v[48:51]
	ds_read_b128 v[180:183], v21 offset:33024
	v_mfma_f32_16x16x32_bf16 v[52:55], v[152:155], a[228:231], v[52:55]
	global_load_dwordx4 a[176:179], v7, s[72:73] offset:2048
	s_waitcnt lgkmcnt(6)
	v_mfma_f32_16x16x32_bf16 v[56:59], v[156:159], a[224:227], v[56:59]
	ds_read_b128 v[184:187], v21 offset:33792
	v_mfma_f32_16x16x32_bf16 v[60:63], v[156:159], a[228:231], v[60:63]
	s_waitcnt lgkmcnt(6)
	v_mfma_f32_16x16x32_bf16 v[64:67], v[160:163], a[224:227], v[64:67]
	ds_read_b128 v[188:191], v21 offset:34048
	v_mfma_f32_16x16x32_bf16 v[68:71], v[160:163], a[228:231], v[68:71]
	global_load_dwordx4 a[180:183], v7, s[74:75] offset:2048
	s_waitcnt lgkmcnt(6)
	v_mfma_f32_16x16x32_bf16 v[72:75], v[164:167], a[224:227], v[72:75]
	ds_read_b128 v[192:195], v21 offset:34816
	v_mfma_f32_16x16x32_bf16 v[76:79], v[164:167], a[228:231], v[76:79]
	s_waitcnt lgkmcnt(6)
	v_mfma_f32_16x16x32_bf16 v[80:83], v[168:171], a[224:227], v[80:83]
	ds_read_b128 v[196:199], v21 offset:35072
	v_mfma_f32_16x16x32_bf16 v[84:87], v[168:171], a[228:231], v[84:87]
	s_waitcnt lgkmcnt(6)
	v_mfma_f32_16x16x32_bf16 v[88:91], v[172:175], a[224:227], v[88:91]
	ds_read_b128 v[144:147], v21 offset:43008
	v_mfma_f32_16x16x32_bf16 v[92:95], v[172:175], a[228:231], v[92:95]
	global_load_dwordx4 a[252:255], v20, s[30:31] offset:2304
	s_waitcnt lgkmcnt(6)
	v_mfma_f32_16x16x32_bf16 v[96:99], v[176:179], a[224:227], v[96:99]
	ds_read_b128 v[148:151], v21 offset:43264
	v_mfma_f32_16x16x32_bf16 v[100:103], v[176:179], a[228:231], v[100:103]
	s_waitcnt lgkmcnt(6)
	v_mfma_f32_16x16x32_bf16 v[104:107], v[180:183], a[224:227], v[104:107]
	ds_read_b128 v[152:155], v21 offset:44032
	v_mfma_f32_16x16x32_bf16 v[108:111], v[180:183], a[228:231], v[108:111]
	global_load_dwordx4 a[184:187], v7, s[72:73] offset:3072
	s_waitcnt lgkmcnt(6)
	v_mfma_f32_16x16x32_bf16 v[112:115], v[184:187], a[224:227], v[112:115]
	ds_read_b128 v[156:159], v21 offset:44288
	v_mfma_f32_16x16x32_bf16 v[116:119], v[184:187], a[228:231], v[116:119]
	s_waitcnt lgkmcnt(6)
	v_mfma_f32_16x16x32_bf16 v[120:123], v[188:191], a[224:227], v[120:123]
	ds_read_b128 v[160:163], v21 offset:45056
	v_mfma_f32_16x16x32_bf16 v[124:127], v[188:191], a[228:231], v[124:127]
	global_load_dwordx4 a[188:191], v7, s[74:75] offset:3072
	s_waitcnt lgkmcnt(6)
	v_mfma_f32_16x16x32_bf16 v[128:131], v[192:195], a[224:227], v[128:131]
	ds_read_b128 v[164:167], v21 offset:45312
	v_mfma_f32_16x16x32_bf16 v[132:135], v[192:195], a[228:231], v[132:135]
	s_waitcnt lgkmcnt(6)
	v_mfma_f32_16x16x32_bf16 v[136:139], v[196:199], a[224:227], v[136:139]
	ds_read_b128 v[168:171], v21 offset:46080
	v_mfma_f32_16x16x32_bf16 v[140:143], v[196:199], a[228:231], v[140:143]
	s_waitcnt vmcnt(17) lgkmcnt(6)
	v_mfma_f32_16x16x32_bf16 v[32:35], v[144:147], a[232:235], v[32:35]
	ds_read_b128 v[172:175], v21 offset:46336
	s_waitcnt vmcnt(14)
	v_mfma_f32_16x16x32_bf16 v[36:39], v[144:147], a[236:239], v[36:39]
	global_load_dwordx4 a[192:195], v8, s[72:73] offset:0
	s_waitcnt lgkmcnt(6)
	v_mfma_f32_16x16x32_bf16 v[40:43], v[148:151], a[232:235], v[40:43]
	ds_read_b128 v[176:179], v21 offset:47104
	v_mfma_f32_16x16x32_bf16 v[44:47], v[148:151], a[236:239], v[44:47]
	s_waitcnt lgkmcnt(6)
	v_mfma_f32_16x16x32_bf16 v[48:51], v[152:155], a[232:235], v[48:51]
	ds_read_b128 v[180:183], v21 offset:47360
	v_mfma_f32_16x16x32_bf16 v[52:55], v[152:155], a[236:239], v[52:55]
	global_load_dwordx4 a[196:199], v8, s[74:75] offset:0
	s_waitcnt lgkmcnt(6)
	v_mfma_f32_16x16x32_bf16 v[56:59], v[156:159], a[232:235], v[56:59]
	ds_read_b128 v[184:187], v21 offset:48128
	v_mfma_f32_16x16x32_bf16 v[60:63], v[156:159], a[236:239], v[60:63]
	s_waitcnt lgkmcnt(6)
	v_mfma_f32_16x16x32_bf16 v[64:67], v[160:163], a[232:235], v[64:67]
	ds_read_b128 v[188:191], v21 offset:48384
	v_mfma_f32_16x16x32_bf16 v[68:71], v[160:163], a[236:239], v[68:71]
	global_load_dwordx4 a[200:203], v8, s[72:73] offset:1024
	s_waitcnt lgkmcnt(6)
	v_mfma_f32_16x16x32_bf16 v[72:75], v[164:167], a[232:235], v[72:75]
	ds_read_b128 v[192:195], v21 offset:49152
	v_mfma_f32_16x16x32_bf16 v[76:79], v[164:167], a[236:239], v[76:79]
	s_waitcnt lgkmcnt(6)
	v_mfma_f32_16x16x32_bf16 v[80:83], v[168:171], a[232:235], v[80:83]
	ds_read_b128 v[196:199], v21 offset:49408
	v_mfma_f32_16x16x32_bf16 v[84:87], v[168:171], a[236:239], v[84:87]
	s_barrier
	s_waitcnt lgkmcnt(6)
	v_mfma_f32_16x16x32_bf16 v[88:91], v[172:175], a[232:235], v[88:91]
	ds_read_b128 v[144:147], v22 offset:0
	v_mfma_f32_16x16x32_bf16 v[92:95], v[172:175], a[236:239], v[92:95]
	global_load_dwordx4 a[204:207], v8, s[74:75] offset:1024
	s_waitcnt lgkmcnt(6)
	v_mfma_f32_16x16x32_bf16 v[96:99], v[176:179], a[232:235], v[96:99]
	ds_read_b128 v[148:151], v22 offset:256
	v_mfma_f32_16x16x32_bf16 v[100:103], v[176:179], a[236:239], v[100:103]
	s_waitcnt lgkmcnt(6)
	v_mfma_f32_16x16x32_bf16 v[104:107], v[180:183], a[232:235], v[104:107]
	ds_read_b128 v[152:155], v22 offset:1024
	v_mfma_f32_16x16x32_bf16 v[108:111], v[180:183], a[236:239], v[108:111]
	global_load_dwordx4 a[208:211], v8, s[72:73] offset:2048
	s_waitcnt lgkmcnt(6)
	v_mfma_f32_16x16x32_bf16 v[112:115], v[184:187], a[232:235], v[112:115]
	ds_read_b128 v[156:159], v22 offset:1280
	v_mfma_f32_16x16x32_bf16 v[116:119], v[184:187], a[236:239], v[116:119]
	s_waitcnt lgkmcnt(6)
	v_mfma_f32_16x16x32_bf16 v[120:123], v[188:191], a[232:235], v[120:123]
	ds_read_b128 v[160:163], v22 offset:2048
	v_mfma_f32_16x16x32_bf16 v[124:127], v[188:191], a[236:239], v[124:127]
	global_load_dwordx4 a[212:215], v8, s[74:75] offset:2048
	s_waitcnt lgkmcnt(6)
	v_mfma_f32_16x16x32_bf16 v[128:131], v[192:195], a[232:235], v[128:131]
	ds_read_b128 v[164:167], v22 offset:2304
	v_mfma_f32_16x16x32_bf16 v[132:135], v[192:195], a[236:239], v[132:135]
	s_waitcnt lgkmcnt(6)
	v_mfma_f32_16x16x32_bf16 v[136:139], v[196:199], a[232:235], v[136:139]
	ds_read_b128 v[168:171], v22 offset:3072
	v_mfma_f32_16x16x32_bf16 v[140:143], v[196:199], a[236:239], v[140:143]
	s_waitcnt vmcnt(17) lgkmcnt(6)
	v_mfma_f32_16x16x32_bf16 v[32:35], v[144:147], a[240:243], v[32:35]
	ds_read_b128 v[172:175], v22 offset:3328
	s_waitcnt vmcnt(14)
	v_mfma_f32_16x16x32_bf16 v[36:39], v[144:147], a[244:247], v[36:39]
	global_load_dwordx4 a[216:219], v8, s[72:73] offset:3072
	s_waitcnt lgkmcnt(6)
	v_mfma_f32_16x16x32_bf16 v[40:43], v[148:151], a[240:243], v[40:43]
	ds_read_b128 v[176:179], v22 offset:4096
	v_mfma_f32_16x16x32_bf16 v[44:47], v[148:151], a[244:247], v[44:47]
	s_waitcnt lgkmcnt(6)
	v_mfma_f32_16x16x32_bf16 v[48:51], v[152:155], a[240:243], v[48:51]
	ds_read_b128 v[180:183], v22 offset:4352
	v_mfma_f32_16x16x32_bf16 v[52:55], v[152:155], a[244:247], v[52:55]
	global_load_dwordx4 a[220:223], v8, s[74:75] offset:3072
	s_waitcnt lgkmcnt(6)
	v_mfma_f32_16x16x32_bf16 v[56:59], v[156:159], a[240:243], v[56:59]
	ds_read_b128 v[184:187], v22 offset:5120
	v_mfma_f32_16x16x32_bf16 v[60:63], v[156:159], a[244:247], v[60:63]
	s_waitcnt lgkmcnt(6)
	v_mfma_f32_16x16x32_bf16 v[64:67], v[160:163], a[240:243], v[64:67]
	ds_read_b128 v[188:191], v22 offset:5376
	v_mfma_f32_16x16x32_bf16 v[68:71], v[160:163], a[244:247], v[68:71]
	s_waitcnt lgkmcnt(6)
	v_mfma_f32_16x16x32_bf16 v[72:75], v[164:167], a[240:243], v[72:75]
	ds_read_b128 v[192:195], v22 offset:6144
	v_mfma_f32_16x16x32_bf16 v[76:79], v[164:167], a[244:247], v[76:79]
	s_waitcnt lgkmcnt(6)
	v_mfma_f32_16x16x32_bf16 v[80:83], v[168:171], a[240:243], v[80:83]
	ds_read_b128 v[196:199], v22 offset:6400
	v_mfma_f32_16x16x32_bf16 v[84:87], v[168:171], a[244:247], v[84:87]
	s_waitcnt lgkmcnt(6)
	v_mfma_f32_16x16x32_bf16 v[88:91], v[172:175], a[240:243], v[88:91]
	ds_read_b128 v[144:147], v22 offset:14336
	v_mfma_f32_16x16x32_bf16 v[92:95], v[172:175], a[244:247], v[92:95]
	s_waitcnt lgkmcnt(6)
	v_mfma_f32_16x16x32_bf16 v[96:99], v[176:179], a[240:243], v[96:99]
	ds_read_b128 v[148:151], v22 offset:14592
	v_mfma_f32_16x16x32_bf16 v[100:103], v[176:179], a[244:247], v[100:103]
	s_waitcnt lgkmcnt(6)
	v_mfma_f32_16x16x32_bf16 v[104:107], v[180:183], a[240:243], v[104:107]
	ds_read_b128 v[152:155], v22 offset:15360
	v_mfma_f32_16x16x32_bf16 v[108:111], v[180:183], a[244:247], v[108:111]
	s_waitcnt lgkmcnt(6)
	v_mfma_f32_16x16x32_bf16 v[112:115], v[184:187], a[240:243], v[112:115]
	ds_read_b128 v[156:159], v22 offset:15616
	v_mfma_f32_16x16x32_bf16 v[116:119], v[184:187], a[244:247], v[116:119]
	s_waitcnt lgkmcnt(6)
	v_mfma_f32_16x16x32_bf16 v[120:123], v[188:191], a[240:243], v[120:123]
	ds_read_b128 v[160:163], v22 offset:16384
	v_mfma_f32_16x16x32_bf16 v[124:127], v[188:191], a[244:247], v[124:127]
	s_waitcnt lgkmcnt(6)
	v_mfma_f32_16x16x32_bf16 v[128:131], v[192:195], a[240:243], v[128:131]
	ds_read_b128 v[164:167], v22 offset:16640
	v_mfma_f32_16x16x32_bf16 v[132:135], v[192:195], a[244:247], v[132:135]
	s_waitcnt lgkmcnt(6)
	v_mfma_f32_16x16x32_bf16 v[136:139], v[196:199], a[240:243], v[136:139]
	ds_read_b128 v[168:171], v22 offset:17408
	v_mfma_f32_16x16x32_bf16 v[140:143], v[196:199], a[244:247], v[140:143]
	s_waitcnt vmcnt(13) lgkmcnt(6)
	v_mfma_f32_16x16x32_bf16 v[32:35], v[144:147], a[248:251], v[32:35]
	ds_read_b128 v[172:175], v22 offset:17664
	s_waitcnt vmcnt(10)
	v_mfma_f32_16x16x32_bf16 v[36:39], v[144:147], a[252:255], v[36:39]
	s_waitcnt lgkmcnt(6)
	v_mfma_f32_16x16x32_bf16 v[40:43], v[148:151], a[248:251], v[40:43]
	ds_read_b128 v[176:179], v22 offset:18432
	v_mfma_f32_16x16x32_bf16 v[44:47], v[148:151], a[252:255], v[44:47]
	s_waitcnt lgkmcnt(6)
	v_mfma_f32_16x16x32_bf16 v[48:51], v[152:155], a[248:251], v[48:51]
	ds_read_b128 v[180:183], v22 offset:18688
	v_mfma_f32_16x16x32_bf16 v[52:55], v[152:155], a[252:255], v[52:55]
	s_waitcnt lgkmcnt(6)
	v_mfma_f32_16x16x32_bf16 v[56:59], v[156:159], a[248:251], v[56:59]
	ds_read_b128 v[184:187], v22 offset:19456
	v_mfma_f32_16x16x32_bf16 v[60:63], v[156:159], a[252:255], v[60:63]
	s_waitcnt lgkmcnt(6)
	v_mfma_f32_16x16x32_bf16 v[64:67], v[160:163], a[248:251], v[64:67]
	ds_read_b128 v[188:191], v22 offset:19712
	v_mfma_f32_16x16x32_bf16 v[68:71], v[160:163], a[252:255], v[68:71]
	s_waitcnt lgkmcnt(6)
	v_mfma_f32_16x16x32_bf16 v[72:75], v[164:167], a[248:251], v[72:75]
	ds_read_b128 v[192:195], v22 offset:20480
	v_mfma_f32_16x16x32_bf16 v[76:79], v[164:167], a[252:255], v[76:79]
	s_waitcnt lgkmcnt(6)
	v_mfma_f32_16x16x32_bf16 v[80:83], v[168:171], a[248:251], v[80:83]
	ds_read_b128 v[196:199], v22 offset:20736
	v_mfma_f32_16x16x32_bf16 v[84:87], v[168:171], a[252:255], v[84:87]
	s_waitcnt lgkmcnt(6)
	v_mfma_f32_16x16x32_bf16 v[88:91], v[172:175], a[248:251], v[88:91]
	v_mfma_f32_16x16x32_bf16 v[92:95], v[172:175], a[252:255], v[92:95]
	s_waitcnt lgkmcnt(5)
	v_mfma_f32_16x16x32_bf16 v[96:99], v[176:179], a[248:251], v[96:99]
	v_mfma_f32_16x16x32_bf16 v[100:103], v[176:179], a[252:255], v[100:103]
	s_waitcnt lgkmcnt(4)
	v_mfma_f32_16x16x32_bf16 v[104:107], v[180:183], a[248:251], v[104:107]
	v_mfma_f32_16x16x32_bf16 v[108:111], v[180:183], a[252:255], v[108:111]
	s_waitcnt lgkmcnt(3)
	v_mfma_f32_16x16x32_bf16 v[112:115], v[184:187], a[248:251], v[112:115]
	v_mfma_f32_16x16x32_bf16 v[116:119], v[184:187], a[252:255], v[116:119]
	s_waitcnt lgkmcnt(2)
	v_mfma_f32_16x16x32_bf16 v[120:123], v[188:191], a[248:251], v[120:123]
	v_mfma_f32_16x16x32_bf16 v[124:127], v[188:191], a[252:255], v[124:127]
	s_waitcnt lgkmcnt(1)
	v_mfma_f32_16x16x32_bf16 v[128:131], v[192:195], a[248:251], v[128:131]
	v_mfma_f32_16x16x32_bf16 v[132:135], v[192:195], a[252:255], v[132:135]
	s_waitcnt lgkmcnt(0)
	v_mfma_f32_16x16x32_bf16 v[136:139], v[196:199], a[248:251], v[136:139]
	v_mfma_f32_16x16x32_bf16 v[140:143], v[196:199], a[252:255], v[140:143]
	s_mul_i32 s46, s22, 2359296
	s_mul_i32 s47, s24, 114688
	s_add_u32 s46, s46, s47
	s_mul_i32 s47, s23, 7168
	s_add_u32 s46, s46, s47
	s_add_u32 s46, s46, 11272192
	s_add_u32 s30, s20, s46
	s_addc_u32 s31, s21, 0
	v_mfma_f32_16x16x32_bf16 v[32:35], v[218:221], v[204:207], v[32:35]
	v_mfma_f32_16x16x32_bf16 v[36:39], v[218:221], v[208:211], v[36:39]
	v_mfma_f32_16x16x32_bf16 v[40:43], v[218:221], v[210:213], v[40:43]
	v_mfma_f32_16x16x32_bf16 v[44:47], v[218:221], v[206:209], v[44:47]
	v_mfma_f32_16x16x32_bf16 v[48:51], v[222:225], v[204:207], v[48:51]
	v_mfma_f32_16x16x32_bf16 v[52:55], v[222:225], v[208:211], v[52:55]
	v_mfma_f32_16x16x32_bf16 v[56:59], v[222:225], v[210:213], v[56:59]
	v_mfma_f32_16x16x32_bf16 v[60:63], v[222:225], v[206:209], v[60:63]
	v_mfma_f32_16x16x32_bf16 v[64:67], v[226:229], v[204:207], v[64:67]
	s_nop 5
	v_pk_mul_f32 v[32:33], v[32:33], v[40:41]
	v_mfma_f32_16x16x32_bf16 v[68:71], v[226:229], v[208:211], v[68:71]
	v_pk_mul_f32 v[34:35], v[34:35], v[42:43]
	v_pk_mul_f32 v[36:37], v[36:37], v[44:45]
	v_pk_mul_f32 v[38:39], v[38:39], v[46:47]
	v_pk_mul_f32 v[32:33], v[32:33], v[216:217] op_sel_hi:[1,0]
	v_mfma_f32_16x16x32_bf16 v[72:75], v[226:229], v[210:213], v[72:75]
	v_pk_mul_f32 v[34:35], v[34:35], v[216:217] op_sel_hi:[1,0]
	v_pk_mul_f32 v[36:37], v[36:37], v[246:247] op_sel_hi:[1,0]
	v_pk_mul_f32 v[38:39], v[38:39], v[246:247] op_sel_hi:[1,0]
	v_cvt_pk_bf16_f32 v144, v32, v33
	v_mfma_f32_16x16x32_bf16 v[76:79], v[226:229], v[206:209], v[76:79]
	v_cvt_pk_bf16_f32 v146, v36, v37
	v_cvt_pk_bf16_f32 v145, v34, v35
	v_cvt_pk_bf16_f32 v147, v38, v39
	v_mfma_f32_16x16x32_bf16 v[80:83], v[230:233], v[204:207], v[80:83]
	v_permlane32_swap_b32 v144, v146
	v_permlane32_swap_b32 v145, v147
	global_store_dwordx4 v24, v[144:147], s[30:31] offset:0 sc1
	v_pk_mul_f32 v[48:49], v[48:49], v[56:57]
	v_mfma_f32_16x16x32_bf16 v[84:87], v[230:233], v[208:211], v[84:87]
	v_pk_mul_f32 v[50:51], v[50:51], v[58:59]
	v_pk_mul_f32 v[52:53], v[52:53], v[60:61]
	v_pk_mul_f32 v[54:55], v[54:55], v[62:63]
	v_pk_mul_f32 v[48:49], v[48:49], v[216:217] op_sel_hi:[1,0]
	v_mfma_f32_16x16x32_bf16 v[88:91], v[230:233], v[210:213], v[88:91]
	v_pk_mul_f32 v[50:51], v[50:51], v[216:217] op_sel_hi:[1,0]
	v_pk_mul_f32 v[52:53], v[52:53], v[246:247] op_sel_hi:[1,0]
	v_pk_mul_f32 v[54:55], v[54:55], v[246:247] op_sel_hi:[1,0]
	v_cvt_pk_bf16_f32 v148, v48, v49
	v_mfma_f32_16x16x32_bf16 v[92:95], v[230:233], v[206:209], v[92:95]
	v_cvt_pk_bf16_f32 v150, v52, v53
	v_cvt_pk_bf16_f32 v149, v50, v51
	v_cvt_pk_bf16_f32 v151, v54, v55
	v_mfma_f32_16x16x32_bf16 v[96:99], v[234:237], v[204:207], v[96:99]
	v_permlane32_swap_b32 v148, v150
	v_permlane32_swap_b32 v149, v151
	global_store_dwordx4 v24, v[148:151], s[30:31] offset:1024 sc1
	v_pk_mul_f32 v[64:65], v[64:65], v[72:73]
	v_mfma_f32_16x16x32_bf16 v[100:103], v[234:237], v[208:211], v[100:103]
	v_pk_mul_f32 v[66:67], v[66:67], v[74:75]
	v_pk_mul_f32 v[68:69], v[68:69], v[76:77]
	v_pk_mul_f32 v[70:71], v[70:71], v[78:79]
	v_pk_mul_f32 v[64:65], v[64:65], v[216:217] op_sel_hi:[1,0]
	v_mfma_f32_16x16x32_bf16 v[104:107], v[234:237], v[210:213], v[104:107]
	v_pk_mul_f32 v[66:67], v[66:67], v[216:217] op_sel_hi:[1,0]
	v_pk_mul_f32 v[68:69], v[68:69], v[246:247] op_sel_hi:[1,0]
	v_pk_mul_f32 v[70:71], v[70:71], v[246:247] op_sel_hi:[1,0]
	v_cvt_pk_bf16_f32 v152, v64, v65
	v_mfma_f32_16x16x32_bf16 v[108:111], v[234:237], v[206:209], v[108:111]
	v_cvt_pk_bf16_f32 v154, v68, v69
	v_cvt_pk_bf16_f32 v153, v66, v67
	v_cvt_pk_bf16_f32 v155, v70, v71
	v_mfma_f32_16x16x32_bf16 v[112:115], v[238:241], v[204:207], v[112:115]
	v_permlane32_swap_b32 v152, v154
	v_permlane32_swap_b32 v153, v155
	global_store_dwordx4 v24, v[152:155], s[30:31] offset:2048 sc1
	v_pk_mul_f32 v[80:81], v[80:81], v[88:89]
	v_mfma_f32_16x16x32_bf16 v[116:119], v[238:241], v[208:211], v[116:119]
	v_pk_mul_f32 v[82:83], v[82:83], v[90:91]
	v_pk_mul_f32 v[84:85], v[84:85], v[92:93]
	v_pk_mul_f32 v[86:87], v[86:87], v[94:95]
	v_pk_mul_f32 v[80:81], v[80:81], v[216:217] op_sel_hi:[1,0]
	v_mfma_f32_16x16x32_bf16 v[120:123], v[238:241], v[210:213], v[120:123]
	v_pk_mul_f32 v[82:83], v[82:83], v[216:217] op_sel_hi:[1,0]
	v_pk_mul_f32 v[84:85], v[84:85], v[246:247] op_sel_hi:[1,0]
	v_pk_mul_f32 v[86:87], v[86:87], v[246:247] op_sel_hi:[1,0]
	v_cvt_pk_bf16_f32 v156, v80, v81
	v_mfma_f32_16x16x32_bf16 v[124:127], v[238:241], v[206:209], v[124:127]
	v_cvt_pk_bf16_f32 v158, v84, v85
	v_cvt_pk_bf16_f32 v157, v82, v83
	v_cvt_pk_bf16_f32 v159, v86, v87
	v_mfma_f32_16x16x32_bf16 v[128:131], v[242:245], v[204:207], v[128:131]
	v_permlane32_swap_b32 v156, v158
	v_permlane32_swap_b32 v157, v159
	global_store_dwordx4 v24, v[156:159], s[30:31] offset:3072 sc1
	v_pk_mul_f32 v[96:97], v[96:97], v[104:105]
	v_mfma_f32_16x16x32_bf16 v[132:135], v[242:245], v[208:211], v[132:135]
	v_pk_mul_f32 v[98:99], v[98:99], v[106:107]
	v_pk_mul_f32 v[100:101], v[100:101], v[108:109]
	v_pk_mul_f32 v[102:103], v[102:103], v[110:111]
	v_pk_mul_f32 v[96:97], v[96:97], v[216:217] op_sel_hi:[1,0]
	v_mfma_f32_16x16x32_bf16 v[136:139], v[242:245], v[210:213], v[136:139]
	v_pk_mul_f32 v[98:99], v[98:99], v[216:217] op_sel_hi:[1,0]
	v_pk_mul_f32 v[100:101], v[100:101], v[246:247] op_sel_hi:[1,0]
	v_pk_mul_f32 v[102:103], v[102:103], v[246:247] op_sel_hi:[1,0]
	v_cvt_pk_bf16_f32 v160, v96, v97
	v_mfma_f32_16x16x32_bf16 v[140:143], v[242:245], v[206:209], v[140:143]
	v_cvt_pk_bf16_f32 v162, v100, v101
	v_cvt_pk_bf16_f32 v161, v98, v99
	v_cvt_pk_bf16_f32 v163, v102, v103
	v_permlane32_swap_b32 v160, v162
	s_nop 0
	v_permlane32_swap_b32 v161, v163
	global_store_dwordx4 v25, v[160:163], s[30:31] offset:0 sc1
	v_pk_mul_f32 v[112:113], v[112:113], v[120:121]
	v_pk_mul_f32 v[114:115], v[114:115], v[122:123]
	v_pk_mul_f32 v[116:117], v[116:117], v[124:125]
	v_pk_mul_f32 v[118:119], v[118:119], v[126:127]
	v_pk_mul_f32 v[112:113], v[112:113], v[216:217] op_sel_hi:[1,0]
	v_pk_mul_f32 v[114:115], v[114:115], v[216:217] op_sel_hi:[1,0]
	v_pk_mul_f32 v[116:117], v[116:117], v[246:247] op_sel_hi:[1,0]
	v_pk_mul_f32 v[118:119], v[118:119], v[246:247] op_sel_hi:[1,0]
	v_cvt_pk_bf16_f32 v164, v112, v113
	v_cvt_pk_bf16_f32 v166, v116, v117
	v_cvt_pk_bf16_f32 v165, v114, v115
	v_cvt_pk_bf16_f32 v167, v118, v119
	v_permlane32_swap_b32 v164, v166
	s_nop 0
	v_permlane32_swap_b32 v165, v167
	global_store_dwordx4 v25, v[164:167], s[30:31] offset:1024 sc1
	v_pk_mul_f32 v[128:129], v[128:129], v[136:137]
	v_pk_mul_f32 v[130:131], v[130:131], v[138:139]
	v_pk_mul_f32 v[132:133], v[132:133], v[140:141]
	v_pk_mul_f32 v[134:135], v[134:135], v[142:143]
	v_pk_mul_f32 v[128:129], v[128:129], v[216:217] op_sel_hi:[1,0]
	v_pk_mul_f32 v[130:131], v[130:131], v[216:217] op_sel_hi:[1,0]
	v_pk_mul_f32 v[132:133], v[132:133], v[246:247] op_sel_hi:[1,0]
	v_pk_mul_f32 v[134:135], v[134:135], v[246:247] op_sel_hi:[1,0]
	v_cvt_pk_bf16_f32 v168, v128, v129
	v_cvt_pk_bf16_f32 v170, v132, v133
	v_cvt_pk_bf16_f32 v169, v130, v131
	v_cvt_pk_bf16_f32 v171, v134, v135
	v_permlane32_swap_b32 v168, v170
	s_nop 0
	v_permlane32_swap_b32 v169, v171
	global_store_dwordx4 v25, v[168:171], s[30:31] offset:2048 sc1
	s_lshl_b32 s46, s22, 8
	s_lshl_b32 s47, s23, 4
	s_add_u32 s46, s46, s47
	s_lshl_b32 s47, s24, 2
	s_add_u32 s46, s46, s47
	s_add_u32 s46, s46, 36864
	s_add_u32 s38, s20, s46
	s_addc_u32 s39, s21, 0
	s_waitcnt vmcnt(0) lgkmcnt(0)
	v_mov_b32 v28, s51
	v_mov_b32 v29, 0
	s_mov_b64 exec, 1
	s_cmp_eq_u32 s25, 1
	s_cbranch_scc1 L_alt_84
	global_store_dword v29, v28, s[38:39] sc1
	s_branch L_join_85
L_alt_84:
	global_store_dword v29, v28, s[38:39]
L_join_85:
	s_mov_b64 exec, -1
	v_lshlrev_b32 v32, 16, v10
	v_and_b32 v33, 0xffff0000, v10
	v_lshlrev_b32 v34, 16, v11
	v_and_b32 v35, 0xffff0000, v11
	v_lshlrev_b32 v36, 16, v12
	v_and_b32 v37, 0xffff0000, v12
	v_lshlrev_b32 v38, 16, v13
	v_and_b32 v39, 0xffff0000, v13
	v_lshlrev_b32 v40, 16, v14
	v_and_b32 v41, 0xffff0000, v14
	v_lshlrev_b32 v42, 16, v15
	v_and_b32 v43, 0xffff0000, v15
	v_lshlrev_b32 v44, 16, v16
	v_and_b32 v45, 0xffff0000, v16
	v_lshlrev_b32 v46, 16, v17
	v_and_b32 v47, 0xffff0000, v17
	s_xor_b32 s40, s70, 0
	s_mul_i32 s46, s22, 2359296
	s_mul_i32 s47, s40, 114688
	s_add_u32 s46, s46, s47
	s_mul_i32 s47, s24, 28672
	s_add_u32 s46, s46, s47
	s_add_u32 s46, s46, 11272192
	s_add_u32 s30, s20, s46
	s_addc_u32 s31, s21, 0
	s_xor_b32 s40, s70, 1
	s_mul_i32 s46, s22, 2359296
	s_mul_i32 s47, s40, 114688
	s_add_u32 s46, s46, s47
	s_mul_i32 s47, s24, 28672
	s_add_u32 s46, s46, s47
	s_add_u32 s46, s46, 11272192
	s_add_u32 s32, s20, s46
	s_addc_u32 s33, s21, 0
	s_lshl_b32 s46, s22, 8
	s_add_u32 s46, s46, 36864
	s_add_u32 s38, s20, s46
	s_addc_u32 s39, s21, 0
	s_mov_b32 s49, 0
	s_nop 1
L_poll_86:
	global_load_dword v28, v1, s[38:39] sc1
	s_waitcnt vmcnt(0)
	v_cmp_ne_u32 vcc, s51, v28
	s_nop 4
	s_cbranch_vccz L_pollout_87
	s_add_u32 s49, s49, 1
	s_cmp_ge_u32 s49, s26
	s_cbranch_scc0 L_poll_86
	s_mov_b32 s26, 1
L_pollout_87:
	global_load_dwordx4 v[96:99], v2, s[30:31] offset:0
	global_load_dwordx4 v[100:103], v2, s[32:33] offset:0
	global_load_dwordx4 v[104:107], v2, s[30:31] offset:1024
	global_load_dwordx4 v[108:111], v2, s[32:33] offset:1024
	global_load_dwordx4 v[112:115], v2, s[30:31] offset:2048
	global_load_dwordx4 v[116:119], v2, s[32:33] offset:2048
	global_load_dwordx4 v[120:123], v2, s[30:31] offset:3072
	global_load_dwordx4 v[124:127], v2, s[32:33] offset:3072
	global_load_dwordx4 v[128:131], v3, s[30:31] offset:0
	global_load_dwordx4 v[132:135], v3, s[32:33] offset:0
	s_waitcnt vmcnt(9)
	v_mfma_f32_32x32x16_bf16 v[32:47], a[0:3], v[96:99], v[32:47]
	global_load_dwordx4 v[136:139], v3, s[30:31] offset:1024
	s_waitcnt vmcnt(9)
	v_mfma_f32_32x32x16_bf16 v[48:63], a[0:3], v[100:103], 0
	v_mfma_f32_32x32x16_bf16 v[64:79], a[4:7], v[96:99], 0
	global_load_dwordx4 v[140:143], v3, s[32:33] offset:1024
	v_mfma_f32_32x32x16_bf16 v[80:95], a[4:7], v[100:103], 0
	s_waitcnt vmcnt(9)
	v_mfma_f32_32x32x16_bf16 v[32:47], a[8:11], v[104:107], v[32:47]
	global_load_dwordx4 v[144:147], v3, s[30:31] offset:2048
	s_waitcnt vmcnt(9)
	v_mfma_f32_32x32x16_bf16 v[48:63], a[8:11], v[108:111], v[48:63]
	v_mfma_f32_32x32x16_bf16 v[64:79], a[12:15], v[104:107], v[64:79]
	global_load_dwordx4 v[148:151], v3, s[32:33] offset:2048
	v_mfma_f32_32x32x16_bf16 v[80:95], a[12:15], v[108:111], v[80:95]
	s_waitcnt vmcnt(9)
	v_mfma_f32_32x32x16_bf16 v[32:47], a[16:19], v[112:115], v[32:47]
	global_load_dwordx4 v[152:155], v3, s[30:31] offset:3072
	s_waitcnt vmcnt(9)
	v_mfma_f32_32x32x16_bf16 v[48:63], a[16:19], v[116:119], v[48:63]
	v_mfma_f32_32x32x16_bf16 v[64:79], a[20:23], v[112:115], v[64:79]
	global_load_dwordx4 v[156:159], v3, s[32:33] offset:3072
	v_mfma_f32_32x32x16_bf16 v[80:95], a[20:23], v[116:119], v[80:95]
	s_waitcnt vmcnt(9)
	v_mfma_f32_32x32x16_bf16 v[32:47], a[24:27], v[120:123], v[32:47]
	global_load_dwordx4 v[160:163], v4, s[30:31] offset:0
	s_waitcnt vmcnt(9)
	v_mfma_f32_32x32x16_bf16 v[48:63], a[24:27], v[124:127], v[48:63]
	v_mfma_f32_32x32x16_bf16 v[64:79], a[28:31], v[120:123], v[64:79]
	global_load_dwordx4 v[164:167], v4, s[32:33] offset:0
	v_mfma_f32_32x32x16_bf16 v[80:95], a[28:31], v[124:127], v[80:95]
	s_waitcnt vmcnt(9)
	v_mfma_f32_32x32x16_bf16 v[32:47], a[32:35], v[128:131], v[32:47]
	global_load_dwordx4 v[168:171], v4, s[30:31] offset:1024
	s_waitcnt vmcnt(9)
	v_mfma_f32_32x32x16_bf16 v[48:63], a[32:35], v[132:135], v[48:63]
	v_mfma_f32_32x32x16_bf16 v[64:79], a[36:39], v[128:131], v[64:79]
	global_load_dwordx4 v[172:175], v4, s[32:33] offset:1024
	v_mfma_f32_32x32x16_bf16 v[80:95], a[36:39], v[132:135], v[80:95]
	s_waitcnt vmcnt(9)
	v_mfma_f32_32x32x16_bf16 v[32:47], a[40:43], v[136:139], v[32:47]
	global_load_dwordx4 v[176:179], v4, s[30:31] offset:2048
	s_waitcnt vmcnt(9)
	v_mfma_f32_32x32x16_bf16 v[48:63], a[40:43], v[140:143], v[48:63]
	v_mfma_f32_32x32x16_bf16 v[64:79], a[44:47], v[136:139], v[64:79]
	global_load_dwordx4 v[180:183], v4, s[32:33] offset:2048
	v_mfma_f32_32x32x16_bf16 v[80:95], a[44:47], v[140:143], v[80:95]
	s_waitcnt vmcnt(9)
	v_mfma_f32_32x32x16_bf16 v[32:47], a[48:51], v[144:147], v[32:47]
	global_load_dwordx4 v[184:187], v4, s[30:31] offset:3072
	s_waitcnt vmcnt(9)
	v_mfma_f32_32x32x16_bf16 v[48:63], a[48:51], v[148:151], v[48:63]
	v_mfma_f32_32x32x16_bf16 v[64:79], a[52:55], v[144:147], v[64:79]
	global_load_dwordx4 v[188:191], v4, s[32:33] offset:3072
	v_mfma_f32_32x32x16_bf16 v[80:95], a[52:55], v[148:151], v[80:95]
	s_waitcnt vmcnt(9)
	v_mfma_f32_32x32x16_bf16 v[32:47], a[56:59], v[152:155], v[32:47]
	global_load_dwordx4 v[192:195], v5, s[30:31] offset:0
	s_waitcnt vmcnt(9)
	v_mfma_f32_32x32x16_bf16 v[48:63], a[56:59], v[156:159], v[48:63]
	v_mfma_f32_32x32x16_bf16 v[64:79], a[60:63], v[152:155], v[64:79]
	global_load_dwordx4 v[196:199], v5, s[32:33] offset:0
	v_mfma_f32_32x32x16_bf16 v[80:95], a[60:63], v[156:159], v[80:95]
	s_waitcnt vmcnt(9)
	v_mfma_f32_32x32x16_bf16 v[32:47], a[64:67], v[160:163], v[32:47]
	global_load_dwordx4 v[200:203], v5, s[30:31] offset:1024
	s_waitcnt vmcnt(9)
	v_mfma_f32_32x32x16_bf16 v[48:63], a[64:67], v[164:167], v[48:63]
	v_mfma_f32_32x32x16_bf16 v[64:79], a[68:71], v[160:163], v[64:79]
	global_load_dwordx4 v[204:207], v5, s[32:33] offset:1024
	v_mfma_f32_32x32x16_bf16 v[80:95], a[68:71], v[164:167], v[80:95]
	s_waitcnt vmcnt(9)
	v_mfma_f32_32x32x16_bf16 v[32:47], a[72:75], v[168:171], v[32:47]
	global_load_dwordx4 v[208:211], v5, s[30:31] offset:2048
	s_waitcnt vmcnt(9)
	v_mfma_f32_32x32x16_bf16 v[48:63], a[72:75], v[172:175], v[48:63]
	v_mfma_f32_32x32x16_bf16 v[64:79], a[76:79], v[168:171], v[64:79]
	global_load_dwordx4 v[212:215], v5, s[32:33] offset:2048
	v_mfma_f32_32x32x16_bf16 v[80:95], a[76:79], v[172:175], v[80:95]
	s_waitcnt vmcnt(9)
	v_mfma_f32_32x32x16_bf16 v[32:47], a[80:83], v[176:179], v[32:47]
	global_load_dwordx4 v[216:219], v5, s[30:31] offset:3072
	s_waitcnt vmcnt(9)
	v_mfma_f32_32x32x16_bf16 v[48:63], a[80:83], v[180:183], v[48:63]
	v_mfma_f32_32x32x16_bf16 v[64:79], a[84:87], v[176:179], v[64:79]
	global_load_dwordx4 v[220:223], v5, s[32:33] offset:3072
	v_mfma_f32_32x32x16_bf16 v[80:95], a[84:87], v[180:183], v[80:95]
	s_waitcnt vmcnt(9)
	v_mfma_f32_32x32x16_bf16 v[32:47], a[88:91], v[184:187], v[32:47]
	global_load_dwordx4 v[224:227], v6, s[30:31] offset:0
	s_waitcnt vmcnt(9)
	v_mfma_f32_32x32x16_bf16 v[48:63], a[88:91], v[188:191], v[48:63]
	v_mfma_f32_32x32x16_bf16 v[64:79], a[92:95], v[184:187], v[64:79]
	global_load_dwordx4 v[228:231], v6, s[32:33] offset:0
	v_mfma_f32_32x32x16_bf16 v[80:95], a[92:95], v[188:191], v[80:95]
	s_waitcnt vmcnt(9)
	v_mfma_f32_32x32x16_bf16 v[32:47], a[96:99], v[192:195], v[32:47]
	global_load_dwordx4 v[232:235], v6, s[30:31] offset:1024
	s_waitcnt vmcnt(9)
	v_mfma_f32_32x32x16_bf16 v[48:63], a[96:99], v[196:199], v[48:63]
	v_mfma_f32_32x32x16_bf16 v[64:79], a[100:103], v[192:195], v[64:79]
	global_load_dwordx4 v[236:239], v6, s[32:33] offset:1024
	v_mfma_f32_32x32x16_bf16 v[80:95], a[100:103], v[196:199], v[80:95]
	s_waitcnt vmcnt(9)
	v_mfma_f32_32x32x16_bf16 v[32:47], a[104:107], v[200:203], v[32:47]
	global_load_dwordx4 v[240:243], v6, s[30:31] offset:2048
	s_waitcnt vmcnt(9)
	v_mfma_f32_32x32x16_bf16 v[48:63], a[104:107], v[204:207], v[48:63]
	v_mfma_f32_32x32x16_bf16 v[64:79], a[108:111], v[200:203], v[64:79]
	global_load_dwordx4 v[244:247], v6, s[32:33] offset:2048
	v_mfma_f32_32x32x16_bf16 v[80:95], a[108:111], v[204:207], v[80:95]
	s_waitcnt vmcnt(9)
	v_mfma_f32_32x32x16_bf16 v[32:47], a[112:115], v[208:211], v[32:47]
	global_load_dwordx4 v[248:251], v6, s[30:31] offset:3072
	s_waitcnt vmcnt(9)
	v_mfma_f32_32x32x16_bf16 v[48:63], a[112:115], v[212:215], v[48:63]
	v_mfma_f32_32x32x16_bf16 v[64:79], a[116:119], v[208:211], v[64:79]
	global_load_dwordx4 v[252:255], v6, s[32:33] offset:3072
	v_mfma_f32_32x32x16_bf16 v[80:95], a[116:119], v[212:215], v[80:95]
	s_waitcnt vmcnt(9)
	v_mfma_f32_32x32x16_bf16 v[32:47], a[120:123], v[216:219], v[32:47]
	global_load_dwordx4 v[96:99], v7, s[30:31] offset:0
	s_waitcnt vmcnt(9)
	v_mfma_f32_32x32x16_bf16 v[48:63], a[120:123], v[220:223], v[48:63]
	v_mfma_f32_32x32x16_bf16 v[64:79], a[124:127], v[216:219], v[64:79]
	global_load_dwordx4 v[100:103], v7, s[32:33] offset:0
	v_mfma_f32_32x32x16_bf16 v[80:95], a[124:127], v[220:223], v[80:95]
	s_waitcnt vmcnt(9)
	v_mfma_f32_32x32x16_bf16 v[32:47], a[128:131], v[224:227], v[32:47]
	global_load_dwordx4 v[104:107], v7, s[30:31] offset:1024
	s_waitcnt vmcnt(9)
	v_mfma_f32_32x32x16_bf16 v[48:63], a[128:131], v[228:231], v[48:63]
	v_mfma_f32_32x32x16_bf16 v[64:79], a[132:135], v[224:227], v[64:79]
	global_load_dwordx4 v[108:111], v7, s[32:33] offset:1024
	v_mfma_f32_32x32x16_bf16 v[80:95], a[132:135], v[228:231], v[80:95]
	s_waitcnt vmcnt(9)
	v_mfma_f32_32x32x16_bf16 v[32:47], a[136:139], v[232:235], v[32:47]
	global_load_dwordx4 v[112:115], v7, s[30:31] offset:2048
	s_waitcnt vmcnt(9)
	v_mfma_f32_32x32x16_bf16 v[48:63], a[136:139], v[236:239], v[48:63]
	v_mfma_f32_32x32x16_bf16 v[64:79], a[140:143], v[232:235], v[64:79]
	global_load_dwordx4 v[116:119], v7, s[32:33] offset:2048
	v_mfma_f32_32x32x16_bf16 v[80:95], a[140:143], v[236:239], v[80:95]
	s_waitcnt vmcnt(9)
	v_mfma_f32_32x32x16_bf16 v[32:47], a[144:147], v[240:243], v[32:47]
	global_load_dwordx4 v[120:123], v7, s[30:31] offset:3072
	s_waitcnt vmcnt(9)
	v_mfma_f32_32x32x16_bf16 v[48:63], a[144:147], v[244:247], v[48:63]
	v_mfma_f32_32x32x16_bf16 v[64:79], a[148:151], v[240:243], v[64:79]
	global_load_dwordx4 v[124:127], v7, s[32:33] offset:3072
	v_mfma_f32_32x32x16_bf16 v[80:95], a[148:151], v[244:247], v[80:95]
	s_waitcnt vmcnt(9)
	v_mfma_f32_32x32x16_bf16 v[32:47], a[152:155], v[248:251], v[32:47]
	global_load_dwordx4 v[128:131], v8, s[30:31] offset:0
	s_waitcnt vmcnt(9)
	v_mfma_f32_32x32x16_bf16 v[48:63], a[152:155], v[252:255], v[48:63]
	v_mfma_f32_32x32x16_bf16 v[64:79], a[156:159], v[248:251], v[64:79]
	global_load_dwordx4 v[132:135], v8, s[32:33] offset:0
	v_mfma_f32_32x32x16_bf16 v[80:95], a[156:159], v[252:255], v[80:95]
	s_waitcnt vmcnt(9)
	v_mfma_f32_32x32x16_bf16 v[32:47], a[160:163], v[96:99], v[32:47]
	global_load_dwordx4 v[136:139], v8, s[30:31] offset:1024
	s_waitcnt vmcnt(9)
	v_mfma_f32_32x32x16_bf16 v[48:63], a[160:163], v[100:103], v[48:63]
	v_mfma_f32_32x32x16_bf16 v[64:79], a[164:167], v[96:99], v[64:79]
	global_load_dwordx4 v[140:143], v8, s[32:33] offset:1024
	v_mfma_f32_32x32x16_bf16 v[80:95], a[164:167], v[100:103], v[80:95]
	s_waitcnt vmcnt(9)
	v_mfma_f32_32x32x16_bf16 v[32:47], a[168:171], v[104:107], v[32:47]
	global_load_dwordx4 v[144:147], v8, s[30:31] offset:2048
	s_waitcnt vmcnt(9)
	v_mfma_f32_32x32x16_bf16 v[48:63], a[168:171], v[108:111], v[48:63]
	v_mfma_f32_32x32x16_bf16 v[64:79], a[172:175], v[104:107], v[64:79]
	global_load_dwordx4 v[148:151], v8, s[32:33] offset:2048
	v_mfma_f32_32x32x16_bf16 v[80:95], a[172:175], v[108:111], v[80:95]
	s_waitcnt vmcnt(9)
	v_mfma_f32_32x32x16_bf16 v[32:47], a[176:179], v[112:115], v[32:47]
	global_load_dwordx4 v[152:155], v8, s[30:31] offset:3072
	s_waitcnt vmcnt(9)
	v_mfma_f32_32x32x16_bf16 v[48:63], a[176:179], v[116:119], v[48:63]
	v_mfma_f32_32x32x16_bf16 v[64:79], a[180:183], v[112:115], v[64:79]
	global_load_dwordx4 v[156:159], v8, s[32:33] offset:3072
	v_mfma_f32_32x32x16_bf16 v[80:95], a[180:183], v[116:119], v[80:95]
	s_waitcnt vmcnt(9)
	v_mfma_f32_32x32x16_bf16 v[32:47], a[184:187], v[120:123], v[32:47]
	s_waitcnt vmcnt(8)
	v_mfma_f32_32x32x16_bf16 v[48:63], a[184:187], v[124:127], v[48:63]
	v_mfma_f32_32x32x16_bf16 v[64:79], a[188:191], v[120:123], v[64:79]
	v_mfma_f32_32x32x16_bf16 v[80:95], a[188:191], v[124:127], v[80:95]
	s_waitcnt vmcnt(7)
	v_mfma_f32_32x32x16_bf16 v[32:47], a[192:195], v[128:131], v[32:47]
	s_waitcnt vmcnt(6)
	v_mfma_f32_32x32x16_bf16 v[48:63], a[192:195], v[132:135], v[48:63]
	v_mfma_f32_32x32x16_bf16 v[64:79], a[196:199], v[128:131], v[64:79]
	v_mfma_f32_32x32x16_bf16 v[80:95], a[196:199], v[132:135], v[80:95]
	s_waitcnt vmcnt(5)
	v_mfma_f32_32x32x16_bf16 v[32:47], a[200:203], v[136:139], v[32:47]
	s_waitcnt vmcnt(4)
	v_mfma_f32_32x32x16_bf16 v[48:63], a[200:203], v[140:143], v[48:63]
	v_mfma_f32_32x32x16_bf16 v[64:79], a[204:207], v[136:139], v[64:79]
	v_mfma_f32_32x32x16_bf16 v[80:95], a[204:207], v[140:143], v[80:95]
	s_waitcnt vmcnt(3)
	v_mfma_f32_32x32x16_bf16 v[32:47], a[208:211], v[144:147], v[32:47]
	s_waitcnt vmcnt(2)
	v_mfma_f32_32x32x16_bf16 v[48:63], a[208:211], v[148:151], v[48:63]
	v_mfma_f32_32x32x16_bf16 v[64:79], a[212:215], v[144:147], v[64:79]
	v_mfma_f32_32x32x16_bf16 v[80:95], a[212:215], v[148:151], v[80:95]
	s_waitcnt vmcnt(1)
	v_mfma_f32_32x32x16_bf16 v[32:47], a[216:219], v[152:155], v[32:47]
	s_waitcnt vmcnt(0)
	v_mfma_f32_32x32x16_bf16 v[48:63], a[216:219], v[156:159], v[48:63]
	v_mfma_f32_32x32x16_bf16 v[64:79], a[220:223], v[152:155], v[64:79]
	v_mfma_f32_32x32x16_bf16 v[80:95], a[220:223], v[156:159], v[80:95]
	s_xor_b32 s40, s24, 1
	s_mul_i32 s40, s40, 12288
	s_add_u32 s40, s40, 114688
	v_add_u32 v21, s40, v2
	s_xor_b32 s40, s24, 2
	s_mul_i32 s40, s40, 12288
	s_add_u32 s40, s40, 118784
	v_add_u32 v22, s40, v2
	s_xor_b32 s40, s24, 3
	s_mul_i32 s40, s40, 12288
	s_add_u32 s40, s40, 122880
	v_add_u32 v23, s40, v2
	ds_write_b128 v21, v[48:51] offset:0
	ds_write_b128 v21, v[52:55] offset:1024
	ds_write_b128 v21, v[56:59] offset:2048
	ds_write_b128 v21, v[60:63] offset:3072
	ds_write_b128 v22, v[64:67] offset:0
	ds_write_b128 v22, v[68:71] offset:1024
	ds_write_b128 v22, v[72:75] offset:2048
	ds_write_b128 v22, v[76:79] offset:3072
	ds_write_b128 v23, v[80:83] offset:0
	ds_write_b128 v23, v[84:87] offset:1024
	ds_write_b128 v23, v[88:91] offset:2048
	ds_write_b128 v23, v[92:95] offset:3072
	s_mul_i32 s40, s24, 12288
	s_add_u32 s40, s40, 114688
	v_add_u32 v20, s40, v2
	s_waitcnt lgkmcnt(0)
	s_barrier
	ds_read_b128 v[96:99], v20 offset:0
	ds_read_b128 v[100:103], v20 offset:1024
	ds_read_b128 v[104:107], v20 offset:2048
	ds_read_b128 v[108:111], v20 offset:3072
	ds_read_b128 v[112:115], v20 offset:4096
	ds_read_b128 v[116:119], v20 offset:5120
	ds_read_b128 v[120:123], v20 offset:6144
	ds_read_b128 v[124:127], v20 offset:7168
	ds_read_b128 v[128:131], v20 offset:8192
	ds_read_b128 v[132:135], v20 offset:9216
	ds_read_b128 v[136:139], v20 offset:10240
	ds_read_b128 v[140:143], v20 offset:11264
	s_waitcnt lgkmcnt(11)
	v_pk_add_f32 v[32:33], v[32:33], v[96:97]
	v_pk_add_f32 v[34:35], v[34:35], v[98:99]
	s_waitcnt lgkmcnt(10)
	v_pk_add_f32 v[36:37], v[36:37], v[100:101]
	v_pk_add_f32 v[38:39], v[38:39], v[102:103]
	s_waitcnt lgkmcnt(9)
	v_pk_add_f32 v[40:41], v[40:41], v[104:105]
	v_pk_add_f32 v[42:43], v[42:43], v[106:107]
	s_waitcnt lgkmcnt(8)
	v_pk_add_f32 v[44:45], v[44:45], v[108:109]
	v_pk_add_f32 v[46:47], v[46:47], v[110:111]
	s_waitcnt lgkmcnt(7)
	v_pk_add_f32 v[32:33], v[32:33], v[112:113]
	v_pk_add_f32 v[34:35], v[34:35], v[114:115]
	s_waitcnt lgkmcnt(6)
	v_pk_add_f32 v[36:37], v[36:37], v[116:117]
	v_pk_add_f32 v[38:39], v[38:39], v[118:119]
	s_waitcnt lgkmcnt(5)
	v_pk_add_f32 v[40:41], v[40:41], v[120:121]
	v_pk_add_f32 v[42:43], v[42:43], v[122:123]
	s_waitcnt lgkmcnt(4)
	v_pk_add_f32 v[44:45], v[44:45], v[124:125]
	v_pk_add_f32 v[46:47], v[46:47], v[126:127]
	s_waitcnt lgkmcnt(3)
	v_pk_add_f32 v[32:33], v[32:33], v[128:129]
	v_pk_add_f32 v[34:35], v[34:35], v[130:131]
	s_waitcnt lgkmcnt(2)
	v_pk_add_f32 v[36:37], v[36:37], v[132:133]
	v_pk_add_f32 v[38:39], v[38:39], v[134:135]
	s_waitcnt lgkmcnt(1)
	v_pk_add_f32 v[40:41], v[40:41], v[136:137]
	v_pk_add_f32 v[42:43], v[42:43], v[138:139]
	s_waitcnt lgkmcnt(0)
	v_pk_add_f32 v[44:45], v[44:45], v[140:141]
	v_pk_add_f32 v[46:47], v[46:47], v[142:143]
	v_cvt_pk_bf16_f32 v10, v32, v33
	v_cvt_pk_bf16_f32 v11, v34, v35
	v_cvt_pk_bf16_f32 v12, v36, v37
	v_cvt_pk_bf16_f32 v13, v38, v39
	v_cvt_pk_bf16_f32 v14, v40, v41
	v_cvt_pk_bf16_f32 v15, v42, v43
	v_cvt_pk_bf16_f32 v16, v44, v45
	v_cvt_pk_bf16_f32 v17, v46, v47
	v_permlane32_swap_b32 v10, v12
	v_permlane32_swap_b32 v11, v13
	v_permlane32_swap_b32 v14, v16
	v_permlane32_swap_b32 v15, v17
	v_and_b32 v20, 31, v0
	v_lshlrev_b32 v20, 10, v20
	v_lshrrev_b32 v21, 5, v0
	v_lshl_add_u32 v20, v21, 4, v20
	s_lshl_b32 s46, s28, 15
	s_lshl_b32 s47, s29, 6
	s_add_u32 s46, s46, s47
	s_add_u32 s34, s16, s46
	s_addc_u32 s35, s17, 0
	global_store_dwordx4 v20, v[10:13], s[34:35] offset:0
	global_store_dwordx4 v20, v[14:17], s[34:35] offset:32
	s_waitcnt vmcnt(0) lgkmcnt(0)
L_exit:
	s_endpgm
L_fallback_0:
	s_nop 11
	s_waitcnt lgkmcnt(0)
	s_lshl_b32 s42, s22, 2
	s_add_u32 s42, s42, s60
	s_min_u32 s40, s42, 7
	s_add_u32 s43, s60, 8
	s_lshl_b32 s44, s43, 12
	v_add_u32 v50, s44, v104
	v_mov_b32 v48, v105
	ds_read_b128 v[80:83], v50
	s_waitcnt lgkmcnt(0)
	v_mfma_f32_32x32x16_bf16 v[32:47], v[80:83], v[164:167], v[208:223]
	s_nop 11
	v_max3_f32 v48, v48, v32, v33
	v_max3_f32 v48, v48, v34, v35
	v_max3_f32 v48, v48, v36, v37
	v_max3_f32 v48, v48, v38, v39
	v_max3_f32 v48, v48, v40, v41
	v_max3_f32 v48, v48, v42, v43
	v_max3_f32 v48, v48, v44, v45
	v_max3_f32 v48, v48, v46, v47
	v_subrev_u32 v50, 4096, v50
	s_mov_b32 s41, 0
	s_nop 3
L_fbl_88:
	s_cmp_ge_u32 s41, s40
	s_cbranch_scc1 L_fbd_89
	ds_read_b128 v[80:83], v50
	s_waitcnt lgkmcnt(0)
	v_mfma_f32_32x32x16_bf16 v[32:47], v[80:83], v[164:167], 0
	s_nop 11
	v_max3_f32 v48, v48, v32, v33
	v_max3_f32 v48, v48, v34, v35
	v_max3_f32 v48, v48, v36, v37
	v_max3_f32 v48, v48, v38, v39
	v_max3_f32 v48, v48, v40, v41
	v_max3_f32 v48, v48, v42, v43
	v_max3_f32 v48, v48, v44, v45
	v_max3_f32 v48, v48, v46, v47
	v_subrev_u32 v50, 4096, v50
	s_add_u32 s41, s41, 1
	s_waitcnt lgkmcnt(0)
	s_nop 2
	s_branch L_fbl_88
L_fbd_89:
	s_nop 0
	s_nop 11
	s_cmp_lt_u32 s42, 8
	s_cbranch_scc1 L_fbo_90
	ds_read_b128 v[80:83], v50
	s_waitcnt lgkmcnt(0)
	v_mfma_f32_32x32x16_bf16 v[32:47], v[80:83], v[164:167], v[240:255]
	s_nop 11
	v_max3_f32 v48, v48, v32, v33
	v_max3_f32 v48, v48, v34, v35
	v_max3_f32 v48, v48, v36, v37
	v_max3_f32 v48, v48, v38, v39
	v_max3_f32 v48, v48, v40, v41
	v_max3_f32 v48, v48, v42, v43
	v_max3_f32 v48, v48, v44, v45
	v_max3_f32 v48, v48, v46, v47
	v_subrev_u32 v50, 4096, v50
	s_waitcnt lgkmcnt(0)
L_fbo_90:
	s_nop 3
	s_nop 11
	v_mov_b32 v49, v48
	s_nop 1
	v_permlane32_swap_b32 v48, v49
	v_max_f32 v48, v48, v49
	v_add_u32 v50, s44, v104
	v_mul_u32_u24 v51, s43, v175
	v_add_u32 v51, v51, v174
	v_mov_b32 v176, 0
	v_mov_b32 v177, 0
	v_mov_b32 v178, 0
	v_mov_b32 v179, 0
	v_mov_b32 v180, 0
	v_mov_b32 v181, 0
	v_mov_b32 v182, 0
	v_mov_b32 v183, 0
	v_mov_b32 v184, 0
	v_mov_b32 v185, 0
	v_mov_b32 v186, 0
	v_mov_b32 v187, 0
	v_mov_b32 v188, 0
	v_mov_b32 v189, 0
	v_mov_b32 v190, 0
	v_mov_b32 v191, 0
	ds_read_b128 v[80:83], v50
	ds_read_b128 v[88:91], v51 offset:0
	ds_read_b128 v[92:95], v51 offset:1024
	s_waitcnt lgkmcnt(2)
	v_mfma_f32_32x32x16_bf16 v[32:47], v[80:83], v[164:167], v[208:223]
	s_nop 11
	v_sub_f32 v32, v32, v48
	v_sub_f32 v33, v33, v48
	v_sub_f32 v34, v34, v48
	v_sub_f32 v35, v35, v48
	v_sub_f32 v36, v36, v48
	v_sub_f32 v37, v37, v48
	v_sub_f32 v38, v38, v48
	v_sub_f32 v39, v39, v48
	v_sub_f32 v40, v40, v48
	v_sub_f32 v41, v41, v48
	v_sub_f32 v42, v42, v48
	v_sub_f32 v43, v43, v48
	v_sub_f32 v44, v44, v48
	v_sub_f32 v45, v45, v48
	v_sub_f32 v46, v46, v48
	v_sub_f32 v47, v47, v48
	v_exp_f32 v32, v32
	v_exp_f32 v33, v33
	v_exp_f32 v34, v34
	v_exp_f32 v35, v35
	v_exp_f32 v36, v36
	v_exp_f32 v37, v37
	v_exp_f32 v38, v38
	v_exp_f32 v39, v39
	v_exp_f32 v40, v40
	v_exp_f32 v41, v41
	v_exp_f32 v42, v42
	v_exp_f32 v43, v43
	v_exp_f32 v44, v44
	v_exp_f32 v45, v45
	v_exp_f32 v46, v46
	v_exp_f32 v47, v47
	v_cvt_pk_bf16_f32 v64, v32, v33
	v_cvt_pk_bf16_f32 v65, v34, v35
	v_cvt_pk_bf16_f32 v66, v36, v37
	v_cvt_pk_bf16_f32 v67, v38, v39
	v_cvt_pk_bf16_f32 v68, v40, v41
	v_cvt_pk_bf16_f32 v69, v42, v43
	v_cvt_pk_bf16_f32 v70, v44, v45
	v_cvt_pk_bf16_f32 v71, v46, v47
	s_waitcnt lgkmcnt(1)
	v_mfma_f32_32x32x16_bf16 v[176:191], v[88:91], v[64:67], v[176:191]
	s_waitcnt lgkmcnt(0)
	v_mfma_f32_32x32x16_bf16 v[176:191], v[92:95], v[68:71], v[176:191]
	v_sub_u32 v51, v51, v175
	v_subrev_u32 v50, 4096, v50
	s_mov_b32 s41, 0
	s_nop 8
L_fbl_91:
	s_cmp_ge_u32 s41, s40
	s_cbranch_scc1 L_fbd_92
	ds_read_b128 v[80:83], v50
	ds_read_b128 v[88:91], v51 offset:0
	ds_read_b128 v[92:95], v51 offset:1024
	s_waitcnt lgkmcnt(2)
	v_mfma_f32_32x32x16_bf16 v[32:47], v[80:83], v[164:167], 0
	s_nop 11
	v_sub_f32 v32, v32, v48
	v_sub_f32 v33, v33, v48
	v_sub_f32 v34, v34, v48
	v_sub_f32 v35, v35, v48
	v_sub_f32 v36, v36, v48
	v_sub_f32 v37, v37, v48
	v_sub_f32 v38, v38, v48
	v_sub_f32 v39, v39, v48
	v_sub_f32 v40, v40, v48
	v_sub_f32 v41, v41, v48
	v_sub_f32 v42, v42, v48
	v_sub_f32 v43, v43, v48
	v_sub_f32 v44, v44, v48
	v_sub_f32 v45, v45, v48
	v_sub_f32 v46, v46, v48
	v_sub_f32 v47, v47, v48
	v_exp_f32 v32, v32
	v_exp_f32 v33, v33
	v_exp_f32 v34, v34
	v_exp_f32 v35, v35
	v_exp_f32 v36, v36
	v_exp_f32 v37, v37
	v_exp_f32 v38, v38
	v_exp_f32 v39, v39
	v_exp_f32 v40, v40
	v_exp_f32 v41, v41
	v_exp_f32 v42, v42
	v_exp_f32 v43, v43
	v_exp_f32 v44, v44
	v_exp_f32 v45, v45
	v_exp_f32 v46, v46
	v_exp_f32 v47, v47
	v_cvt_pk_bf16_f32 v64, v32, v33
	v_cvt_pk_bf16_f32 v65, v34, v35
	v_cvt_pk_bf16_f32 v66, v36, v37
	v_cvt_pk_bf16_f32 v67, v38, v39
	v_cvt_pk_bf16_f32 v68, v40, v41
	v_cvt_pk_bf16_f32 v69, v42, v43
	v_cvt_pk_bf16_f32 v70, v44, v45
	v_cvt_pk_bf16_f32 v71, v46, v47
	s_waitcnt lgkmcnt(1)
	v_mfma_f32_32x32x16_bf16 v[176:191], v[88:91], v[64:67], v[176:191]
	s_waitcnt lgkmcnt(0)
	v_mfma_f32_32x32x16_bf16 v[176:191], v[92:95], v[68:71], v[176:191]
	v_sub_u32 v51, v51, v175
	v_subrev_u32 v50, 4096, v50
	s_add_u32 s41, s41, 1
	s_waitcnt lgkmcnt(0)
	s_nop 7
	s_branch L_fbl_91
L_fbd_92:
	s_nop 0
	s_nop 11
	s_cmp_lt_u32 s42, 8
	s_cbranch_scc1 L_fbo_93
	ds_read_b128 v[80:83], v50
	ds_read_b128 v[88:91], v51 offset:0
	ds_read_b128 v[92:95], v51 offset:1024
	s_waitcnt lgkmcnt(2)
	v_mfma_f32_32x32x16_bf16 v[32:47], v[80:83], v[164:167], v[240:255]
	s_nop 11
	v_sub_f32 v32, v32, v48
	v_sub_f32 v33, v33, v48
	v_sub_f32 v34, v34, v48
	v_sub_f32 v35, v35, v48
	v_sub_f32 v36, v36, v48
	v_sub_f32 v37, v37, v48
	v_sub_f32 v38, v38, v48
	v_sub_f32 v39, v39, v48
	v_sub_f32 v40, v40, v48
	v_sub_f32 v41, v41, v48
	v_sub_f32 v42, v42, v48
	v_sub_f32 v43, v43, v48
	v_sub_f32 v44, v44, v48
	v_sub_f32 v45, v45, v48
	v_sub_f32 v46, v46, v48
	v_sub_f32 v47, v47, v48
	v_exp_f32 v32, v32
	v_exp_f32 v33, v33
	v_exp_f32 v34, v34
	v_exp_f32 v35, v35
	v_exp_f32 v36, v36
	v_exp_f32 v37, v37
	v_exp_f32 v38, v38
	v_exp_f32 v39, v39
	v_exp_f32 v40, v40
	v_exp_f32 v41, v41
	v_exp_f32 v42, v42
	v_exp_f32 v43, v43
	v_exp_f32 v44, v44
	v_exp_f32 v45, v45
	v_exp_f32 v46, v46
	v_exp_f32 v47, v47
	v_cvt_pk_bf16_f32 v64, v32, v33
	v_cvt_pk_bf16_f32 v65, v34, v35
	v_cvt_pk_bf16_f32 v66, v36, v37
	v_cvt_pk_bf16_f32 v67, v38, v39
	v_cvt_pk_bf16_f32 v68, v40, v41
	v_cvt_pk_bf16_f32 v69, v42, v43
	v_cvt_pk_bf16_f32 v70, v44, v45
	v_cvt_pk_bf16_f32 v71, v46, v47
	s_waitcnt lgkmcnt(1)
	v_mfma_f32_32x32x16_bf16 v[176:191], v[88:91], v[64:67], v[176:191]
	s_waitcnt lgkmcnt(0)
	v_mfma_f32_32x32x16_bf16 v[176:191], v[92:95], v[68:71], v[176:191]
	v_sub_u32 v51, v51, v175
	v_subrev_u32 v50, 4096, v50
	s_waitcnt lgkmcnt(0)
L_fbo_93:
	s_nop 8
	s_nop 11
	s_lshl_b32 s42, s22, 2
	s_add_u32 s42, s42, s61
	s_min_u32 s40, s42, 7
	s_add_u32 s43, s61, 8
	s_lshl_b32 s44, s43, 12
	v_add_u32 v50, s44, v104
	v_mov_b32 v48, v105
	ds_read_b128 v[80:83], v50
	s_waitcnt lgkmcnt(0)
	v_mfma_f32_32x32x16_bf16 v[32:47], v[80:83], v[168:171], v[208:223]
	s_nop 11
	v_max3_f32 v48, v48, v32, v33
	v_max3_f32 v48, v48, v34, v35
	v_max3_f32 v48, v48, v36, v37
	v_max3_f32 v48, v48, v38, v39
	v_max3_f32 v48, v48, v40, v41
	v_max3_f32 v48, v48, v42, v43
	v_max3_f32 v48, v48, v44, v45
	v_max3_f32 v48, v48, v46, v47
	v_subrev_u32 v50, 4096, v50
	s_mov_b32 s41, 0
	s_nop 3
L_fbl_94:
	s_cmp_ge_u32 s41, s40
	s_cbranch_scc1 L_fbd_95
	ds_read_b128 v[80:83], v50
	s_waitcnt lgkmcnt(0)
	v_mfma_f32_32x32x16_bf16 v[32:47], v[80:83], v[168:171], 0
	s_nop 11
	v_max3_f32 v48, v48, v32, v33
	v_max3_f32 v48, v48, v34, v35
	v_max3_f32 v48, v48, v36, v37
	v_max3_f32 v48, v48, v38, v39
	v_max3_f32 v48, v48, v40, v41
	v_max3_f32 v48, v48, v42, v43
	v_max3_f32 v48, v48, v44, v45
	v_max3_f32 v48, v48, v46, v47
	v_subrev_u32 v50, 4096, v50
	s_add_u32 s41, s41, 1
	s_waitcnt lgkmcnt(0)
	s_nop 2
	s_branch L_fbl_94
L_fbd_95:
	s_nop 0
	s_nop 11
	s_cmp_lt_u32 s42, 8
	s_cbranch_scc1 L_fbo_96
	ds_read_b128 v[80:83], v50
	s_waitcnt lgkmcnt(0)
	v_mfma_f32_32x32x16_bf16 v[32:47], v[80:83], v[168:171], v[240:255]
	s_nop 11
	v_max3_f32 v48, v48, v32, v33
	v_max3_f32 v48, v48, v34, v35
	v_max3_f32 v48, v48, v36, v37
	v_max3_f32 v48, v48, v38, v39
	v_max3_f32 v48, v48, v40, v41
	v_max3_f32 v48, v48, v42, v43
	v_max3_f32 v48, v48, v44, v45
	v_max3_f32 v48, v48, v46, v47
	v_subrev_u32 v50, 4096, v50
	s_waitcnt lgkmcnt(0)
L_fbo_96:
	s_nop 3
	s_nop 11
	v_mov_b32 v49, v48
	s_nop 1
	v_permlane32_swap_b32 v48, v49
	v_max_f32 v48, v48, v49
	v_add_u32 v50, s44, v104
	v_mul_u32_u24 v51, s43, v175
	v_add_u32 v51, v51, v174
	v_mov_b32 v192, 0
	v_mov_b32 v193, 0
	v_mov_b32 v194, 0
	v_mov_b32 v195, 0
	v_mov_b32 v196, 0
	v_mov_b32 v197, 0
	v_mov_b32 v198, 0
	v_mov_b32 v199, 0
	v_mov_b32 v200, 0
	v_mov_b32 v201, 0
	v_mov_b32 v202, 0
	v_mov_b32 v203, 0
	v_mov_b32 v204, 0
	v_mov_b32 v205, 0
	v_mov_b32 v206, 0
	v_mov_b32 v207, 0
	ds_read_b128 v[80:83], v50
	ds_read_b128 v[88:91], v51 offset:0
	ds_read_b128 v[92:95], v51 offset:1024
	s_waitcnt lgkmcnt(2)
	v_mfma_f32_32x32x16_bf16 v[32:47], v[80:83], v[168:171], v[208:223]
	s_nop 11
	v_sub_f32 v32, v32, v48
	v_sub_f32 v33, v33, v48
	v_sub_f32 v34, v34, v48
	v_sub_f32 v35, v35, v48
	v_sub_f32 v36, v36, v48
	v_sub_f32 v37, v37, v48
	v_sub_f32 v38, v38, v48
	v_sub_f32 v39, v39, v48
	v_sub_f32 v40, v40, v48
	v_sub_f32 v41, v41, v48
	v_sub_f32 v42, v42, v48
	v_sub_f32 v43, v43, v48
	v_sub_f32 v44, v44, v48
	v_sub_f32 v45, v45, v48
	v_sub_f32 v46, v46, v48
	v_sub_f32 v47, v47, v48
	v_exp_f32 v32, v32
	v_exp_f32 v33, v33
	v_exp_f32 v34, v34
	v_exp_f32 v35, v35
	v_exp_f32 v36, v36
	v_exp_f32 v37, v37
	v_exp_f32 v38, v38
	v_exp_f32 v39, v39
	v_exp_f32 v40, v40
	v_exp_f32 v41, v41
	v_exp_f32 v42, v42
	v_exp_f32 v43, v43
	v_exp_f32 v44, v44
	v_exp_f32 v45, v45
	v_exp_f32 v46, v46
	v_exp_f32 v47, v47
	v_cvt_pk_bf16_f32 v64, v32, v33
	v_cvt_pk_bf16_f32 v65, v34, v35
	v_cvt_pk_bf16_f32 v66, v36, v37
	v_cvt_pk_bf16_f32 v67, v38, v39
	v_cvt_pk_bf16_f32 v68, v40, v41
	v_cvt_pk_bf16_f32 v69, v42, v43
	v_cvt_pk_bf16_f32 v70, v44, v45
	v_cvt_pk_bf16_f32 v71, v46, v47
	s_waitcnt lgkmcnt(1)
	v_mfma_f32_32x32x16_bf16 v[192:207], v[88:91], v[64:67], v[192:207]
	s_waitcnt lgkmcnt(0)
	v_mfma_f32_32x32x16_bf16 v[192:207], v[92:95], v[68:71], v[192:207]
	v_sub_u32 v51, v51, v175
	v_subrev_u32 v50, 4096, v50
	s_mov_b32 s41, 0
	s_nop 8
L_fbl_97:
	s_cmp_ge_u32 s41, s40
	s_cbranch_scc1 L_fbd_98
	ds_read_b128 v[80:83], v50
	ds_read_b128 v[88:91], v51 offset:0
	ds_read_b128 v[92:95], v51 offset:1024
	s_waitcnt lgkmcnt(2)
	v_mfma_f32_32x32x16_bf16 v[32:47], v[80:83], v[168:171], 0
	s_nop 11
	v_sub_f32 v32, v32, v48
	v_sub_f32 v33, v33, v48
	v_sub_f32 v34, v34, v48
	v_sub_f32 v35, v35, v48
	v_sub_f32 v36, v36, v48
	v_sub_f32 v37, v37, v48
	v_sub_f32 v38, v38, v48
	v_sub_f32 v39, v39, v48
	v_sub_f32 v40, v40, v48
	v_sub_f32 v41, v41, v48
	v_sub_f32 v42, v42, v48
	v_sub_f32 v43, v43, v48
	v_sub_f32 v44, v44, v48
	v_sub_f32 v45, v45, v48
	v_sub_f32 v46, v46, v48
	v_sub_f32 v47, v47, v48
	v_exp_f32 v32, v32
	v_exp_f32 v33, v33
	v_exp_f32 v34, v34
	v_exp_f32 v35, v35
	v_exp_f32 v36, v36
	v_exp_f32 v37, v37
	v_exp_f32 v38, v38
	v_exp_f32 v39, v39
	v_exp_f32 v40, v40
	v_exp_f32 v41, v41
	v_exp_f32 v42, v42
	v_exp_f32 v43, v43
	v_exp_f32 v44, v44
	v_exp_f32 v45, v45
	v_exp_f32 v46, v46
	v_exp_f32 v47, v47
	v_cvt_pk_bf16_f32 v64, v32, v33
	v_cvt_pk_bf16_f32 v65, v34, v35
	v_cvt_pk_bf16_f32 v66, v36, v37
	v_cvt_pk_bf16_f32 v67, v38, v39
	v_cvt_pk_bf16_f32 v68, v40, v41
	v_cvt_pk_bf16_f32 v69, v42, v43
	v_cvt_pk_bf16_f32 v70, v44, v45
	v_cvt_pk_bf16_f32 v71, v46, v47
	s_waitcnt lgkmcnt(1)
	v_mfma_f32_32x32x16_bf16 v[192:207], v[88:91], v[64:67], v[192:207]
	s_waitcnt lgkmcnt(0)
	v_mfma_f32_32x32x16_bf16 v[192:207], v[92:95], v[68:71], v[192:207]
	v_sub_u32 v51, v51, v175
	v_subrev_u32 v50, 4096, v50
	s_add_u32 s41, s41, 1
	s_waitcnt lgkmcnt(0)
	s_nop 7
	s_branch L_fbl_97
L_fbd_98:
	s_nop 0
	s_nop 11
	s_cmp_lt_u32 s42, 8
	s_cbranch_scc1 L_fbo_99
	ds_read_b128 v[80:83], v50
	ds_read_b128 v[88:91], v51 offset:0
	ds_read_b128 v[92:95], v51 offset:1024
	s_waitcnt lgkmcnt(2)
	v_mfma_f32_32x32x16_bf16 v[32:47], v[80:83], v[168:171], v[240:255]
	s_nop 11
	v_sub_f32 v32, v32, v48
	v_sub_f32 v33, v33, v48
	v_sub_f32 v34, v34, v48
	v_sub_f32 v35, v35, v48
	v_sub_f32 v36, v36, v48
	v_sub_f32 v37, v37, v48
	v_sub_f32 v38, v38, v48
	v_sub_f32 v39, v39, v48
	v_sub_f32 v40, v40, v48
	v_sub_f32 v41, v41, v48
	v_sub_f32 v42, v42, v48
	v_sub_f32 v43, v43, v48
	v_sub_f32 v44, v44, v48
	v_sub_f32 v45, v45, v48
	v_sub_f32 v46, v46, v48
	v_sub_f32 v47, v47, v48
	v_exp_f32 v32, v32
	v_exp_f32 v33, v33
	v_exp_f32 v34, v34
	v_exp_f32 v35, v35
	v_exp_f32 v36, v36
	v_exp_f32 v37, v37
	v_exp_f32 v38, v38
	v_exp_f32 v39, v39
	v_exp_f32 v40, v40
	v_exp_f32 v41, v41
	v_exp_f32 v42, v42
	v_exp_f32 v43, v43
	v_exp_f32 v44, v44
	v_exp_f32 v45, v45
	v_exp_f32 v46, v46
	v_exp_f32 v47, v47
	v_cvt_pk_bf16_f32 v64, v32, v33
	v_cvt_pk_bf16_f32 v65, v34, v35
	v_cvt_pk_bf16_f32 v66, v36, v37
	v_cvt_pk_bf16_f32 v67, v38, v39
	v_cvt_pk_bf16_f32 v68, v40, v41
	v_cvt_pk_bf16_f32 v69, v42, v43
	v_cvt_pk_bf16_f32 v70, v44, v45
	v_cvt_pk_bf16_f32 v71, v46, v47
	s_waitcnt lgkmcnt(1)
	v_mfma_f32_32x32x16_bf16 v[192:207], v[88:91], v[64:67], v[192:207]
	s_waitcnt lgkmcnt(0)
	v_mfma_f32_32x32x16_bf16 v[192:207], v[92:95], v[68:71], v[192:207]
	v_sub_u32 v51, v51, v175
	v_subrev_u32 v50, 4096, v50
	s_waitcnt lgkmcnt(0)
L_fbo_99:
	s_nop 8
	s_nop 11
	s_nop 11
	s_branch L_norm_0
L_fallback_1:
	s_nop 11
	s_waitcnt lgkmcnt(0)
	s_lshl_b32 s42, s22, 2
	s_add_u32 s42, s42, s60
	s_min_u32 s40, s42, 7
	s_add_u32 s43, s60, 8
	s_lshl_b32 s44, s43, 12
	v_add_u32 v50, s44, v104
	v_mov_b32 v48, v105
	ds_read_b128 v[80:83], v50
	s_waitcnt lgkmcnt(0)
	v_mfma_f32_32x32x16_bf16 v[32:47], v[80:83], v[164:167], v[208:223]
	s_nop 11
	v_max3_f32 v48, v48, v32, v33
	v_max3_f32 v48, v48, v34, v35
	v_max3_f32 v48, v48, v36, v37
	v_max3_f32 v48, v48, v38, v39
	v_max3_f32 v48, v48, v40, v41
	v_max3_f32 v48, v48, v42, v43
	v_max3_f32 v48, v48, v44, v45
	v_max3_f32 v48, v48, v46, v47
	v_subrev_u32 v50, 4096, v50
	s_mov_b32 s41, 0
	s_nop 3
L_fbl_100:
	s_cmp_ge_u32 s41, s40
	s_cbranch_scc1 L_fbd_101
	ds_read_b128 v[80:83], v50
	s_waitcnt lgkmcnt(0)
	v_mfma_f32_32x32x16_bf16 v[32:47], v[80:83], v[164:167], 0
	s_nop 11
	v_max3_f32 v48, v48, v32, v33
	v_max3_f32 v48, v48, v34, v35
	v_max3_f32 v48, v48, v36, v37
	v_max3_f32 v48, v48, v38, v39
	v_max3_f32 v48, v48, v40, v41
	v_max3_f32 v48, v48, v42, v43
	v_max3_f32 v48, v48, v44, v45
	v_max3_f32 v48, v48, v46, v47
	v_subrev_u32 v50, 4096, v50
	s_add_u32 s41, s41, 1
	s_waitcnt lgkmcnt(0)
	s_nop 2
	s_branch L_fbl_100
L_fbd_101:
	s_nop 0
	s_nop 11
	s_cmp_lt_u32 s42, 8
	s_cbranch_scc1 L_fbo_102
	ds_read_b128 v[80:83], v50
	s_waitcnt lgkmcnt(0)
	v_mfma_f32_32x32x16_bf16 v[32:47], v[80:83], v[164:167], v[240:255]
	s_nop 11
	v_max3_f32 v48, v48, v32, v33
	v_max3_f32 v48, v48, v34, v35
	v_max3_f32 v48, v48, v36, v37
	v_max3_f32 v48, v48, v38, v39
	v_max3_f32 v48, v48, v40, v41
	v_max3_f32 v48, v48, v42, v43
	v_max3_f32 v48, v48, v44, v45
	v_max3_f32 v48, v48, v46, v47
	v_subrev_u32 v50, 4096, v50
	s_waitcnt lgkmcnt(0)
L_fbo_102:
	s_nop 3
	s_nop 11
	v_mov_b32 v49, v48
	s_nop 1
	v_permlane32_swap_b32 v48, v49
	v_max_f32 v48, v48, v49
	v_add_u32 v50, s44, v104
	v_mul_u32_u24 v51, s43, v175
	v_add_u32 v51, v51, v174
	v_mov_b32 v176, 0
	v_mov_b32 v177, 0
	v_mov_b32 v178, 0
	v_mov_b32 v179, 0
	v_mov_b32 v180, 0
	v_mov_b32 v181, 0
	v_mov_b32 v182, 0
	v_mov_b32 v183, 0
	v_mov_b32 v184, 0
	v_mov_b32 v185, 0
	v_mov_b32 v186, 0
	v_mov_b32 v187, 0
	v_mov_b32 v188, 0
	v_mov_b32 v189, 0
	v_mov_b32 v190, 0
	v_mov_b32 v191, 0
	ds_read_b128 v[80:83], v50
	ds_read_b128 v[88:91], v51 offset:0
	ds_read_b128 v[92:95], v51 offset:1024
	s_waitcnt lgkmcnt(2)
	v_mfma_f32_32x32x16_bf16 v[32:47], v[80:83], v[164:167], v[208:223]
	s_nop 11
	v_sub_f32 v32, v32, v48
	v_sub_f32 v33, v33, v48
	v_sub_f32 v34, v34, v48
	v_sub_f32 v35, v35, v48
	v_sub_f32 v36, v36, v48
	v_sub_f32 v37, v37, v48
	v_sub_f32 v38, v38, v48
	v_sub_f32 v39, v39, v48
	v_sub_f32 v40, v40, v48
	v_sub_f32 v41, v41, v48
	v_sub_f32 v42, v42, v48
	v_sub_f32 v43, v43, v48
	v_sub_f32 v44, v44, v48
	v_sub_f32 v45, v45, v48
	v_sub_f32 v46, v46, v48
	v_sub_f32 v47, v47, v48
	v_exp_f32 v32, v32
	v_exp_f32 v33, v33
	v_exp_f32 v34, v34
	v_exp_f32 v35, v35
	v_exp_f32 v36, v36
	v_exp_f32 v37, v37
	v_exp_f32 v38, v38
	v_exp_f32 v39, v39
	v_exp_f32 v40, v40
	v_exp_f32 v41, v41
	v_exp_f32 v42, v42
	v_exp_f32 v43, v43
	v_exp_f32 v44, v44
	v_exp_f32 v45, v45
	v_exp_f32 v46, v46
	v_exp_f32 v47, v47
	v_cvt_pk_bf16_f32 v64, v32, v33
	v_cvt_pk_bf16_f32 v65, v34, v35
	v_cvt_pk_bf16_f32 v66, v36, v37
	v_cvt_pk_bf16_f32 v67, v38, v39
	v_cvt_pk_bf16_f32 v68, v40, v41
	v_cvt_pk_bf16_f32 v69, v42, v43
	v_cvt_pk_bf16_f32 v70, v44, v45
	v_cvt_pk_bf16_f32 v71, v46, v47
	s_waitcnt lgkmcnt(1)
	v_mfma_f32_32x32x16_bf16 v[176:191], v[88:91], v[64:67], v[176:191]
	s_waitcnt lgkmcnt(0)
	v_mfma_f32_32x32x16_bf16 v[176:191], v[92:95], v[68:71], v[176:191]
	v_sub_u32 v51, v51, v175
	v_subrev_u32 v50, 4096, v50
	s_mov_b32 s41, 0
	s_nop 8
L_fbl_103:
	s_cmp_ge_u32 s41, s40
	s_cbranch_scc1 L_fbd_104
	ds_read_b128 v[80:83], v50
	ds_read_b128 v[88:91], v51 offset:0
	ds_read_b128 v[92:95], v51 offset:1024
	s_waitcnt lgkmcnt(2)
	v_mfma_f32_32x32x16_bf16 v[32:47], v[80:83], v[164:167], 0
	s_nop 11
	v_sub_f32 v32, v32, v48
	v_sub_f32 v33, v33, v48
	v_sub_f32 v34, v34, v48
	v_sub_f32 v35, v35, v48
	v_sub_f32 v36, v36, v48
	v_sub_f32 v37, v37, v48
	v_sub_f32 v38, v38, v48
	v_sub_f32 v39, v39, v48
	v_sub_f32 v40, v40, v48
	v_sub_f32 v41, v41, v48
	v_sub_f32 v42, v42, v48
	v_sub_f32 v43, v43, v48
	v_sub_f32 v44, v44, v48
	v_sub_f32 v45, v45, v48
	v_sub_f32 v46, v46, v48
	v_sub_f32 v47, v47, v48
	v_exp_f32 v32, v32
	v_exp_f32 v33, v33
	v_exp_f32 v34, v34
	v_exp_f32 v35, v35
	v_exp_f32 v36, v36
	v_exp_f32 v37, v37
	v_exp_f32 v38, v38
	v_exp_f32 v39, v39
	v_exp_f32 v40, v40
	v_exp_f32 v41, v41
	v_exp_f32 v42, v42
	v_exp_f32 v43, v43
	v_exp_f32 v44, v44
	v_exp_f32 v45, v45
	v_exp_f32 v46, v46
	v_exp_f32 v47, v47
	v_cvt_pk_bf16_f32 v64, v32, v33
	v_cvt_pk_bf16_f32 v65, v34, v35
	v_cvt_pk_bf16_f32 v66, v36, v37
	v_cvt_pk_bf16_f32 v67, v38, v39
	v_cvt_pk_bf16_f32 v68, v40, v41
	v_cvt_pk_bf16_f32 v69, v42, v43
	v_cvt_pk_bf16_f32 v70, v44, v45
	v_cvt_pk_bf16_f32 v71, v46, v47
	s_waitcnt lgkmcnt(1)
	v_mfma_f32_32x32x16_bf16 v[176:191], v[88:91], v[64:67], v[176:191]
	s_waitcnt lgkmcnt(0)
	v_mfma_f32_32x32x16_bf16 v[176:191], v[92:95], v[68:71], v[176:191]
	v_sub_u32 v51, v51, v175
	v_subrev_u32 v50, 4096, v50
	s_add_u32 s41, s41, 1
	s_waitcnt lgkmcnt(0)
	s_nop 7
	s_branch L_fbl_103
L_fbd_104:
	s_nop 0
	s_nop 11
	s_cmp_lt_u32 s42, 8
	s_cbranch_scc1 L_fbo_105
	ds_read_b128 v[80:83], v50
	ds_read_b128 v[88:91], v51 offset:0
	ds_read_b128 v[92:95], v51 offset:1024
	s_waitcnt lgkmcnt(2)
	v_mfma_f32_32x32x16_bf16 v[32:47], v[80:83], v[164:167], v[240:255]
	s_nop 11
	v_sub_f32 v32, v32, v48
	v_sub_f32 v33, v33, v48
	v_sub_f32 v34, v34, v48
	v_sub_f32 v35, v35, v48
	v_sub_f32 v36, v36, v48
	v_sub_f32 v37, v37, v48
	v_sub_f32 v38, v38, v48
	v_sub_f32 v39, v39, v48
	v_sub_f32 v40, v40, v48
	v_sub_f32 v41, v41, v48
	v_sub_f32 v42, v42, v48
	v_sub_f32 v43, v43, v48
	v_sub_f32 v44, v44, v48
	v_sub_f32 v45, v45, v48
	v_sub_f32 v46, v46, v48
	v_sub_f32 v47, v47, v48
	v_exp_f32 v32, v32
	v_exp_f32 v33, v33
	v_exp_f32 v34, v34
	v_exp_f32 v35, v35
	v_exp_f32 v36, v36
	v_exp_f32 v37, v37
	v_exp_f32 v38, v38
	v_exp_f32 v39, v39
	v_exp_f32 v40, v40
	v_exp_f32 v41, v41
	v_exp_f32 v42, v42
	v_exp_f32 v43, v43
	v_exp_f32 v44, v44
	v_exp_f32 v45, v45
	v_exp_f32 v46, v46
	v_exp_f32 v47, v47
	v_cvt_pk_bf16_f32 v64, v32, v33
	v_cvt_pk_bf16_f32 v65, v34, v35
	v_cvt_pk_bf16_f32 v66, v36, v37
	v_cvt_pk_bf16_f32 v67, v38, v39
	v_cvt_pk_bf16_f32 v68, v40, v41
	v_cvt_pk_bf16_f32 v69, v42, v43
	v_cvt_pk_bf16_f32 v70, v44, v45
	v_cvt_pk_bf16_f32 v71, v46, v47
	s_waitcnt lgkmcnt(1)
	v_mfma_f32_32x32x16_bf16 v[176:191], v[88:91], v[64:67], v[176:191]
	s_waitcnt lgkmcnt(0)
	v_mfma_f32_32x32x16_bf16 v[176:191], v[92:95], v[68:71], v[176:191]
	v_sub_u32 v51, v51, v175
	v_subrev_u32 v50, 4096, v50
	s_waitcnt lgkmcnt(0)
L_fbo_105:
	s_nop 8
	s_nop 11
	s_lshl_b32 s42, s22, 2
	s_add_u32 s42, s42, s61
	s_min_u32 s40, s42, 7
	s_add_u32 s43, s61, 8
	s_lshl_b32 s44, s43, 12
	v_add_u32 v50, s44, v104
	v_mov_b32 v48, v105
	ds_read_b128 v[80:83], v50
	s_waitcnt lgkmcnt(0)
	v_mfma_f32_32x32x16_bf16 v[32:47], v[80:83], v[168:171], v[208:223]
	s_nop 11
	v_max3_f32 v48, v48, v32, v33
	v_max3_f32 v48, v48, v34, v35
	v_max3_f32 v48, v48, v36, v37
	v_max3_f32 v48, v48, v38, v39
	v_max3_f32 v48, v48, v40, v41
	v_max3_f32 v48, v48, v42, v43
	v_max3_f32 v48, v48, v44, v45
	v_max3_f32 v48, v48, v46, v47
	v_subrev_u32 v50, 4096, v50
	s_mov_b32 s41, 0
	s_nop 3
L_fbl_106:
	s_cmp_ge_u32 s41, s40
	s_cbranch_scc1 L_fbd_107
	ds_read_b128 v[80:83], v50
	s_waitcnt lgkmcnt(0)
	v_mfma_f32_32x32x16_bf16 v[32:47], v[80:83], v[168:171], 0
	s_nop 11
	v_max3_f32 v48, v48, v32, v33
	v_max3_f32 v48, v48, v34, v35
	v_max3_f32 v48, v48, v36, v37
	v_max3_f32 v48, v48, v38, v39
	v_max3_f32 v48, v48, v40, v41
	v_max3_f32 v48, v48, v42, v43
	v_max3_f32 v48, v48, v44, v45
	v_max3_f32 v48, v48, v46, v47
	v_subrev_u32 v50, 4096, v50
	s_add_u32 s41, s41, 1
	s_waitcnt lgkmcnt(0)
	s_nop 2
	s_branch L_fbl_106
L_fbd_107:
	s_nop 0
	s_nop 11
	s_cmp_lt_u32 s42, 8
	s_cbranch_scc1 L_fbo_108
	ds_read_b128 v[80:83], v50
	s_waitcnt lgkmcnt(0)
	v_mfma_f32_32x32x16_bf16 v[32:47], v[80:83], v[168:171], v[240:255]
	s_nop 11
	v_max3_f32 v48, v48, v32, v33
	v_max3_f32 v48, v48, v34, v35
	v_max3_f32 v48, v48, v36, v37
	v_max3_f32 v48, v48, v38, v39
	v_max3_f32 v48, v48, v40, v41
	v_max3_f32 v48, v48, v42, v43
	v_max3_f32 v48, v48, v44, v45
	v_max3_f32 v48, v48, v46, v47
	v_subrev_u32 v50, 4096, v50
	s_waitcnt lgkmcnt(0)
L_fbo_108:
	s_nop 3
	s_nop 11
	v_mov_b32 v49, v48
	s_nop 1
	v_permlane32_swap_b32 v48, v49
	v_max_f32 v48, v48, v49
	v_add_u32 v50, s44, v104
	v_mul_u32_u24 v51, s43, v175
	v_add_u32 v51, v51, v174
	v_mov_b32 v192, 0
	v_mov_b32 v193, 0
	v_mov_b32 v194, 0
	v_mov_b32 v195, 0
	v_mov_b32 v196, 0
	v_mov_b32 v197, 0
	v_mov_b32 v198, 0
	v_mov_b32 v199, 0
	v_mov_b32 v200, 0
	v_mov_b32 v201, 0
	v_mov_b32 v202, 0
	v_mov_b32 v203, 0
	v_mov_b32 v204, 0
	v_mov_b32 v205, 0
	v_mov_b32 v206, 0
	v_mov_b32 v207, 0
	ds_read_b128 v[80:83], v50
	ds_read_b128 v[88:91], v51 offset:0
	ds_read_b128 v[92:95], v51 offset:1024
	s_waitcnt lgkmcnt(2)
	v_mfma_f32_32x32x16_bf16 v[32:47], v[80:83], v[168:171], v[208:223]
	s_nop 11
	v_sub_f32 v32, v32, v48
	v_sub_f32 v33, v33, v48
	v_sub_f32 v34, v34, v48
	v_sub_f32 v35, v35, v48
	v_sub_f32 v36, v36, v48
	v_sub_f32 v37, v37, v48
	v_sub_f32 v38, v38, v48
	v_sub_f32 v39, v39, v48
	v_sub_f32 v40, v40, v48
	v_sub_f32 v41, v41, v48
	v_sub_f32 v42, v42, v48
	v_sub_f32 v43, v43, v48
	v_sub_f32 v44, v44, v48
	v_sub_f32 v45, v45, v48
	v_sub_f32 v46, v46, v48
	v_sub_f32 v47, v47, v48
	v_exp_f32 v32, v32
	v_exp_f32 v33, v33
	v_exp_f32 v34, v34
	v_exp_f32 v35, v35
	v_exp_f32 v36, v36
	v_exp_f32 v37, v37
	v_exp_f32 v38, v38
	v_exp_f32 v39, v39
	v_exp_f32 v40, v40
	v_exp_f32 v41, v41
	v_exp_f32 v42, v42
	v_exp_f32 v43, v43
	v_exp_f32 v44, v44
	v_exp_f32 v45, v45
	v_exp_f32 v46, v46
	v_exp_f32 v47, v47
	v_cvt_pk_bf16_f32 v64, v32, v33
	v_cvt_pk_bf16_f32 v65, v34, v35
	v_cvt_pk_bf16_f32 v66, v36, v37
	v_cvt_pk_bf16_f32 v67, v38, v39
	v_cvt_pk_bf16_f32 v68, v40, v41
	v_cvt_pk_bf16_f32 v69, v42, v43
	v_cvt_pk_bf16_f32 v70, v44, v45
	v_cvt_pk_bf16_f32 v71, v46, v47
	s_waitcnt lgkmcnt(1)
	v_mfma_f32_32x32x16_bf16 v[192:207], v[88:91], v[64:67], v[192:207]
	s_waitcnt lgkmcnt(0)
	v_mfma_f32_32x32x16_bf16 v[192:207], v[92:95], v[68:71], v[192:207]
	v_sub_u32 v51, v51, v175
	v_subrev_u32 v50, 4096, v50
	s_mov_b32 s41, 0
	s_nop 8
L_fbl_109:
	s_cmp_ge_u32 s41, s40
	s_cbranch_scc1 L_fbd_110
	ds_read_b128 v[80:83], v50
	ds_read_b128 v[88:91], v51 offset:0
	ds_read_b128 v[92:95], v51 offset:1024
	s_waitcnt lgkmcnt(2)
	v_mfma_f32_32x32x16_bf16 v[32:47], v[80:83], v[168:171], 0
	s_nop 11
	v_sub_f32 v32, v32, v48
	v_sub_f32 v33, v33, v48
	v_sub_f32 v34, v34, v48
	v_sub_f32 v35, v35, v48
	v_sub_f32 v36, v36, v48
	v_sub_f32 v37, v37, v48
	v_sub_f32 v38, v38, v48
	v_sub_f32 v39, v39, v48
	v_sub_f32 v40, v40, v48
	v_sub_f32 v41, v41, v48
	v_sub_f32 v42, v42, v48
	v_sub_f32 v43, v43, v48
	v_sub_f32 v44, v44, v48
	v_sub_f32 v45, v45, v48
	v_sub_f32 v46, v46, v48
	v_sub_f32 v47, v47, v48
	v_exp_f32 v32, v32
	v_exp_f32 v33, v33
	v_exp_f32 v34, v34
	v_exp_f32 v35, v35
	v_exp_f32 v36, v36
	v_exp_f32 v37, v37
	v_exp_f32 v38, v38
	v_exp_f32 v39, v39
	v_exp_f32 v40, v40
	v_exp_f32 v41, v41
	v_exp_f32 v42, v42
	v_exp_f32 v43, v43
	v_exp_f32 v44, v44
	v_exp_f32 v45, v45
	v_exp_f32 v46, v46
	v_exp_f32 v47, v47
	v_cvt_pk_bf16_f32 v64, v32, v33
	v_cvt_pk_bf16_f32 v65, v34, v35
	v_cvt_pk_bf16_f32 v66, v36, v37
	v_cvt_pk_bf16_f32 v67, v38, v39
	v_cvt_pk_bf16_f32 v68, v40, v41
	v_cvt_pk_bf16_f32 v69, v42, v43
	v_cvt_pk_bf16_f32 v70, v44, v45
	v_cvt_pk_bf16_f32 v71, v46, v47
	s_waitcnt lgkmcnt(1)
	v_mfma_f32_32x32x16_bf16 v[192:207], v[88:91], v[64:67], v[192:207]
	s_waitcnt lgkmcnt(0)
	v_mfma_f32_32x32x16_bf16 v[192:207], v[92:95], v[68:71], v[192:207]
	v_sub_u32 v51, v51, v175
	v_subrev_u32 v50, 4096, v50
	s_add_u32 s41, s41, 1
	s_waitcnt lgkmcnt(0)
	s_nop 7
	s_branch L_fbl_109
L_fbd_110:
	s_nop 0
	s_nop 11
	s_cmp_lt_u32 s42, 8
	s_cbranch_scc1 L_fbo_111
	ds_read_b128 v[80:83], v50
	ds_read_b128 v[88:91], v51 offset:0
	ds_read_b128 v[92:95], v51 offset:1024
	s_waitcnt lgkmcnt(2)
	v_mfma_f32_32x32x16_bf16 v[32:47], v[80:83], v[168:171], v[240:255]
	s_nop 11
	v_sub_f32 v32, v32, v48
	v_sub_f32 v33, v33, v48
	v_sub_f32 v34, v34, v48
	v_sub_f32 v35, v35, v48
	v_sub_f32 v36, v36, v48
	v_sub_f32 v37, v37, v48
	v_sub_f32 v38, v38, v48
	v_sub_f32 v39, v39, v48
	v_sub_f32 v40, v40, v48
	v_sub_f32 v41, v41, v48
	v_sub_f32 v42, v42, v48
	v_sub_f32 v43, v43, v48
	v_sub_f32 v44, v44, v48
	v_sub_f32 v45, v45, v48
	v_sub_f32 v46, v46, v48
	v_sub_f32 v47, v47, v48
	v_exp_f32 v32, v32
	v_exp_f32 v33, v33
	v_exp_f32 v34, v34
	v_exp_f32 v35, v35
	v_exp_f32 v36, v36
	v_exp_f32 v37, v37
	v_exp_f32 v38, v38
	v_exp_f32 v39, v39
	v_exp_f32 v40, v40
	v_exp_f32 v41, v41
	v_exp_f32 v42, v42
	v_exp_f32 v43, v43
	v_exp_f32 v44, v44
	v_exp_f32 v45, v45
	v_exp_f32 v46, v46
	v_exp_f32 v47, v47
	v_cvt_pk_bf16_f32 v64, v32, v33
	v_cvt_pk_bf16_f32 v65, v34, v35
	v_cvt_pk_bf16_f32 v66, v36, v37
	v_cvt_pk_bf16_f32 v67, v38, v39
	v_cvt_pk_bf16_f32 v68, v40, v41
	v_cvt_pk_bf16_f32 v69, v42, v43
	v_cvt_pk_bf16_f32 v70, v44, v45
	v_cvt_pk_bf16_f32 v71, v46, v47
	s_waitcnt lgkmcnt(1)
	v_mfma_f32_32x32x16_bf16 v[192:207], v[88:91], v[64:67], v[192:207]
	s_waitcnt lgkmcnt(0)
	v_mfma_f32_32x32x16_bf16 v[192:207], v[92:95], v[68:71], v[192:207]
	v_sub_u32 v51, v51, v175
	v_subrev_u32 v50, 4096, v50
	s_waitcnt lgkmcnt(0)
L_fbo_111:
	s_nop 8
	s_nop 11
	s_nop 11
	s_branch L_norm_1
.section .rodata,"a"
.p2align 6
.amdhsa_kernel interleave_layers__sliding_block__glu_gated_bilinear__prompt_kernel
  .amdhsa_next_free_vgpr 512
  .amdhsa_next_free_sgpr 102
  .amdhsa_accum_offset 256
  .amdhsa_group_segment_fixed_size 0
  .amdhsa_kernarg_size 80
  .amdhsa_user_sgpr_count 2
  .amdhsa_user_sgpr_kernarg_segment_ptr 1
  .amdhsa_system_sgpr_workgroup_id_x 1
.end_amdhsa_kernel
```
